```python
import torch

def _softmax(x, axis=-1):
    return torch.softmax(x, dim=axis)
def _gelu(x):
    return torch.nn.functional.gelu(x, approximate="tanh")
def _silu(x):
    return torch.nn.functional.silu(x)
def _sigmoid(x):
    return torch.sigmoid(x)
def _layernorm(x, axis=-1, eps=1e-5):
    m = x.mean(dim=axis, keepdim=True)
    v = x.var(dim=axis, keepdim=True, unbiased=False)
    return (x - m) / torch.sqrt(v + eps)
def _scatter_add(tgt, idx, src, axis=0):
    return tgt.clone().index_add_(axis, idx, src)
def _segment_sum(src, seg, n):
    out = torch.zeros((n,) + src.shape[1:], dtype=src.dtype)
    return out.index_add_(0, seg, src)
def _pad(x, pw):
    flat = tuple(v for pair in reversed(pw) for v in pair)
    return torch.nn.functional.pad(x, flat)

kernel_name = 'parallel_sum__mha_block_cached__dense_activation_silu__decode'

def setup_inputs():

    _w = (lambda a: (lambda t: t.to(torch.bfloat16) if t.is_floating_point() else t)(torch.as_tensor(a)))
    def _A_setup():
        B, Sq, D = 8, 1, 448
        H, Sk, Dh = 16, 4096, 256
        return {
            "x": _w((lambda *s: torch.randn(*s, dtype=torch.bfloat16) * 0.05)(B, Sq, D)),
            "k_cache": _w((lambda *s: torch.randn(*s, dtype=torch.bfloat16) * 3.2)(B, H, Sk, Dh)),
            "v_cache": _w((lambda *s: torch.randn(*s, dtype=torch.bfloat16) * 0.8)(B, H, Sk, Dh)),
            "wq": _w((lambda *s: torch.randn(*s, dtype=torch.bfloat16) * 3.2)(D, H * Dh) * (D ** -0.5)),
            "wo": _w((lambda *s: torch.randn(*s, dtype=torch.bfloat16) * 0.8)(H * Dh, D) * ((H * Dh) ** -0.5)),
        }
    _A_in = _A_setup()

    def _B_setup():
        B, S, D, F = 8, 1, 448, 1792
        return {
            "x": _w((lambda *s: torch.randn(*s, dtype=torch.bfloat16) * 0.05)(B, S, D)),
            "w1": _w((lambda *s: torch.randn(*s, dtype=torch.bfloat16) * 3.2)(D, F) * (D ** -0.5)),
            "w2": _w((lambda *s: torch.randn(*s, dtype=torch.bfloat16) * 0.4)(F, D) * (F ** -0.5)),
        }
    _B_in = _B_setup()

    return {
        "A_x": _A_in["x"],
        "A_k_cache": _A_in["k_cache"],
        "A_v_cache": _A_in["v_cache"],
        "A_wq": _A_in["wq"],
        "A_wo": _A_in["wo"],
        "B_x": _B_in["x"],
        "B_w1": _B_in["w1"],
        "B_w2": _B_in["w2"],
    }

def reference(A_x, A_k_cache, A_v_cache, A_wq, A_wo, B_x, B_w1, B_w2):
    def _A_ref(x, k_cache, v_cache, wq, wo):
        B, Sq, D = x.shape
        H, Dh = 16, 256
        q = (lambda x, *d: x.permute(*d))((x @ wq).reshape(B, Sq, H, Dh), 0, 2, 1, 3)
        scores = torch.einsum("bhqd,bhkd->bhqk", q, k_cache) * (Dh ** -0.5)
        p = _softmax(scores, axis=-1)
        o = torch.einsum("bhqk,bhkd->bhqd", p, v_cache)
        return (lambda x, *d: x.permute(*d))(o, 0, 2, 1, 3).reshape(B, Sq, H * Dh) @ wo

    def _B_ref(x, w1, w2):
        h = torch.einsum("bsd,df->bsf", x, w1)
        h = _silu(h)
        out = torch.einsum("bsf,fd->bsd", h, w2)
        return out

    x = A_x
    xn = _layernorm(x, axis=-1)
    return x + _A_ref(xn, A_k_cache, A_v_cache, A_wq, A_wo) + _B_ref(xn, B_w1, B_w2)
```

```asm
; @launch grid=(256,1,1) block=(512,1,1) lds=86912
.amdgcn_target "amdgcn-amd-amdhsa--gfx950"
.text
.globl parallel_sum__mha_block_cached__dense_activation_silu__decode_kernel
.p2align 8
.type parallel_sum__mha_block_cached__dense_activation_silu__decode_kernel,@function
parallel_sum__mha_block_cached__dense_activation_silu__decode_kernel:
    s_cmp_ge_u32 s2, 256
    s_cbranch_scc1 L_end
    s_load_dwordx16 s[4:19], s[0:1], 0
    s_load_dwordx4 s[20:23], s[0:1], 64
    s_load_dwordx2 s[24:25], s[0:1], 80
    v_lshrrev_b32 v1, 6, v0
    v_and_b32 v0, 63, v0
    v_readfirstlane_b32 s3, v1
    s_and_b32 s26, s2, 7
    s_lshr_b32 s27, s2, 3
    s_and_b32 s28, s27, 1
    s_bfe_u32 s29, s27, 0x10001
    s_lshr_b32 s30, s27, 2
    s_lshl_b32 s29, s29, 3
    s_add_u32 s31, s26, s29
    s_lshl_b32 s32, s31, 1
    s_add_u32 s32, s32, s28
    s_lshl_b32 s33, s30, 5
    s_add_u32 s33, s33, s32
    v_lshrrev_b32 v2, 3, v0
    v_and_b32 v3, 7, v0
    s_mov_b32 s34, 0x3db8aa3b
    s_mov_b32 s60, 0x00ff00ff
    s_mov_b32 s61, 0x00ff00ff
    s_mov_b32 s97, 0xfffff000
    s_lshr_b32 s98, s33, 5
    s_mul_i32 s98, s98, 1
    s_and_b32 s98, s98, 0xff
    s_lshl_b32 s98, s98, 12
    s_cmp_eq_u32 s3, 0
    s_cbranch_scc1 L_stream
    s_cmp_ge_u32 s3, 5
    s_cbranch_scc1 L_buf
    s_branch L_help
L_stream:
    s_setprio 3
    v_lshlrev_b32 v4, 9, v2
    v_lshl_add_u32 v4, v3, 4, v4
    v_mul_u32_u24 v6, 1040, v2
    v_lshrrev_b32 v7, 2, v3
    v_lshl_add_u32 v6, v7, 2, v6
    v_mov_b32 v8, 0xff800000
    s_lshl_b32 s35, s33, 20
    v_mov_b32 v5, v4
    v_mov_b32 v36, 0
    ds_write_b32 v36, v36 offset:584
    s_waitcnt lgkmcnt(0)
    s_add_u32 s36, s6, s35
    s_addc_u32 s37, s7, 0
    s_mov_b32 s38, 1048576
    s_mov_b32 s39, 0x20000
    s_add_u32 s40, s8, s35
    s_addc_u32 s41, s9, 0
    s_mov_b32 s42, 1048576
    s_mov_b32 s43, 0x20000
    s_mov_b32 s44, s98
    s_mov_b32 s45, s98
    s_mov_b32 s50, 2
    s_cmp_eq_u32 s28, 1
    s_cbranch_scc1 L_b0_1
    s_barrier
L_b0_1:
    buffer_load_dwordx4 v[64:67], v4, s[36:39], s44 offen offset:0 nt
    buffer_load_dwordx4 v[68:71], v4, s[36:39], s44 offen offset:128 nt
    buffer_load_dwordx4 v[72:75], v4, s[36:39], s44 offen offset:256 nt
    buffer_load_dwordx4 v[76:79], v4, s[36:39], s44 offen offset:384 nt
    s_add_u32 s44, s44, 4096
    s_and_b32 s44, s44, 0xfffff
    buffer_load_dwordx4 v[80:83], v4, s[36:39], s44 offen offset:0 nt
    buffer_load_dwordx4 v[84:87], v4, s[36:39], s44 offen offset:128 nt
    buffer_load_dwordx4 v[88:91], v4, s[36:39], s44 offen offset:256 nt
    buffer_load_dwordx4 v[92:95], v4, s[36:39], s44 offen offset:384 nt
    s_add_u32 s44, s44, 28672
    s_and_b32 s44, s44, 0xfffff
    buffer_load_dwordx4 v[96:99], v4, s[36:39], s44 offen offset:0 nt
    buffer_load_dwordx4 v[100:103], v4, s[36:39], s44 offen offset:128 nt
    s_lshl_b32 s47, s30, 17
    s_add_u32 s52, s24, s47
    s_addc_u32 s53, s25, 0
    s_mov_b32 s54, 131072
    s_mov_b32 s55, 0x20000
    s_mul_i32 s47, s30, 896
    s_add_u32 s92, s20, s47
    s_addc_u32 s93, s21, 0
    s_mov_b32 s94, 896
    s_mov_b32 s95, 0x20000
    s_waitcnt vmcnt(9)
    buffer_load_dwordx4 v[104:107], v4, s[36:39], s44 offen offset:256 nt
    s_waitcnt vmcnt(9)
    buffer_load_dwordx4 v[108:111], v4, s[36:39], s44 offen offset:384 nt
    s_add_u32 s44, s44, 4096
    s_and_b32 s44, s44, 0xfffff
    s_waitcnt vmcnt(9)
    buffer_load_dwordx4 v[112:115], v4, s[36:39], s44 offen offset:0 nt
    s_waitcnt vmcnt(9)
    buffer_load_dwordx4 v[116:119], v4, s[36:39], s44 offen offset:128 nt
    s_waitcnt vmcnt(9)
    buffer_load_dwordx4 v[120:123], v4, s[36:39], s44 offen offset:256 nt
    s_waitcnt vmcnt(9)
    buffer_load_dwordx4 v[124:127], v4, s[36:39], s44 offen offset:384 nt
    s_add_u32 s44, s44, 28672
    s_and_b32 s44, s44, 0xfffff
    s_waitcnt vmcnt(9)
    buffer_load_dwordx4 v[128:131], v4, s[36:39], s44 offen offset:0 nt
    s_waitcnt vmcnt(9)
    buffer_load_dwordx4 v[132:135], v4, s[36:39], s44 offen offset:128 nt
    s_waitcnt vmcnt(9)
    buffer_load_dwordx4 v[136:139], v4, s[36:39], s44 offen offset:256 nt
    s_waitcnt vmcnt(9)
    buffer_load_dwordx4 v[140:143], v4, s[36:39], s44 offen offset:384 nt
    s_add_u32 s44, s44, 4096
    s_and_b32 s44, s44, 0xfffff
    s_waitcnt vmcnt(9)
    buffer_load_dwordx4 v[144:147], v4, s[36:39], s44 offen offset:0 nt
    s_waitcnt vmcnt(9)
    buffer_load_dwordx4 v[148:151], v4, s[36:39], s44 offen offset:128 nt
    s_waitcnt vmcnt(9)
    buffer_load_dwordx4 v[152:155], v4, s[36:39], s44 offen offset:256 nt
    s_waitcnt vmcnt(9)
    buffer_load_dwordx4 v[156:159], v4, s[36:39], s44 offen offset:384 nt
    s_add_u32 s44, s44, 28672
    s_and_b32 s44, s44, 0xfffff
    s_waitcnt vmcnt(9)
    buffer_load_dwordx4 v[160:163], v4, s[36:39], s44 offen offset:0 nt
    s_waitcnt vmcnt(9)
    buffer_load_dwordx4 v[164:167], v4, s[36:39], s44 offen offset:128 nt
    s_waitcnt vmcnt(9)
    buffer_load_dwordx4 v[168:171], v4, s[36:39], s44 offen offset:256 nt
    s_waitcnt vmcnt(9)
    buffer_load_dwordx4 v[172:175], v4, s[36:39], s44 offen offset:384 nt
    s_add_u32 s44, s44, 4096
    s_and_b32 s44, s44, 0xfffff
    s_waitcnt vmcnt(9)
    buffer_load_dwordx4 v[176:179], v4, s[36:39], s44 offen offset:0 nt
    s_waitcnt vmcnt(9)
    buffer_load_dwordx4 v[180:183], v4, s[36:39], s44 offen offset:128 nt
    s_waitcnt vmcnt(9)
    buffer_load_dwordx4 v[184:187], v4, s[36:39], s44 offen offset:256 nt
    s_waitcnt vmcnt(9)
    buffer_load_dwordx4 v[188:191], v4, s[36:39], s44 offen offset:384 nt
    s_add_u32 s44, s44, 28672
    s_and_b32 s44, s44, 0xfffff
    s_waitcnt vmcnt(9)
    buffer_load_dwordx4 v[192:195], v4, s[36:39], s44 offen offset:0 nt
    s_waitcnt vmcnt(9)
    buffer_load_dwordx4 v[196:199], v4, s[36:39], s44 offen offset:128 nt
    s_waitcnt vmcnt(9)
    buffer_load_dwordx4 v[200:203], v4, s[36:39], s44 offen offset:256 nt
    s_waitcnt vmcnt(9)
    buffer_load_dwordx4 v[204:207], v4, s[36:39], s44 offen offset:384 nt
    s_add_u32 s44, s44, 4096
    s_and_b32 s44, s44, 0xfffff
    s_waitcnt vmcnt(9)
    buffer_load_dwordx4 v[208:211], v4, s[36:39], s44 offen offset:0 nt
    s_waitcnt vmcnt(9)
    buffer_load_dwordx4 v[212:215], v4, s[36:39], s44 offen offset:128 nt
    s_waitcnt vmcnt(9)
    buffer_load_dwordx4 v[216:219], v4, s[36:39], s44 offen offset:256 nt
    s_waitcnt vmcnt(9)
    buffer_load_dwordx4 v[220:223], v4, s[36:39], s44 offen offset:384 nt
    s_add_u32 s44, s44, 28672
    s_and_b32 s44, s44, 0xfffff
    s_waitcnt vmcnt(9)
    buffer_load_dwordx4 v[224:227], v4, s[36:39], s44 offen offset:0 nt
    s_waitcnt vmcnt(9)
    buffer_load_dwordx4 v[228:231], v4, s[36:39], s44 offen offset:128 nt
    s_waitcnt vmcnt(9)
    buffer_load_dwordx4 v[232:235], v4, s[36:39], s44 offen offset:256 nt
    s_waitcnt vmcnt(9)
    buffer_load_dwordx4 v[236:239], v4, s[36:39], s44 offen offset:384 nt
    s_add_u32 s44, s44, 4096
    s_and_b32 s44, s44, 0xfffff
    s_waitcnt vmcnt(9)
    buffer_load_dwordx4 v[240:243], v4, s[36:39], s44 offen offset:0 nt
    s_waitcnt vmcnt(9)
    buffer_load_dwordx4 v[244:247], v4, s[36:39], s44 offen offset:128 nt
    s_waitcnt vmcnt(9)
    buffer_load_dwordx4 v[248:251], v4, s[36:39], s44 offen offset:256 nt
    s_cmp_eq_u32 s28, 0
    s_cbranch_scc1 L_b0_2
    s_barrier
L_b0_2:
    s_barrier
    v_lshlrev_b32 v9, 4, v3
    ds_read_b128 v[16:19], v9 offset:0
    ds_read_b128 v[20:23], v9 offset:128
    ds_read_b128 v[24:27], v9 offset:256
    ds_read_b128 v[28:31], v9 offset:384
    s_waitcnt lgkmcnt(0)
    s_waitcnt vmcnt(23)
    buffer_load_dwordx4 v[252:255], v4, s[36:39], s44 offen offset:384 nt
    s_add_u32 s44, s44, 28672
    s_and_b32 s44, s44, 0xfffff
    v_dot2_f32_bf16 v11, v64, v16, 0
    v_dot2_f32_bf16 v12, v65, v17, 0
    v_dot2_f32_bf16 v11, v66, v18, v11
    v_dot2_f32_bf16 v12, v67, v19, v12
    s_waitcnt vmcnt(23)
    buffer_load_dwordx4 v[64:67], v4, s[36:39], s44 offen offset:0 nt
    v_dot2_f32_bf16 v11, v68, v20, v11
    v_dot2_f32_bf16 v12, v69, v21, v12
    v_dot2_f32_bf16 v11, v70, v22, v11
    v_dot2_f32_bf16 v12, v71, v23, v12
    s_waitcnt vmcnt(23)
    buffer_load_dwordx4 v[68:71], v4, s[36:39], s44 offen offset:128 nt
    v_dot2_f32_bf16 v11, v72, v24, v11
    v_dot2_f32_bf16 v12, v73, v25, v12
    v_dot2_f32_bf16 v11, v74, v26, v11
    v_dot2_f32_bf16 v12, v75, v27, v12
    s_waitcnt vmcnt(23)
    buffer_load_dwordx4 v[72:75], v4, s[36:39], s44 offen offset:256 nt
    v_dot2_f32_bf16 v11, v76, v28, v11
    v_dot2_f32_bf16 v12, v77, v29, v12
    v_dot2_f32_bf16 v11, v78, v30, v11
    v_dot2_f32_bf16 v12, v79, v31, v12
    s_waitcnt vmcnt(23)
    buffer_load_dwordx4 v[76:79], v4, s[36:39], s44 offen offset:384 nt
    s_add_u32 s44, s44, 4096
    s_and_b32 s44, s44, 0xfffff
    v_dot2_f32_bf16 v13, v80, v16, 0
    v_dot2_f32_bf16 v14, v81, v17, 0
    v_dot2_f32_bf16 v13, v82, v18, v13
    v_dot2_f32_bf16 v14, v83, v19, v14
    v_add_f32 v11, v11, v12
    s_waitcnt vmcnt(23)
    buffer_load_dwordx4 v[80:83], v4, s[36:39], s44 offen offset:0 nt
    v_dot2_f32_bf16 v13, v84, v20, v13
    v_dot2_f32_bf16 v14, v85, v21, v14
    v_dot2_f32_bf16 v13, v86, v22, v13
    v_dot2_f32_bf16 v14, v87, v23, v14
    v_add_f32_dpp v9, v11, v11 row_half_mirror row_mask:0xf bank_mask:0x5
    s_waitcnt vmcnt(23)
    buffer_load_dwordx4 v[84:87], v4, s[36:39], s44 offen offset:128 nt
    v_dot2_f32_bf16 v13, v88, v24, v13
    v_dot2_f32_bf16 v14, v89, v25, v14
    v_dot2_f32_bf16 v13, v90, v26, v13
    v_dot2_f32_bf16 v14, v91, v27, v14
    s_waitcnt vmcnt(23)
    buffer_load_dwordx4 v[88:91], v4, s[36:39], s44 offen offset:256 nt
    v_dot2_f32_bf16 v13, v92, v28, v13
    v_dot2_f32_bf16 v14, v93, v29, v14
    v_dot2_f32_bf16 v13, v94, v30, v13
    v_dot2_f32_bf16 v14, v95, v31, v14
    s_waitcnt vmcnt(23)
    buffer_load_dwordx4 v[92:95], v4, s[36:39], s44 offen offset:384 nt
    s_add_u32 s44, s44, 4096
    s_and_b32 s44, s44, 0xfffff
    v_dot2_f32_bf16 v11, v96, v16, 0
    v_dot2_f32_bf16 v12, v97, v17, 0
    v_dot2_f32_bf16 v11, v98, v18, v11
    v_dot2_f32_bf16 v12, v99, v19, v12
    v_add_f32 v13, v13, v14
    s_waitcnt vmcnt(23)
    buffer_load_dwordx4 v[96:99], v4, s[36:39], s44 offen offset:0 nt
    v_dot2_f32_bf16 v11, v100, v20, v11
    v_dot2_f32_bf16 v12, v101, v21, v12
    v_dot2_f32_bf16 v11, v102, v22, v11
    v_dot2_f32_bf16 v12, v103, v23, v12
    v_add_f32_dpp v9, v13, v13 row_half_mirror row_mask:0xf bank_mask:0xa
    s_waitcnt vmcnt(23)
    buffer_load_dwordx4 v[100:103], v4, s[36:39], s44 offen offset:128 nt
    v_dot2_f32_bf16 v11, v104, v24, v11
    v_dot2_f32_bf16 v12, v105, v25, v12
    v_dot2_f32_bf16 v11, v106, v26, v11
    v_dot2_f32_bf16 v12, v107, v27, v12
    v_add_f32_dpp v9, v9, v9 quad_perm:[1,0,3,2] row_mask:0xf bank_mask:0xf
    s_waitcnt vmcnt(23)
    buffer_load_dwordx4 v[104:107], v4, s[36:39], s44 offen offset:256 nt
    v_dot2_f32_bf16 v11, v108, v28, v11
    v_dot2_f32_bf16 v12, v109, v29, v12
    v_dot2_f32_bf16 v11, v110, v30, v11
    v_dot2_f32_bf16 v12, v111, v31, v12
    v_add_f32_dpp v9, v9, v9 quad_perm:[2,3,0,1] row_mask:0xf bank_mask:0xf
    s_waitcnt vmcnt(23)
    buffer_load_dwordx4 v[108:111], v4, s[36:39], s44 offen offset:384 nt
    s_add_u32 s44, s44, 4096
    s_and_b32 s44, s44, 0xfffff
    v_dot2_f32_bf16 v13, v112, v16, 0
    v_dot2_f32_bf16 v14, v113, v17, 0
    v_dot2_f32_bf16 v13, v114, v18, v13
    v_dot2_f32_bf16 v14, v115, v19, v14
    v_cvt_pk_bf16_f32 v10, 0, v9
    v_add_f32 v11, v11, v12
    s_waitcnt vmcnt(23)
    buffer_load_dwordx4 v[112:115], v4, s[36:39], s44 offen offset:0 nt
    v_dot2_f32_bf16 v13, v116, v20, v13
    v_dot2_f32_bf16 v14, v117, v21, v14
    v_dot2_f32_bf16 v13, v118, v22, v13
    v_dot2_f32_bf16 v14, v119, v23, v14
    v_max_f32 v8, v8, v10
    ds_write_b32 v6, v10 offset:1280
    v_add_f32_dpp v9, v11, v11 row_half_mirror row_mask:0xf bank_mask:0x5
    s_waitcnt vmcnt(23)
    buffer_load_dwordx4 v[116:119], v4, s[36:39], s44 offen offset:128 nt
    v_dot2_f32_bf16 v13, v120, v24, v13
    v_dot2_f32_bf16 v14, v121, v25, v14
    v_dot2_f32_bf16 v13, v122, v26, v13
    v_dot2_f32_bf16 v14, v123, v27, v14
    s_waitcnt vmcnt(23)
    buffer_load_dwordx4 v[120:123], v4, s[36:39], s44 offen offset:256 nt
    v_dot2_f32_bf16 v13, v124, v28, v13
    v_dot2_f32_bf16 v14, v125, v29, v14
    v_dot2_f32_bf16 v13, v126, v30, v13
    v_dot2_f32_bf16 v14, v127, v31, v14
    s_waitcnt vmcnt(23)
    buffer_load_dwordx4 v[124:127], v4, s[36:39], s44 offen offset:384 nt
    s_add_u32 s44, s44, 4096
    s_and_b32 s44, s44, 0xfffff
    v_dot2_f32_bf16 v11, v128, v16, 0
    v_dot2_f32_bf16 v12, v129, v17, 0
    v_dot2_f32_bf16 v11, v130, v18, v11
    v_dot2_f32_bf16 v12, v131, v19, v12
    v_add_f32 v13, v13, v14
    s_waitcnt vmcnt(23)
    buffer_load_dwordx4 v[128:131], v4, s[36:39], s44 offen offset:0 nt
    v_dot2_f32_bf16 v11, v132, v20, v11
    v_dot2_f32_bf16 v12, v133, v21, v12
    v_dot2_f32_bf16 v11, v134, v22, v11
    v_dot2_f32_bf16 v12, v135, v23, v12
    v_add_f32_dpp v9, v13, v13 row_half_mirror row_mask:0xf bank_mask:0xa
    s_waitcnt vmcnt(23)
    buffer_load_dwordx4 v[132:135], v4, s[36:39], s44 offen offset:128 nt
    v_dot2_f32_bf16 v11, v136, v24, v11
    v_dot2_f32_bf16 v12, v137, v25, v12
    v_dot2_f32_bf16 v11, v138, v26, v11
    v_dot2_f32_bf16 v12, v139, v27, v12
    v_add_f32_dpp v9, v9, v9 quad_perm:[1,0,3,2] row_mask:0xf bank_mask:0xf
    s_waitcnt vmcnt(23)
    buffer_load_dwordx4 v[136:139], v4, s[36:39], s44 offen offset:256 nt
    v_dot2_f32_bf16 v11, v140, v28, v11
    v_dot2_f32_bf16 v12, v141, v29, v12
    v_dot2_f32_bf16 v11, v142, v30, v11
    v_dot2_f32_bf16 v12, v143, v31, v12
    v_add_f32_dpp v9, v9, v9 quad_perm:[2,3,0,1] row_mask:0xf bank_mask:0xf
    s_waitcnt vmcnt(23)
    buffer_load_dwordx4 v[140:143], v4, s[36:39], s44 offen offset:384 nt
    s_add_u32 s44, s44, 4096
    s_and_b32 s44, s44, 0xfffff
    v_dot2_f32_bf16 v13, v144, v16, 0
    v_dot2_f32_bf16 v14, v145, v17, 0
    v_dot2_f32_bf16 v13, v146, v18, v13
    v_dot2_f32_bf16 v14, v147, v19, v14
    v_cvt_pk_bf16_f32 v10, 0, v9
    v_add_f32 v11, v11, v12
    s_waitcnt vmcnt(23)
    buffer_load_dwordx4 v[144:147], v4, s[36:39], s44 offen offset:0 nt
    v_dot2_f32_bf16 v13, v148, v20, v13
    v_dot2_f32_bf16 v14, v149, v21, v14
    v_dot2_f32_bf16 v13, v150, v22, v13
    v_dot2_f32_bf16 v14, v151, v23, v14
    v_max_f32 v8, v8, v10
    ds_write_b32 v6, v10 offset:1312
    v_add_f32_dpp v9, v11, v11 row_half_mirror row_mask:0xf bank_mask:0x5
    s_waitcnt vmcnt(23)
    buffer_load_dwordx4 v[148:151], v4, s[36:39], s44 offen offset:128 nt
    v_dot2_f32_bf16 v13, v152, v24, v13
    v_dot2_f32_bf16 v14, v153, v25, v14
    v_dot2_f32_bf16 v13, v154, v26, v13
    v_dot2_f32_bf16 v14, v155, v27, v14
    s_waitcnt vmcnt(23)
    buffer_load_dwordx4 v[152:155], v4, s[36:39], s44 offen offset:256 nt
    v_dot2_f32_bf16 v13, v156, v28, v13
    v_dot2_f32_bf16 v14, v157, v29, v14
    v_dot2_f32_bf16 v13, v158, v30, v13
    v_dot2_f32_bf16 v14, v159, v31, v14
    s_waitcnt vmcnt(23)
    buffer_load_dwordx4 v[156:159], v4, s[36:39], s44 offen offset:384 nt
    s_add_u32 s44, s44, 4096
    s_and_b32 s44, s44, 0xfffff
    v_dot2_f32_bf16 v11, v160, v16, 0
    v_dot2_f32_bf16 v12, v161, v17, 0
    v_dot2_f32_bf16 v11, v162, v18, v11
    v_dot2_f32_bf16 v12, v163, v19, v12
    v_add_f32 v13, v13, v14
    s_waitcnt vmcnt(23)
    buffer_load_dwordx4 v[160:163], v4, s[36:39], s44 offen offset:0 nt
    v_dot2_f32_bf16 v11, v164, v20, v11
    v_dot2_f32_bf16 v12, v165, v21, v12
    v_dot2_f32_bf16 v11, v166, v22, v11
    v_dot2_f32_bf16 v12, v167, v23, v12
    v_add_f32_dpp v9, v13, v13 row_half_mirror row_mask:0xf bank_mask:0xa
    s_waitcnt vmcnt(23)
    buffer_load_dwordx4 v[164:167], v4, s[36:39], s44 offen offset:128 nt
    v_dot2_f32_bf16 v11, v168, v24, v11
    v_dot2_f32_bf16 v12, v169, v25, v12
    v_dot2_f32_bf16 v11, v170, v26, v11
    v_dot2_f32_bf16 v12, v171, v27, v12
    v_add_f32_dpp v9, v9, v9 quad_perm:[1,0,3,2] row_mask:0xf bank_mask:0xf
    s_waitcnt vmcnt(23)
    buffer_load_dwordx4 v[168:171], v4, s[36:39], s44 offen offset:256 nt
    v_dot2_f32_bf16 v11, v172, v28, v11
    v_dot2_f32_bf16 v12, v173, v29, v12
    v_dot2_f32_bf16 v11, v174, v30, v11
    v_dot2_f32_bf16 v12, v175, v31, v12
    v_add_f32_dpp v9, v9, v9 quad_perm:[2,3,0,1] row_mask:0xf bank_mask:0xf
    s_waitcnt vmcnt(23)
    buffer_load_dwordx4 v[172:175], v4, s[36:39], s44 offen offset:384 nt
    s_add_u32 s44, s44, 4096
    s_and_b32 s44, s44, 0xfffff
    v_dot2_f32_bf16 v13, v176, v16, 0
    v_dot2_f32_bf16 v14, v177, v17, 0
    v_dot2_f32_bf16 v13, v178, v18, v13
    v_dot2_f32_bf16 v14, v179, v19, v14
    v_cvt_pk_bf16_f32 v10, 0, v9
    v_add_f32 v11, v11, v12
    s_waitcnt vmcnt(23)
    buffer_load_dwordx4 v[176:179], v4, s[36:39], s44 offen offset:0 nt
    v_dot2_f32_bf16 v13, v180, v20, v13
    v_dot2_f32_bf16 v14, v181, v21, v14
    v_dot2_f32_bf16 v13, v182, v22, v13
    v_dot2_f32_bf16 v14, v183, v23, v14
    v_max_f32 v8, v8, v10
    ds_write_b32 v6, v10 offset:1344
    v_add_f32_dpp v9, v11, v11 row_half_mirror row_mask:0xf bank_mask:0x5
    s_waitcnt vmcnt(23)
    buffer_load_dwordx4 v[180:183], v4, s[36:39], s44 offen offset:128 nt
    v_dot2_f32_bf16 v13, v184, v24, v13
    v_dot2_f32_bf16 v14, v185, v25, v14
    v_dot2_f32_bf16 v13, v186, v26, v13
    v_dot2_f32_bf16 v14, v187, v27, v14
    s_waitcnt vmcnt(23)
    buffer_load_dwordx4 v[184:187], v4, s[36:39], s44 offen offset:256 nt
    v_dot2_f32_bf16 v13, v188, v28, v13
    v_dot2_f32_bf16 v14, v189, v29, v14
    v_dot2_f32_bf16 v13, v190, v30, v13
    v_dot2_f32_bf16 v14, v191, v31, v14
    s_waitcnt vmcnt(23)
    buffer_load_dwordx4 v[188:191], v4, s[36:39], s44 offen offset:384 nt
    s_add_u32 s44, s44, 4096
    s_and_b32 s44, s44, 0xfffff
    v_dot2_f32_bf16 v11, v192, v16, 0
    v_dot2_f32_bf16 v12, v193, v17, 0
    v_dot2_f32_bf16 v11, v194, v18, v11
    v_dot2_f32_bf16 v12, v195, v19, v12
    v_add_f32 v13, v13, v14
    s_waitcnt vmcnt(23)
    buffer_load_dwordx4 v[192:195], v4, s[36:39], s44 offen offset:0 nt
    v_dot2_f32_bf16 v11, v196, v20, v11
    v_dot2_f32_bf16 v12, v197, v21, v12
    v_dot2_f32_bf16 v11, v198, v22, v11
    v_dot2_f32_bf16 v12, v199, v23, v12
    v_add_f32_dpp v9, v13, v13 row_half_mirror row_mask:0xf bank_mask:0xa
    s_waitcnt vmcnt(23)
    buffer_load_dwordx4 v[196:199], v4, s[36:39], s44 offen offset:128 nt
    v_dot2_f32_bf16 v11, v200, v24, v11
    v_dot2_f32_bf16 v12, v201, v25, v12
    v_dot2_f32_bf16 v11, v202, v26, v11
    v_dot2_f32_bf16 v12, v203, v27, v12
    v_add_f32_dpp v9, v9, v9 quad_perm:[1,0,3,2] row_mask:0xf bank_mask:0xf
    s_waitcnt vmcnt(23)
    buffer_load_dwordx4 v[200:203], v4, s[36:39], s44 offen offset:256 nt
    v_dot2_f32_bf16 v11, v204, v28, v11
    v_dot2_f32_bf16 v12, v205, v29, v12
    v_dot2_f32_bf16 v11, v206, v30, v11
    v_dot2_f32_bf16 v12, v207, v31, v12
    v_add_f32_dpp v9, v9, v9 quad_perm:[2,3,0,1] row_mask:0xf bank_mask:0xf
    s_waitcnt vmcnt(23)
    buffer_load_dwordx4 v[204:207], v4, s[36:39], s44 offen offset:384 nt
    s_add_u32 s44, s44, 4096
    s_and_b32 s44, s44, 0xfffff
    v_dot2_f32_bf16 v13, v208, v16, 0
    v_dot2_f32_bf16 v14, v209, v17, 0
    v_dot2_f32_bf16 v13, v210, v18, v13
    v_dot2_f32_bf16 v14, v211, v19, v14
    v_cvt_pk_bf16_f32 v10, 0, v9
    v_add_f32 v11, v11, v12
    s_waitcnt vmcnt(23)
    buffer_load_dwordx4 v[208:211], v4, s[36:39], s44 offen offset:0 nt
    v_dot2_f32_bf16 v13, v212, v20, v13
    v_dot2_f32_bf16 v14, v213, v21, v14
    v_dot2_f32_bf16 v13, v214, v22, v13
    v_dot2_f32_bf16 v14, v215, v23, v14
    v_max_f32 v8, v8, v10
    ds_write_b32 v6, v10 offset:1376
    v_add_f32_dpp v9, v11, v11 row_half_mirror row_mask:0xf bank_mask:0x5
    s_waitcnt vmcnt(23)
    buffer_load_dwordx4 v[212:215], v4, s[36:39], s44 offen offset:128 nt
    v_dot2_f32_bf16 v13, v216, v24, v13
    v_dot2_f32_bf16 v14, v217, v25, v14
    v_dot2_f32_bf16 v13, v218, v26, v13
    v_dot2_f32_bf16 v14, v219, v27, v14
    s_waitcnt vmcnt(23)
    buffer_load_dwordx4 v[216:219], v4, s[36:39], s44 offen offset:256 nt
    v_dot2_f32_bf16 v13, v220, v28, v13
    v_dot2_f32_bf16 v14, v221, v29, v14
    v_dot2_f32_bf16 v13, v222, v30, v13
    v_dot2_f32_bf16 v14, v223, v31, v14
    s_waitcnt vmcnt(23)
    buffer_load_dwordx4 v[220:223], v4, s[36:39], s44 offen offset:384 nt
    s_add_u32 s44, s44, 4096
    s_and_b32 s44, s44, 0xfffff
    v_dot2_f32_bf16 v11, v224, v16, 0
    v_dot2_f32_bf16 v12, v225, v17, 0
    v_dot2_f32_bf16 v11, v226, v18, v11
    v_dot2_f32_bf16 v12, v227, v19, v12
    v_add_f32 v13, v13, v14
    s_waitcnt vmcnt(23)
    buffer_load_dwordx4 v[224:227], v4, s[36:39], s44 offen offset:0 nt
    v_dot2_f32_bf16 v11, v228, v20, v11
    v_dot2_f32_bf16 v12, v229, v21, v12
    v_dot2_f32_bf16 v11, v230, v22, v11
    v_dot2_f32_bf16 v12, v231, v23, v12
    v_add_f32_dpp v9, v13, v13 row_half_mirror row_mask:0xf bank_mask:0xa
    s_waitcnt vmcnt(23)
    buffer_load_dwordx4 v[228:231], v4, s[36:39], s44 offen offset:128 nt
    v_dot2_f32_bf16 v11, v232, v24, v11
    v_dot2_f32_bf16 v12, v233, v25, v12
    v_dot2_f32_bf16 v11, v234, v26, v11
    v_dot2_f32_bf16 v12, v235, v27, v12
    v_add_f32_dpp v9, v9, v9 quad_perm:[1,0,3,2] row_mask:0xf bank_mask:0xf
    s_waitcnt vmcnt(23)
    buffer_load_dwordx4 v[232:235], v4, s[36:39], s44 offen offset:256 nt
    v_dot2_f32_bf16 v11, v236, v28, v11
    v_dot2_f32_bf16 v12, v237, v29, v12
    v_dot2_f32_bf16 v11, v238, v30, v11
    v_dot2_f32_bf16 v12, v239, v31, v12
    v_add_f32_dpp v9, v9, v9 quad_perm:[2,3,0,1] row_mask:0xf bank_mask:0xf
    s_waitcnt vmcnt(23)
    buffer_load_dwordx4 v[236:239], v4, s[36:39], s44 offen offset:384 nt
    s_add_u32 s44, s44, 4096
    s_and_b32 s44, s44, 0xfffff
    v_dot2_f32_bf16 v13, v240, v16, 0
    v_dot2_f32_bf16 v14, v241, v17, 0
    v_dot2_f32_bf16 v13, v242, v18, v13
    v_dot2_f32_bf16 v14, v243, v19, v14
    v_cvt_pk_bf16_f32 v10, 0, v9
    v_add_f32 v11, v11, v12
    s_waitcnt vmcnt(23)
    buffer_load_dwordx4 v[240:243], v4, s[36:39], s44 offen offset:0 nt
    v_dot2_f32_bf16 v13, v244, v20, v13
    v_dot2_f32_bf16 v14, v245, v21, v14
    v_dot2_f32_bf16 v13, v246, v22, v13
    v_dot2_f32_bf16 v14, v247, v23, v14
    v_max_f32 v8, v8, v10
    ds_write_b32 v6, v10 offset:1408
    v_add_f32_dpp v9, v11, v11 row_half_mirror row_mask:0xf bank_mask:0x5
    s_waitcnt vmcnt(23)
    buffer_load_dwordx4 v[244:247], v4, s[36:39], s44 offen offset:128 nt
    v_dot2_f32_bf16 v13, v248, v24, v13
    v_dot2_f32_bf16 v14, v249, v25, v14
    v_dot2_f32_bf16 v13, v250, v26, v13
    v_dot2_f32_bf16 v14, v251, v27, v14
    s_waitcnt vmcnt(23)
    buffer_load_dwordx4 v[248:251], v4, s[36:39], s44 offen offset:256 nt
    v_dot2_f32_bf16 v13, v252, v28, v13
    v_dot2_f32_bf16 v14, v253, v29, v14
    v_dot2_f32_bf16 v13, v254, v30, v13
    v_dot2_f32_bf16 v14, v255, v31, v14
    s_waitcnt vmcnt(23)
    buffer_load_dwordx4 v[252:255], v4, s[36:39], s44 offen offset:384 nt
    s_add_u32 s44, s44, 4096
    s_and_b32 s44, s44, 0xfffff
    v_dot2_f32_bf16 v11, v64, v16, 0
    v_dot2_f32_bf16 v12, v65, v17, 0
    v_dot2_f32_bf16 v11, v66, v18, v11
    v_dot2_f32_bf16 v12, v67, v19, v12
    v_add_f32 v13, v13, v14
    s_waitcnt vmcnt(23)
    buffer_load_dwordx4 v[64:67], v4, s[36:39], s44 offen offset:0 nt
    v_dot2_f32_bf16 v11, v68, v20, v11
    v_dot2_f32_bf16 v12, v69, v21, v12
    v_dot2_f32_bf16 v11, v70, v22, v11
    v_dot2_f32_bf16 v12, v71, v23, v12
    v_add_f32_dpp v9, v13, v13 row_half_mirror row_mask:0xf bank_mask:0xa
    s_waitcnt vmcnt(23)
    buffer_load_dwordx4 v[68:71], v4, s[36:39], s44 offen offset:128 nt
    v_dot2_f32_bf16 v11, v72, v24, v11
    v_dot2_f32_bf16 v12, v73, v25, v12
    v_dot2_f32_bf16 v11, v74, v26, v11
    v_dot2_f32_bf16 v12, v75, v27, v12
    v_add_f32_dpp v9, v9, v9 quad_perm:[1,0,3,2] row_mask:0xf bank_mask:0xf
    s_waitcnt vmcnt(23)
    buffer_load_dwordx4 v[72:75], v4, s[36:39], s44 offen offset:256 nt
    v_dot2_f32_bf16 v11, v76, v28, v11
    v_dot2_f32_bf16 v12, v77, v29, v12
    v_dot2_f32_bf16 v11, v78, v30, v11
    v_dot2_f32_bf16 v12, v79, v31, v12
    v_add_f32_dpp v9, v9, v9 quad_perm:[2,3,0,1] row_mask:0xf bank_mask:0xf
    s_waitcnt vmcnt(23)
    buffer_load_dwordx4 v[76:79], v4, s[36:39], s44 offen offset:384 nt
    s_add_u32 s44, s44, 4096
    s_and_b32 s44, s44, 0xfffff
    v_dot2_f32_bf16 v13, v80, v16, 0
    v_dot2_f32_bf16 v14, v81, v17, 0
    v_dot2_f32_bf16 v13, v82, v18, v13
    v_dot2_f32_bf16 v14, v83, v19, v14
    v_cvt_pk_bf16_f32 v10, 0, v9
    v_add_f32 v11, v11, v12
    s_waitcnt vmcnt(23)
    buffer_load_dwordx4 v[80:83], v4, s[36:39], s44 offen offset:0 nt
    v_dot2_f32_bf16 v13, v84, v20, v13
    v_dot2_f32_bf16 v14, v85, v21, v14
    v_dot2_f32_bf16 v13, v86, v22, v13
    v_dot2_f32_bf16 v14, v87, v23, v14
    v_max_f32 v8, v8, v10
    ds_write_b32 v6, v10 offset:1440
    v_add_f32_dpp v9, v11, v11 row_half_mirror row_mask:0xf bank_mask:0x5
    s_waitcnt vmcnt(23)
    buffer_load_dwordx4 v[84:87], v4, s[36:39], s44 offen offset:128 nt
    v_dot2_f32_bf16 v13, v88, v24, v13
    v_dot2_f32_bf16 v14, v89, v25, v14
    v_dot2_f32_bf16 v13, v90, v26, v13
    v_dot2_f32_bf16 v14, v91, v27, v14
    s_waitcnt vmcnt(23)
    buffer_load_dwordx4 v[88:91], v4, s[36:39], s44 offen offset:256 nt
    v_dot2_f32_bf16 v13, v92, v28, v13
    v_dot2_f32_bf16 v14, v93, v29, v14
    v_dot2_f32_bf16 v13, v94, v30, v13
    v_dot2_f32_bf16 v14, v95, v31, v14
    s_waitcnt vmcnt(23)
    buffer_load_dwordx4 v[92:95], v4, s[36:39], s44 offen offset:384 nt
    s_add_u32 s44, s44, 4096
    s_and_b32 s44, s44, 0xfffff
    v_dot2_f32_bf16 v11, v96, v16, 0
    v_dot2_f32_bf16 v12, v97, v17, 0
    v_dot2_f32_bf16 v11, v98, v18, v11
    v_dot2_f32_bf16 v12, v99, v19, v12
    v_add_f32 v13, v13, v14
    s_waitcnt vmcnt(23)
    buffer_load_dwordx4 v[96:99], v4, s[36:39], s44 offen offset:0 nt
    v_dot2_f32_bf16 v11, v100, v20, v11
    v_dot2_f32_bf16 v12, v101, v21, v12
    v_dot2_f32_bf16 v11, v102, v22, v11
    v_dot2_f32_bf16 v12, v103, v23, v12
    v_add_f32_dpp v9, v13, v13 row_half_mirror row_mask:0xf bank_mask:0xa
    s_waitcnt vmcnt(23)
    buffer_load_dwordx4 v[100:103], v4, s[36:39], s44 offen offset:128 nt
    v_dot2_f32_bf16 v11, v104, v24, v11
    v_dot2_f32_bf16 v12, v105, v25, v12
    v_dot2_f32_bf16 v11, v106, v26, v11
    v_dot2_f32_bf16 v12, v107, v27, v12
    v_add_f32_dpp v9, v9, v9 quad_perm:[1,0,3,2] row_mask:0xf bank_mask:0xf
    s_waitcnt vmcnt(23)
    buffer_load_dwordx4 v[104:107], v4, s[36:39], s44 offen offset:256 nt
    v_dot2_f32_bf16 v11, v108, v28, v11
    v_dot2_f32_bf16 v12, v109, v29, v12
    v_dot2_f32_bf16 v11, v110, v30, v11
    v_dot2_f32_bf16 v12, v111, v31, v12
    v_add_f32_dpp v9, v9, v9 quad_perm:[2,3,0,1] row_mask:0xf bank_mask:0xf
    s_waitcnt vmcnt(23)
    buffer_load_dwordx4 v[108:111], v4, s[36:39], s44 offen offset:384 nt
    s_add_u32 s44, s44, 4096
    s_and_b32 s44, s44, 0xfffff
    v_dot2_f32_bf16 v13, v112, v16, 0
    v_dot2_f32_bf16 v14, v113, v17, 0
    v_dot2_f32_bf16 v13, v114, v18, v13
    v_dot2_f32_bf16 v14, v115, v19, v14
    v_cvt_pk_bf16_f32 v10, 0, v9
    v_add_f32 v11, v11, v12
    s_waitcnt vmcnt(23)
    buffer_load_dwordx4 v[112:115], v4, s[36:39], s44 offen offset:0 nt
    v_dot2_f32_bf16 v13, v116, v20, v13
    v_dot2_f32_bf16 v14, v117, v21, v14
    v_dot2_f32_bf16 v13, v118, v22, v13
    v_dot2_f32_bf16 v14, v119, v23, v14
    v_max_f32 v8, v8, v10
    ds_write_b32 v6, v10 offset:1472
    v_add_f32_dpp v9, v11, v11 row_half_mirror row_mask:0xf bank_mask:0x5
    s_waitcnt vmcnt(23)
    buffer_load_dwordx4 v[116:119], v4, s[36:39], s44 offen offset:128 nt
    v_dot2_f32_bf16 v13, v120, v24, v13
    v_dot2_f32_bf16 v14, v121, v25, v14
    v_dot2_f32_bf16 v13, v122, v26, v13
    v_dot2_f32_bf16 v14, v123, v27, v14
    s_waitcnt vmcnt(23)
    buffer_load_dwordx4 v[120:123], v4, s[36:39], s44 offen offset:256 nt
    v_dot2_f32_bf16 v13, v124, v28, v13
    v_dot2_f32_bf16 v14, v125, v29, v14
    v_dot2_f32_bf16 v13, v126, v30, v13
    v_dot2_f32_bf16 v14, v127, v31, v14
    s_waitcnt vmcnt(23)
    buffer_load_dwordx4 v[124:127], v4, s[36:39], s44 offen offset:384 nt
    s_add_u32 s44, s44, 4096
    s_and_b32 s44, s44, 0xfffff
    v_dot2_f32_bf16 v11, v128, v16, 0
    v_dot2_f32_bf16 v12, v129, v17, 0
    v_dot2_f32_bf16 v11, v130, v18, v11
    v_dot2_f32_bf16 v12, v131, v19, v12
    v_add_f32 v13, v13, v14
    s_waitcnt vmcnt(23)
    buffer_load_dwordx4 v[128:131], v4, s[36:39], s44 offen offset:0 nt
    v_dot2_f32_bf16 v11, v132, v20, v11
    v_dot2_f32_bf16 v12, v133, v21, v12
    v_dot2_f32_bf16 v11, v134, v22, v11
    v_dot2_f32_bf16 v12, v135, v23, v12
    v_add_f32_dpp v9, v13, v13 row_half_mirror row_mask:0xf bank_mask:0xa
    s_waitcnt vmcnt(23)
    buffer_load_dwordx4 v[132:135], v4, s[36:39], s44 offen offset:128 nt
    v_dot2_f32_bf16 v11, v136, v24, v11
    v_dot2_f32_bf16 v12, v137, v25, v12
    v_dot2_f32_bf16 v11, v138, v26, v11
    v_dot2_f32_bf16 v12, v139, v27, v12
    v_add_f32_dpp v9, v9, v9 quad_perm:[1,0,3,2] row_mask:0xf bank_mask:0xf
    s_waitcnt vmcnt(23)
    buffer_load_dwordx4 v[136:139], v4, s[36:39], s44 offen offset:256 nt
    v_dot2_f32_bf16 v11, v140, v28, v11
    v_dot2_f32_bf16 v12, v141, v29, v12
    v_dot2_f32_bf16 v11, v142, v30, v11
    v_dot2_f32_bf16 v12, v143, v31, v12
    v_add_f32_dpp v9, v9, v9 quad_perm:[2,3,0,1] row_mask:0xf bank_mask:0xf
    s_waitcnt vmcnt(23)
    buffer_load_dwordx4 v[140:143], v4, s[36:39], s44 offen offset:384 nt
    s_add_u32 s44, s44, 4096
    s_and_b32 s44, s44, 0xfffff
    v_dot2_f32_bf16 v13, v144, v16, 0
    v_dot2_f32_bf16 v14, v145, v17, 0
    v_dot2_f32_bf16 v13, v146, v18, v13
    v_dot2_f32_bf16 v14, v147, v19, v14
    v_cvt_pk_bf16_f32 v10, 0, v9
    v_add_f32 v11, v11, v12
    s_waitcnt vmcnt(23)
    buffer_load_dwordx4 v[144:147], v4, s[36:39], s44 offen offset:0 nt
    v_dot2_f32_bf16 v13, v148, v20, v13
    v_dot2_f32_bf16 v14, v149, v21, v14
    v_dot2_f32_bf16 v13, v150, v22, v13
    v_dot2_f32_bf16 v14, v151, v23, v14
    v_max_f32 v8, v8, v10
    ds_write_b32 v6, v10 offset:1480
    v_add_f32_dpp v9, v11, v11 row_half_mirror row_mask:0xf bank_mask:0x5
    s_waitcnt vmcnt(23)
    buffer_load_dwordx4 v[148:151], v4, s[36:39], s44 offen offset:128 nt
    v_dot2_f32_bf16 v13, v152, v24, v13
    v_dot2_f32_bf16 v14, v153, v25, v14
    v_dot2_f32_bf16 v13, v154, v26, v13
    v_dot2_f32_bf16 v14, v155, v27, v14
    s_waitcnt vmcnt(23)
    buffer_load_dwordx4 v[152:155], v4, s[36:39], s44 offen offset:256 nt
    v_dot2_f32_bf16 v13, v156, v28, v13
    v_dot2_f32_bf16 v14, v157, v29, v14
    v_dot2_f32_bf16 v13, v158, v30, v13
    v_dot2_f32_bf16 v14, v159, v31, v14
    s_waitcnt vmcnt(23)
    buffer_load_dwordx4 v[156:159], v4, s[36:39], s44 offen offset:384 nt
    s_add_u32 s44, s44, 4096
    s_and_b32 s44, s44, 0xfffff
    v_dot2_f32_bf16 v11, v160, v16, 0
    v_dot2_f32_bf16 v12, v161, v17, 0
    v_dot2_f32_bf16 v11, v162, v18, v11
    v_dot2_f32_bf16 v12, v163, v19, v12
    v_add_f32 v13, v13, v14
    s_waitcnt vmcnt(23)
    buffer_load_dwordx4 v[160:163], v4, s[36:39], s44 offen offset:0 nt
    v_dot2_f32_bf16 v11, v164, v20, v11
    v_dot2_f32_bf16 v12, v165, v21, v12
    v_dot2_f32_bf16 v11, v166, v22, v11
    v_dot2_f32_bf16 v12, v167, v23, v12
    v_add_f32_dpp v9, v13, v13 row_half_mirror row_mask:0xf bank_mask:0xa
    s_waitcnt vmcnt(23)
    buffer_load_dwordx4 v[164:167], v4, s[36:39], s44 offen offset:128 nt
    v_dot2_f32_bf16 v11, v168, v24, v11
    v_dot2_f32_bf16 v12, v169, v25, v12
    v_dot2_f32_bf16 v11, v170, v26, v11
    v_dot2_f32_bf16 v12, v171, v27, v12
    v_add_f32_dpp v9, v9, v9 quad_perm:[1,0,3,2] row_mask:0xf bank_mask:0xf
    s_waitcnt vmcnt(23)
    buffer_load_dwordx4 v[168:171], v4, s[36:39], s44 offen offset:256 nt
    v_dot2_f32_bf16 v11, v172, v28, v11
    v_dot2_f32_bf16 v12, v173, v29, v12
    v_dot2_f32_bf16 v11, v174, v30, v11
    v_dot2_f32_bf16 v12, v175, v31, v12
    v_add_f32_dpp v9, v9, v9 quad_perm:[2,3,0,1] row_mask:0xf bank_mask:0xf
    s_waitcnt vmcnt(23)
    buffer_load_dwordx4 v[172:175], v4, s[36:39], s44 offen offset:384 nt
    s_add_u32 s44, s44, 4096
    s_and_b32 s44, s44, 0xfffff
    v_dot2_f32_bf16 v13, v176, v16, 0
    v_dot2_f32_bf16 v14, v177, v17, 0
    v_dot2_f32_bf16 v13, v178, v18, v13
    v_dot2_f32_bf16 v14, v179, v19, v14
    v_cvt_pk_bf16_f32 v10, 0, v9
    v_add_f32 v11, v11, v12
    s_waitcnt vmcnt(23)
    buffer_load_dwordx4 v[176:179], v4, s[36:39], s44 offen offset:0 nt
    v_dot2_f32_bf16 v13, v180, v20, v13
    v_dot2_f32_bf16 v14, v181, v21, v14
    v_dot2_f32_bf16 v13, v182, v22, v13
    v_dot2_f32_bf16 v14, v183, v23, v14
    v_max_f32 v8, v8, v10
    ds_write_b32 v6, v10 offset:1488
    v_add_f32_dpp v9, v11, v11 row_half_mirror row_mask:0xf bank_mask:0x5
    s_waitcnt vmcnt(23)
    buffer_load_dwordx4 v[180:183], v4, s[36:39], s44 offen offset:128 nt
    v_dot2_f32_bf16 v13, v184, v24, v13
    v_dot2_f32_bf16 v14, v185, v25, v14
    v_dot2_f32_bf16 v13, v186, v26, v13
    v_dot2_f32_bf16 v14, v187, v27, v14
    s_waitcnt vmcnt(23)
    buffer_load_dwordx4 v[184:187], v4, s[36:39], s44 offen offset:256 nt
    v_dot2_f32_bf16 v13, v188, v28, v13
    v_dot2_f32_bf16 v14, v189, v29, v14
    v_dot2_f32_bf16 v13, v190, v30, v13
    v_dot2_f32_bf16 v14, v191, v31, v14
    s_waitcnt vmcnt(23)
    buffer_load_dwordx4 v[188:191], v4, s[36:39], s44 offen offset:384 nt
    s_add_u32 s44, s44, 4096
    s_and_b32 s44, s44, 0xfffff
    v_dot2_f32_bf16 v11, v192, v16, 0
    v_dot2_f32_bf16 v12, v193, v17, 0
    v_dot2_f32_bf16 v11, v194, v18, v11
    v_dot2_f32_bf16 v12, v195, v19, v12
    v_add_f32 v13, v13, v14
    s_waitcnt vmcnt(23)
    buffer_load_dwordx4 v[192:195], v4, s[36:39], s44 offen offset:0 nt
    v_dot2_f32_bf16 v11, v196, v20, v11
    v_dot2_f32_bf16 v12, v197, v21, v12
    v_dot2_f32_bf16 v11, v198, v22, v11
    v_dot2_f32_bf16 v12, v199, v23, v12
    v_add_f32_dpp v9, v13, v13 row_half_mirror row_mask:0xf bank_mask:0xa
    s_waitcnt vmcnt(23)
    buffer_load_dwordx4 v[196:199], v4, s[36:39], s44 offen offset:128 nt
    v_dot2_f32_bf16 v11, v200, v24, v11
    v_dot2_f32_bf16 v12, v201, v25, v12
    v_dot2_f32_bf16 v11, v202, v26, v11
    v_dot2_f32_bf16 v12, v203, v27, v12
    v_add_f32_dpp v9, v9, v9 quad_perm:[1,0,3,2] row_mask:0xf bank_mask:0xf
    s_waitcnt vmcnt(23)
    buffer_load_dwordx4 v[200:203], v4, s[36:39], s44 offen offset:256 nt
    v_dot2_f32_bf16 v11, v204, v28, v11
    v_dot2_f32_bf16 v12, v205, v29, v12
    v_dot2_f32_bf16 v11, v206, v30, v11
    v_dot2_f32_bf16 v12, v207, v31, v12
    v_add_f32_dpp v9, v9, v9 quad_perm:[2,3,0,1] row_mask:0xf bank_mask:0xf
    s_waitcnt vmcnt(23)
    buffer_load_dwordx4 v[204:207], v4, s[36:39], s44 offen offset:384 nt
    s_add_u32 s44, s44, 4096
    s_and_b32 s44, s44, 0xfffff
    v_dot2_f32_bf16 v13, v208, v16, 0
    v_dot2_f32_bf16 v14, v209, v17, 0
    v_dot2_f32_bf16 v13, v210, v18, v13
    v_dot2_f32_bf16 v14, v211, v19, v14
    v_cvt_pk_bf16_f32 v10, 0, v9
    v_add_f32 v11, v11, v12
    s_waitcnt vmcnt(23)
    buffer_load_dwordx4 v[208:211], v4, s[36:39], s44 offen offset:0 nt
    v_dot2_f32_bf16 v13, v212, v20, v13
    v_dot2_f32_bf16 v14, v213, v21, v14
    v_dot2_f32_bf16 v13, v214, v22, v13
    v_dot2_f32_bf16 v14, v215, v23, v14
    v_max_f32 v8, v8, v10
    ds_write_b32 v6, v10 offset:1496
    v_add_f32_dpp v9, v11, v11 row_half_mirror row_mask:0xf bank_mask:0x5
    s_waitcnt vmcnt(23)
    buffer_load_dwordx4 v[212:215], v4, s[36:39], s44 offen offset:128 nt
    v_dot2_f32_bf16 v13, v216, v24, v13
    v_dot2_f32_bf16 v14, v217, v25, v14
    v_dot2_f32_bf16 v13, v218, v26, v13
    v_dot2_f32_bf16 v14, v219, v27, v14
    s_waitcnt vmcnt(23)
    buffer_load_dwordx4 v[216:219], v4, s[36:39], s44 offen offset:256 nt
    v_dot2_f32_bf16 v13, v220, v28, v13
    v_dot2_f32_bf16 v14, v221, v29, v14
    v_dot2_f32_bf16 v13, v222, v30, v13
    v_dot2_f32_bf16 v14, v223, v31, v14
    s_waitcnt vmcnt(23)
    buffer_load_dwordx4 v[220:223], v4, s[36:39], s44 offen offset:384 nt
    s_add_u32 s44, s44, 4096
    s_and_b32 s44, s44, 0xfffff
    v_dot2_f32_bf16 v11, v224, v16, 0
    v_dot2_f32_bf16 v12, v225, v17, 0
    v_dot2_f32_bf16 v11, v226, v18, v11
    v_dot2_f32_bf16 v12, v227, v19, v12
    v_add_f32 v13, v13, v14
    s_waitcnt vmcnt(23)
    buffer_load_dwordx4 v[224:227], v4, s[36:39], s44 offen offset:0 nt
    v_dot2_f32_bf16 v11, v228, v20, v11
    v_dot2_f32_bf16 v12, v229, v21, v12
    v_dot2_f32_bf16 v11, v230, v22, v11
    v_dot2_f32_bf16 v12, v231, v23, v12
    v_add_f32_dpp v9, v13, v13 row_half_mirror row_mask:0xf bank_mask:0xa
    s_waitcnt vmcnt(23)
    buffer_load_dwordx4 v[228:231], v4, s[36:39], s44 offen offset:128 nt
    v_dot2_f32_bf16 v11, v232, v24, v11
    v_dot2_f32_bf16 v12, v233, v25, v12
    v_dot2_f32_bf16 v11, v234, v26, v11
    v_dot2_f32_bf16 v12, v235, v27, v12
    v_add_f32_dpp v9, v9, v9 quad_perm:[1,0,3,2] row_mask:0xf bank_mask:0xf
    s_waitcnt vmcnt(23)
    buffer_load_dwordx4 v[232:235], v4, s[36:39], s44 offen offset:256 nt
    v_dot2_f32_bf16 v11, v236, v28, v11
    v_dot2_f32_bf16 v12, v237, v29, v12
    v_dot2_f32_bf16 v11, v238, v30, v11
    v_dot2_f32_bf16 v12, v239, v31, v12
    v_add_f32_dpp v9, v9, v9 quad_perm:[2,3,0,1] row_mask:0xf bank_mask:0xf
    s_waitcnt vmcnt(23)
    buffer_load_dwordx4 v[236:239], v4, s[36:39], s44 offen offset:384 nt
    s_add_u32 s44, s44, 4096
    s_and_b32 s44, s44, 0xfffff
    v_dot2_f32_bf16 v13, v240, v16, 0
    v_dot2_f32_bf16 v14, v241, v17, 0
    v_dot2_f32_bf16 v13, v242, v18, v13
    v_dot2_f32_bf16 v14, v243, v19, v14
    v_cvt_pk_bf16_f32 v10, 0, v9
    v_add_f32 v11, v11, v12
    s_waitcnt vmcnt(23)
    buffer_load_dwordx4 v[240:243], v4, s[36:39], s44 offen offset:0 nt
    v_dot2_f32_bf16 v13, v244, v20, v13
    v_dot2_f32_bf16 v14, v245, v21, v14
    v_dot2_f32_bf16 v13, v246, v22, v13
    v_dot2_f32_bf16 v14, v247, v23, v14
    v_max_f32 v8, v8, v10
    ds_write_b32 v6, v10 offset:1504
    v_add_f32_dpp v9, v11, v11 row_half_mirror row_mask:0xf bank_mask:0x5
    s_waitcnt vmcnt(23)
    buffer_load_dwordx4 v[244:247], v4, s[36:39], s44 offen offset:128 nt
    v_dot2_f32_bf16 v13, v248, v24, v13
    v_dot2_f32_bf16 v14, v249, v25, v14
    v_dot2_f32_bf16 v13, v250, v26, v13
    v_dot2_f32_bf16 v14, v251, v27, v14
    s_waitcnt vmcnt(23)
    buffer_load_dwordx4 v[248:251], v4, s[36:39], s44 offen offset:256 nt
    v_dot2_f32_bf16 v13, v252, v28, v13
    v_dot2_f32_bf16 v14, v253, v29, v14
    v_dot2_f32_bf16 v13, v254, v30, v13
    v_dot2_f32_bf16 v14, v255, v31, v14
    s_mov_b32 s46, 15
L_kloop1:
    s_waitcnt vmcnt(23)
    buffer_load_dwordx4 v[252:255], v4, s[36:39], s44 offen offset:384 nt
    s_add_u32 s44, s44, 4096
    s_and_b32 s44, s44, 0xfffff
    v_dot2_f32_bf16 v11, v64, v16, 0
    v_dot2_f32_bf16 v12, v65, v17, 0
    v_dot2_f32_bf16 v11, v66, v18, v11
    v_dot2_f32_bf16 v12, v67, v19, v12
    v_add_f32 v13, v13, v14
    s_waitcnt vmcnt(23)
    buffer_load_dwordx4 v[64:67], v4, s[36:39], s44 offen offset:0 nt
    v_dot2_f32_bf16 v11, v68, v20, v11
    v_dot2_f32_bf16 v12, v69, v21, v12
    v_dot2_f32_bf16 v11, v70, v22, v11
    v_dot2_f32_bf16 v12, v71, v23, v12
    v_add_f32_dpp v9, v13, v13 row_half_mirror row_mask:0xf bank_mask:0xa
    s_waitcnt vmcnt(23)
    buffer_load_dwordx4 v[68:71], v4, s[36:39], s44 offen offset:128 nt
    v_dot2_f32_bf16 v11, v72, v24, v11
    v_dot2_f32_bf16 v12, v73, v25, v12
    v_dot2_f32_bf16 v11, v74, v26, v11
    v_dot2_f32_bf16 v12, v75, v27, v12
    v_add_f32_dpp v9, v9, v9 quad_perm:[1,0,3,2] row_mask:0xf bank_mask:0xf
    s_waitcnt vmcnt(23)
    buffer_load_dwordx4 v[72:75], v4, s[36:39], s44 offen offset:256 nt
    v_dot2_f32_bf16 v11, v76, v28, v11
    v_dot2_f32_bf16 v12, v77, v29, v12
    v_dot2_f32_bf16 v11, v78, v30, v11
    v_dot2_f32_bf16 v12, v79, v31, v12
    v_add_f32_dpp v9, v9, v9 quad_perm:[2,3,0,1] row_mask:0xf bank_mask:0xf
    s_waitcnt vmcnt(23)
    buffer_load_dwordx4 v[76:79], v4, s[36:39], s44 offen offset:384 nt
    s_add_u32 s44, s44, 4096
    s_and_b32 s44, s44, 0xfffff
    v_dot2_f32_bf16 v13, v80, v16, 0
    v_dot2_f32_bf16 v14, v81, v17, 0
    v_dot2_f32_bf16 v13, v82, v18, v13
    v_dot2_f32_bf16 v14, v83, v19, v14
    v_cvt_pk_bf16_f32 v10, 0, v9
    v_add_f32 v11, v11, v12
    s_waitcnt vmcnt(23)
    buffer_load_dwordx4 v[80:83], v4, s[36:39], s44 offen offset:0 nt
    v_dot2_f32_bf16 v13, v84, v20, v13
    v_dot2_f32_bf16 v14, v85, v21, v14
    v_dot2_f32_bf16 v13, v86, v22, v13
    v_dot2_f32_bf16 v14, v87, v23, v14
    v_max_f32 v8, v8, v10
    ds_write_b32 v6, v10 offset:1512
    v_add_f32_dpp v9, v11, v11 row_half_mirror row_mask:0xf bank_mask:0x5
    s_waitcnt vmcnt(23)
    buffer_load_dwordx4 v[84:87], v4, s[36:39], s44 offen offset:128 nt
    v_dot2_f32_bf16 v13, v88, v24, v13
    v_dot2_f32_bf16 v14, v89, v25, v14
    v_dot2_f32_bf16 v13, v90, v26, v13
    v_dot2_f32_bf16 v14, v91, v27, v14
    s_waitcnt vmcnt(23)
    buffer_load_dwordx4 v[88:91], v4, s[36:39], s44 offen offset:256 nt
    v_dot2_f32_bf16 v13, v92, v28, v13
    v_dot2_f32_bf16 v14, v93, v29, v14
    v_dot2_f32_bf16 v13, v94, v30, v13
    v_dot2_f32_bf16 v14, v95, v31, v14
    s_waitcnt vmcnt(23)
    buffer_load_dwordx4 v[92:95], v4, s[36:39], s44 offen offset:384 nt
    s_add_u32 s44, s44, 4096
    s_and_b32 s44, s44, 0xfffff
    v_dot2_f32_bf16 v11, v96, v16, 0
    v_dot2_f32_bf16 v12, v97, v17, 0
    v_dot2_f32_bf16 v11, v98, v18, v11
    v_dot2_f32_bf16 v12, v99, v19, v12
    v_add_f32 v13, v13, v14
    s_waitcnt vmcnt(23)
    buffer_load_dwordx4 v[96:99], v4, s[36:39], s44 offen offset:0 nt
    v_dot2_f32_bf16 v11, v100, v20, v11
    v_dot2_f32_bf16 v12, v101, v21, v12
    v_dot2_f32_bf16 v11, v102, v22, v11
    v_dot2_f32_bf16 v12, v103, v23, v12
    v_add_f32_dpp v9, v13, v13 row_half_mirror row_mask:0xf bank_mask:0xa
    s_waitcnt vmcnt(23)
    buffer_load_dwordx4 v[100:103], v4, s[36:39], s44 offen offset:128 nt
    v_dot2_f32_bf16 v11, v104, v24, v11
    v_dot2_f32_bf16 v12, v105, v25, v12
    v_dot2_f32_bf16 v11, v106, v26, v11
    v_dot2_f32_bf16 v12, v107, v27, v12
    v_add_f32_dpp v9, v9, v9 quad_perm:[1,0,3,2] row_mask:0xf bank_mask:0xf
    s_waitcnt vmcnt(23)
    buffer_load_dwordx4 v[104:107], v4, s[36:39], s44 offen offset:256 nt
    v_dot2_f32_bf16 v11, v108, v28, v11
    v_dot2_f32_bf16 v12, v109, v29, v12
    v_dot2_f32_bf16 v11, v110, v30, v11
    v_dot2_f32_bf16 v12, v111, v31, v12
    v_add_f32_dpp v9, v9, v9 quad_perm:[2,3,0,1] row_mask:0xf bank_mask:0xf
    s_waitcnt vmcnt(23)
    buffer_load_dwordx4 v[108:111], v4, s[36:39], s44 offen offset:384 nt
    s_add_u32 s44, s44, 4096
    s_and_b32 s44, s44, 0xfffff
    v_dot2_f32_bf16 v13, v112, v16, 0
    v_dot2_f32_bf16 v14, v113, v17, 0
    v_dot2_f32_bf16 v13, v114, v18, v13
    v_dot2_f32_bf16 v14, v115, v19, v14
    v_cvt_pk_bf16_f32 v10, 0, v9
    v_add_f32 v11, v11, v12
    s_waitcnt vmcnt(23)
    buffer_load_dwordx4 v[112:115], v4, s[36:39], s44 offen offset:0 nt
    v_dot2_f32_bf16 v13, v116, v20, v13
    v_dot2_f32_bf16 v14, v117, v21, v14
    v_dot2_f32_bf16 v13, v118, v22, v13
    v_dot2_f32_bf16 v14, v119, v23, v14
    v_max_f32 v8, v8, v10
    ds_write_b32 v6, v10 offset:1520
    v_add_f32_dpp v9, v11, v11 row_half_mirror row_mask:0xf bank_mask:0x5
    s_waitcnt vmcnt(23)
    buffer_load_dwordx4 v[116:119], v4, s[36:39], s44 offen offset:128 nt
    v_dot2_f32_bf16 v13, v120, v24, v13
    v_dot2_f32_bf16 v14, v121, v25, v14
    v_dot2_f32_bf16 v13, v122, v26, v13
    v_dot2_f32_bf16 v14, v123, v27, v14
    s_waitcnt vmcnt(23)
    buffer_load_dwordx4 v[120:123], v4, s[36:39], s44 offen offset:256 nt
    v_dot2_f32_bf16 v13, v124, v28, v13
    v_dot2_f32_bf16 v14, v125, v29, v14
    v_dot2_f32_bf16 v13, v126, v30, v13
    v_dot2_f32_bf16 v14, v127, v31, v14
    s_waitcnt vmcnt(23)
    buffer_load_dwordx4 v[124:127], v4, s[36:39], s44 offen offset:384 nt
    s_add_u32 s44, s44, 4096
    s_and_b32 s44, s44, 0xfffff
    v_dot2_f32_bf16 v11, v128, v16, 0
    v_dot2_f32_bf16 v12, v129, v17, 0
    v_dot2_f32_bf16 v11, v130, v18, v11
    v_dot2_f32_bf16 v12, v131, v19, v12
    v_add_f32 v13, v13, v14
    s_waitcnt vmcnt(23)
    buffer_load_dwordx4 v[128:131], v4, s[36:39], s44 offen offset:0 nt
    v_dot2_f32_bf16 v11, v132, v20, v11
    v_dot2_f32_bf16 v12, v133, v21, v12
    v_dot2_f32_bf16 v11, v134, v22, v11
    v_dot2_f32_bf16 v12, v135, v23, v12
    v_add_f32_dpp v9, v13, v13 row_half_mirror row_mask:0xf bank_mask:0xa
    s_waitcnt vmcnt(23)
    buffer_load_dwordx4 v[132:135], v4, s[36:39], s44 offen offset:128 nt
    v_dot2_f32_bf16 v11, v136, v24, v11
    v_dot2_f32_bf16 v12, v137, v25, v12
    v_dot2_f32_bf16 v11, v138, v26, v11
    v_dot2_f32_bf16 v12, v139, v27, v12
    v_add_f32_dpp v9, v9, v9 quad_perm:[1,0,3,2] row_mask:0xf bank_mask:0xf
    s_waitcnt vmcnt(23)
    buffer_load_dwordx4 v[136:139], v4, s[36:39], s44 offen offset:256 nt
    v_dot2_f32_bf16 v11, v140, v28, v11
    v_dot2_f32_bf16 v12, v141, v29, v12
    v_dot2_f32_bf16 v11, v142, v30, v11
    v_dot2_f32_bf16 v12, v143, v31, v12
    v_add_f32_dpp v9, v9, v9 quad_perm:[2,3,0,1] row_mask:0xf bank_mask:0xf
    s_waitcnt vmcnt(23)
    buffer_load_dwordx4 v[140:143], v4, s[36:39], s44 offen offset:384 nt
    s_add_u32 s44, s44, 4096
    s_and_b32 s44, s44, 0xfffff
    v_dot2_f32_bf16 v13, v144, v16, 0
    v_dot2_f32_bf16 v14, v145, v17, 0
    v_dot2_f32_bf16 v13, v146, v18, v13
    v_dot2_f32_bf16 v14, v147, v19, v14
    v_cvt_pk_bf16_f32 v10, 0, v9
    v_add_f32 v11, v11, v12
    s_waitcnt vmcnt(23)
    buffer_load_dwordx4 v[144:147], v4, s[36:39], s44 offen offset:0 nt
    v_dot2_f32_bf16 v13, v148, v20, v13
    v_dot2_f32_bf16 v14, v149, v21, v14
    v_dot2_f32_bf16 v13, v150, v22, v13
    v_dot2_f32_bf16 v14, v151, v23, v14
    v_max_f32 v8, v8, v10
    ds_write_b32 v6, v10 offset:1528
    v_add_f32_dpp v9, v11, v11 row_half_mirror row_mask:0xf bank_mask:0x5
    s_waitcnt vmcnt(23)
    buffer_load_dwordx4 v[148:151], v4, s[36:39], s44 offen offset:128 nt
    v_dot2_f32_bf16 v13, v152, v24, v13
    v_dot2_f32_bf16 v14, v153, v25, v14
    v_dot2_f32_bf16 v13, v154, v26, v13
    v_dot2_f32_bf16 v14, v155, v27, v14
    s_waitcnt vmcnt(23)
    buffer_load_dwordx4 v[152:155], v4, s[36:39], s44 offen offset:256 nt
    v_dot2_f32_bf16 v13, v156, v28, v13
    v_dot2_f32_bf16 v14, v157, v29, v14
    v_dot2_f32_bf16 v13, v158, v30, v13
    v_dot2_f32_bf16 v14, v159, v31, v14
    s_waitcnt vmcnt(23)
    buffer_load_dwordx4 v[156:159], v4, s[36:39], s44 offen offset:384 nt
    s_add_u32 s44, s44, 4096
    s_and_b32 s44, s44, 0xfffff
    v_dot2_f32_bf16 v11, v160, v16, 0
    v_dot2_f32_bf16 v12, v161, v17, 0
    v_dot2_f32_bf16 v11, v162, v18, v11
    v_dot2_f32_bf16 v12, v163, v19, v12
    v_add_f32 v13, v13, v14
    s_waitcnt vmcnt(23)
    buffer_load_dwordx4 v[160:163], v4, s[36:39], s44 offen offset:0 nt
    v_dot2_f32_bf16 v11, v164, v20, v11
    v_dot2_f32_bf16 v12, v165, v21, v12
    v_dot2_f32_bf16 v11, v166, v22, v11
    v_dot2_f32_bf16 v12, v167, v23, v12
    v_add_f32_dpp v9, v13, v13 row_half_mirror row_mask:0xf bank_mask:0xa
    s_waitcnt vmcnt(23)
    buffer_load_dwordx4 v[164:167], v4, s[36:39], s44 offen offset:128 nt
    v_dot2_f32_bf16 v11, v168, v24, v11
    v_dot2_f32_bf16 v12, v169, v25, v12
    v_dot2_f32_bf16 v11, v170, v26, v11
    v_dot2_f32_bf16 v12, v171, v27, v12
    v_add_f32_dpp v9, v9, v9 quad_perm:[1,0,3,2] row_mask:0xf bank_mask:0xf
    s_waitcnt vmcnt(23)
    buffer_load_dwordx4 v[168:171], v4, s[36:39], s44 offen offset:256 nt
    v_dot2_f32_bf16 v11, v172, v28, v11
    v_dot2_f32_bf16 v12, v173, v29, v12
    v_dot2_f32_bf16 v11, v174, v30, v11
    v_dot2_f32_bf16 v12, v175, v31, v12
    v_add_f32_dpp v9, v9, v9 quad_perm:[2,3,0,1] row_mask:0xf bank_mask:0xf
    s_waitcnt vmcnt(23)
    buffer_load_dwordx4 v[172:175], v4, s[36:39], s44 offen offset:384 nt
    s_add_u32 s44, s44, 4096
    s_and_b32 s44, s44, 0xfffff
    v_dot2_f32_bf16 v13, v176, v16, 0
    v_dot2_f32_bf16 v14, v177, v17, 0
    v_dot2_f32_bf16 v13, v178, v18, v13
    v_dot2_f32_bf16 v14, v179, v19, v14
    v_cvt_pk_bf16_f32 v10, 0, v9
    v_add_f32 v11, v11, v12
    ds_read_b32 v37, v36 offset:588
    s_waitcnt vmcnt(23)
    buffer_load_dwordx4 v[176:179], v4, s[36:39], s44 offen offset:0 nt
    v_dot2_f32_bf16 v13, v180, v20, v13
    v_dot2_f32_bf16 v14, v181, v21, v14
    v_dot2_f32_bf16 v13, v182, v22, v13
    v_dot2_f32_bf16 v14, v183, v23, v14
    v_max_f32 v8, v8, v10
    ds_write_b32 v6, v10 offset:1536
    v_add_f32_dpp v9, v11, v11 row_half_mirror row_mask:0xf bank_mask:0x5
    s_waitcnt vmcnt(23)
    buffer_load_dwordx4 v[180:183], v4, s[36:39], s44 offen offset:128 nt
    v_dot2_f32_bf16 v13, v184, v24, v13
    v_dot2_f32_bf16 v14, v185, v25, v14
    v_dot2_f32_bf16 v13, v186, v26, v13
    v_dot2_f32_bf16 v14, v187, v27, v14
    s_waitcnt vmcnt(23)
    buffer_load_dwordx4 v[184:187], v4, s[36:39], s44 offen offset:256 nt
    v_dot2_f32_bf16 v13, v188, v28, v13
    v_dot2_f32_bf16 v14, v189, v29, v14
    v_dot2_f32_bf16 v13, v190, v30, v13
    v_dot2_f32_bf16 v14, v191, v31, v14
    s_waitcnt lgkmcnt(0)
    v_readfirstlane_b32 s48, v37
    s_cmp_eq_u32 s48, 0
    s_cbranch_scc1 L_kloopm0
    s_cmp_eq_u32 s48, 2
    s_cbranch_scc1 L_kloopm2
L_kloopm1:
    s_waitcnt vmcnt(23)
    buffer_load_dwordx4 v[188:191], v4, s[36:39], s44 offen offset:384 nt
    s_add_u32 s44, s44, 4096
    s_and_b32 s44, s44, 0xfffff
    v_dot2_f32_bf16 v11, v192, v16, 0
    v_dot2_f32_bf16 v12, v193, v17, 0
    v_dot2_f32_bf16 v11, v194, v18, v11
    v_dot2_f32_bf16 v12, v195, v19, v12
    v_add_f32 v13, v13, v14
    s_waitcnt vmcnt(23)
    buffer_load_dwordx4 v[192:195], v4, s[36:39], s44 offen offset:0 nt
    v_dot2_f32_bf16 v11, v196, v20, v11
    v_dot2_f32_bf16 v12, v197, v21, v12
    v_dot2_f32_bf16 v11, v198, v22, v11
    v_dot2_f32_bf16 v12, v199, v23, v12
    v_add_f32_dpp v9, v13, v13 row_half_mirror row_mask:0xf bank_mask:0xa
    s_waitcnt vmcnt(23)
    buffer_load_dwordx4 v[196:199], v4, s[36:39], s44 offen offset:128 nt
    v_dot2_f32_bf16 v11, v200, v24, v11
    v_dot2_f32_bf16 v12, v201, v25, v12
    v_dot2_f32_bf16 v11, v202, v26, v11
    v_dot2_f32_bf16 v12, v203, v27, v12
    v_add_f32_dpp v9, v9, v9 quad_perm:[1,0,3,2] row_mask:0xf bank_mask:0xf
    s_waitcnt vmcnt(23)
    buffer_load_dwordx4 v[200:203], v4, s[36:39], s44 offen offset:256 nt
    v_dot2_f32_bf16 v11, v204, v28, v11
    v_dot2_f32_bf16 v12, v205, v29, v12
    v_dot2_f32_bf16 v11, v206, v30, v11
    v_dot2_f32_bf16 v12, v207, v31, v12
    v_add_f32_dpp v9, v9, v9 quad_perm:[2,3,0,1] row_mask:0xf bank_mask:0xf
    s_waitcnt vmcnt(23)
    buffer_load_dwordx4 v[204:207], v4, s[36:39], s44 offen offset:384 nt
    s_add_u32 s44, s44, 4096
    s_and_b32 s44, s44, 0xfffff
    v_dot2_f32_bf16 v13, v208, v16, 0
    v_dot2_f32_bf16 v14, v209, v17, 0
    v_dot2_f32_bf16 v13, v210, v18, v13
    v_dot2_f32_bf16 v14, v211, v19, v14
    v_cvt_pk_bf16_f32 v10, 0, v9
    v_add_f32 v11, v11, v12
    s_waitcnt vmcnt(23)
    buffer_load_dwordx4 v[208:211], v4, s[36:39], s44 offen offset:0 nt
    v_dot2_f32_bf16 v13, v212, v20, v13
    v_dot2_f32_bf16 v14, v213, v21, v14
    v_dot2_f32_bf16 v13, v214, v22, v13
    v_dot2_f32_bf16 v14, v215, v23, v14
    v_max_f32 v8, v8, v10
    ds_write_b32 v6, v10 offset:1544
    v_add_f32_dpp v9, v11, v11 row_half_mirror row_mask:0xf bank_mask:0x5
    s_waitcnt vmcnt(23)
    buffer_load_dwordx4 v[212:215], v4, s[36:39], s44 offen offset:128 nt
    v_dot2_f32_bf16 v13, v216, v24, v13
    v_dot2_f32_bf16 v14, v217, v25, v14
    v_dot2_f32_bf16 v13, v218, v26, v13
    v_dot2_f32_bf16 v14, v219, v27, v14
    s_waitcnt vmcnt(23)
    buffer_load_dwordx4 v[216:219], v4, s[36:39], s44 offen offset:256 nt
    v_dot2_f32_bf16 v13, v220, v28, v13
    v_dot2_f32_bf16 v14, v221, v29, v14
    v_dot2_f32_bf16 v13, v222, v30, v13
    v_dot2_f32_bf16 v14, v223, v31, v14
    s_waitcnt vmcnt(23)
    buffer_load_dwordx4 v[220:223], v4, s[36:39], s44 offen offset:384 nt
    s_add_u32 s44, s44, 4096
    s_and_b32 s44, s44, 0xfffff
    v_dot2_f32_bf16 v11, v224, v16, 0
    v_dot2_f32_bf16 v12, v225, v17, 0
    v_dot2_f32_bf16 v11, v226, v18, v11
    v_dot2_f32_bf16 v12, v227, v19, v12
    v_add_f32 v13, v13, v14
    s_waitcnt vmcnt(23)
    buffer_load_dwordx4 v[224:227], v4, s[36:39], s44 offen offset:0 nt
    v_dot2_f32_bf16 v11, v228, v20, v11
    v_dot2_f32_bf16 v12, v229, v21, v12
    v_dot2_f32_bf16 v11, v230, v22, v11
    v_dot2_f32_bf16 v12, v231, v23, v12
    v_add_f32_dpp v9, v13, v13 row_half_mirror row_mask:0xf bank_mask:0xa
    s_waitcnt vmcnt(23)
    buffer_load_dwordx4 v[228:231], v4, s[36:39], s44 offen offset:128 nt
    v_dot2_f32_bf16 v11, v232, v24, v11
    v_dot2_f32_bf16 v12, v233, v25, v12
    v_dot2_f32_bf16 v11, v234, v26, v11
    v_dot2_f32_bf16 v12, v235, v27, v12
    v_add_f32_dpp v9, v9, v9 quad_perm:[1,0,3,2] row_mask:0xf bank_mask:0xf
    s_waitcnt vmcnt(23)
    buffer_load_dwordx4 v[232:235], v4, s[36:39], s44 offen offset:256 nt
    v_dot2_f32_bf16 v11, v236, v28, v11
    v_dot2_f32_bf16 v12, v237, v29, v12
    v_dot2_f32_bf16 v11, v238, v30, v11
    v_dot2_f32_bf16 v12, v239, v31, v12
    v_add_f32_dpp v9, v9, v9 quad_perm:[2,3,0,1] row_mask:0xf bank_mask:0xf
    s_waitcnt vmcnt(23)
    buffer_load_dwordx4 v[236:239], v4, s[36:39], s44 offen offset:384 nt
    s_add_u32 s44, s44, 4096
    s_and_b32 s44, s44, 0xfffff
    v_dot2_f32_bf16 v13, v240, v16, 0
    v_dot2_f32_bf16 v14, v241, v17, 0
    v_dot2_f32_bf16 v13, v242, v18, v13
    v_dot2_f32_bf16 v14, v243, v19, v14
    v_cvt_pk_bf16_f32 v10, 0, v9
    v_add_f32 v11, v11, v12
    ds_read_b32 v37, v36 offset:588
    s_waitcnt vmcnt(23)
    buffer_load_dwordx4 v[240:243], v4, s[36:39], s44 offen offset:0 nt
    v_dot2_f32_bf16 v13, v244, v20, v13
    v_dot2_f32_bf16 v14, v245, v21, v14
    v_dot2_f32_bf16 v13, v246, v22, v13
    v_dot2_f32_bf16 v14, v247, v23, v14
    v_max_f32 v8, v8, v10
    ds_write_b32 v6, v10 offset:1552
    v_add_f32_dpp v9, v11, v11 row_half_mirror row_mask:0xf bank_mask:0x5
    s_waitcnt vmcnt(23)
    buffer_load_dwordx4 v[244:247], v4, s[36:39], s44 offen offset:128 nt
    v_dot2_f32_bf16 v13, v248, v24, v13
    v_dot2_f32_bf16 v14, v249, v25, v14
    v_dot2_f32_bf16 v13, v250, v26, v13
    v_dot2_f32_bf16 v14, v251, v27, v14
    s_waitcnt vmcnt(23)
    buffer_load_dwordx4 v[248:251], v4, s[36:39], s44 offen offset:256 nt
    v_dot2_f32_bf16 v13, v252, v28, v13
    v_dot2_f32_bf16 v14, v253, v29, v14
    v_dot2_f32_bf16 v13, v254, v30, v13
    v_dot2_f32_bf16 v14, v255, v31, v14
    v_add_u32 v6, 48, v6
    s_add_u32 s50, s50, 1
    v_mov_b32 v38, s50
    s_waitcnt lgkmcnt(0)
    v_readfirstlane_b32 s48, v37
    ds_write_b32 v36, v38 offset:584
    s_sub_u32 s46, s46, 1
    s_cmp_eq_u32 s46, 0
    s_cbranch_scc1 L_kloopx
    s_cmp_eq_u32 s48, 1
    s_cbranch_scc1 L_kloop1
    s_cmp_eq_u32 s48, 0
    s_cbranch_scc1 L_kloop0
    s_branch L_kloop2
L_kloop0:
    s_waitcnt vmcnt(17)
    buffer_load_dwordx4 v[252:255], v4, s[36:39], s44 offen offset:384 nt
    s_add_u32 s44, s44, 4096
    s_and_b32 s44, s44, 0xfffff
    v_dot2_f32_bf16 v11, v64, v16, 0
    v_dot2_f32_bf16 v12, v65, v17, 0
    v_dot2_f32_bf16 v11, v66, v18, v11
    v_dot2_f32_bf16 v12, v67, v19, v12
    v_add_f32 v13, v13, v14
    s_waitcnt vmcnt(17)
    buffer_load_dwordx4 v[64:67], v4, s[36:39], s44 offen offset:0 nt
    v_dot2_f32_bf16 v11, v68, v20, v11
    v_dot2_f32_bf16 v12, v69, v21, v12
    v_dot2_f32_bf16 v11, v70, v22, v11
    v_dot2_f32_bf16 v12, v71, v23, v12
    v_add_f32_dpp v9, v13, v13 row_half_mirror row_mask:0xf bank_mask:0xa
    s_waitcnt vmcnt(17)
    buffer_load_dwordx4 v[68:71], v4, s[36:39], s44 offen offset:128 nt
    v_dot2_f32_bf16 v11, v72, v24, v11
    v_dot2_f32_bf16 v12, v73, v25, v12
    v_dot2_f32_bf16 v11, v74, v26, v11
    v_dot2_f32_bf16 v12, v75, v27, v12
    v_add_f32_dpp v9, v9, v9 quad_perm:[1,0,3,2] row_mask:0xf bank_mask:0xf
    s_waitcnt vmcnt(17)
    buffer_load_dwordx4 v[72:75], v4, s[36:39], s44 offen offset:256 nt
    v_dot2_f32_bf16 v11, v76, v28, v11
    v_dot2_f32_bf16 v12, v77, v29, v12
    v_dot2_f32_bf16 v11, v78, v30, v11
    v_dot2_f32_bf16 v12, v79, v31, v12
    v_add_f32_dpp v9, v9, v9 quad_perm:[2,3,0,1] row_mask:0xf bank_mask:0xf
    s_waitcnt vmcnt(17)
    buffer_load_dwordx4 v[76:79], v4, s[36:39], s44 offen offset:384 nt
    s_add_u32 s44, s44, 4096
    s_and_b32 s44, s44, 0xfffff
    v_dot2_f32_bf16 v13, v80, v16, 0
    v_dot2_f32_bf16 v14, v81, v17, 0
    v_dot2_f32_bf16 v13, v82, v18, v13
    v_dot2_f32_bf16 v14, v83, v19, v14
    v_cvt_pk_bf16_f32 v10, 0, v9
    v_add_f32 v11, v11, v12
    s_waitcnt vmcnt(17)
    buffer_load_dwordx4 v[80:83], v4, s[36:39], s44 offen offset:0 nt
    v_dot2_f32_bf16 v13, v84, v20, v13
    v_dot2_f32_bf16 v14, v85, v21, v14
    v_dot2_f32_bf16 v13, v86, v22, v13
    v_dot2_f32_bf16 v14, v87, v23, v14
    v_max_f32 v8, v8, v10
    ds_write_b32 v6, v10 offset:1512
    v_add_f32_dpp v9, v11, v11 row_half_mirror row_mask:0xf bank_mask:0x5
    s_waitcnt vmcnt(17)
    buffer_load_dwordx4 v[84:87], v4, s[36:39], s44 offen offset:128 nt
    v_dot2_f32_bf16 v13, v88, v24, v13
    v_dot2_f32_bf16 v14, v89, v25, v14
    v_dot2_f32_bf16 v13, v90, v26, v13
    v_dot2_f32_bf16 v14, v91, v27, v14
    s_waitcnt vmcnt(17)
    buffer_load_dwordx4 v[88:91], v4, s[36:39], s44 offen offset:256 nt
    v_dot2_f32_bf16 v13, v92, v28, v13
    v_dot2_f32_bf16 v14, v93, v29, v14
    v_dot2_f32_bf16 v13, v94, v30, v13
    v_dot2_f32_bf16 v14, v95, v31, v14
    s_waitcnt vmcnt(17)
    buffer_load_dwordx4 v[92:95], v4, s[36:39], s44 offen offset:384 nt
    s_add_u32 s44, s44, 4096
    s_and_b32 s44, s44, 0xfffff
    v_dot2_f32_bf16 v11, v96, v16, 0
    v_dot2_f32_bf16 v12, v97, v17, 0
    v_dot2_f32_bf16 v11, v98, v18, v11
    v_dot2_f32_bf16 v12, v99, v19, v12
    v_add_f32 v13, v13, v14
    s_waitcnt vmcnt(17)
    buffer_load_dwordx4 v[96:99], v4, s[36:39], s44 offen offset:0 nt
    v_dot2_f32_bf16 v11, v100, v20, v11
    v_dot2_f32_bf16 v12, v101, v21, v12
    v_dot2_f32_bf16 v11, v102, v22, v11
    v_dot2_f32_bf16 v12, v103, v23, v12
    v_add_f32_dpp v9, v13, v13 row_half_mirror row_mask:0xf bank_mask:0xa
    s_waitcnt vmcnt(17)
    buffer_load_dwordx4 v[100:103], v4, s[36:39], s44 offen offset:128 nt
    v_dot2_f32_bf16 v11, v104, v24, v11
    v_dot2_f32_bf16 v12, v105, v25, v12
    v_dot2_f32_bf16 v11, v106, v26, v11
    v_dot2_f32_bf16 v12, v107, v27, v12
    v_add_f32_dpp v9, v9, v9 quad_perm:[1,0,3,2] row_mask:0xf bank_mask:0xf
    s_waitcnt vmcnt(17)
    buffer_load_dwordx4 v[104:107], v4, s[36:39], s44 offen offset:256 nt
    v_dot2_f32_bf16 v11, v108, v28, v11
    v_dot2_f32_bf16 v12, v109, v29, v12
    v_dot2_f32_bf16 v11, v110, v30, v11
    v_dot2_f32_bf16 v12, v111, v31, v12
    v_add_f32_dpp v9, v9, v9 quad_perm:[2,3,0,1] row_mask:0xf bank_mask:0xf
    s_waitcnt vmcnt(17)
    buffer_load_dwordx4 v[108:111], v4, s[36:39], s44 offen offset:384 nt
    s_add_u32 s44, s44, 4096
    s_and_b32 s44, s44, 0xfffff
    v_dot2_f32_bf16 v13, v112, v16, 0
    v_dot2_f32_bf16 v14, v113, v17, 0
    v_dot2_f32_bf16 v13, v114, v18, v13
    v_dot2_f32_bf16 v14, v115, v19, v14
    v_cvt_pk_bf16_f32 v10, 0, v9
    v_add_f32 v11, v11, v12
    s_waitcnt vmcnt(17)
    buffer_load_dwordx4 v[112:115], v4, s[36:39], s44 offen offset:0 nt
    v_dot2_f32_bf16 v13, v116, v20, v13
    v_dot2_f32_bf16 v14, v117, v21, v14
    v_dot2_f32_bf16 v13, v118, v22, v13
    v_dot2_f32_bf16 v14, v119, v23, v14
    v_max_f32 v8, v8, v10
    ds_write_b32 v6, v10 offset:1520
    v_add_f32_dpp v9, v11, v11 row_half_mirror row_mask:0xf bank_mask:0x5
    s_waitcnt vmcnt(17)
    buffer_load_dwordx4 v[116:119], v4, s[36:39], s44 offen offset:128 nt
    v_dot2_f32_bf16 v13, v120, v24, v13
    v_dot2_f32_bf16 v14, v121, v25, v14
    v_dot2_f32_bf16 v13, v122, v26, v13
    v_dot2_f32_bf16 v14, v123, v27, v14
    s_waitcnt vmcnt(17)
    buffer_load_dwordx4 v[120:123], v4, s[36:39], s44 offen offset:256 nt
    v_dot2_f32_bf16 v13, v124, v28, v13
    v_dot2_f32_bf16 v14, v125, v29, v14
    v_dot2_f32_bf16 v13, v126, v30, v13
    v_dot2_f32_bf16 v14, v127, v31, v14
    s_waitcnt vmcnt(17)
    buffer_load_dwordx4 v[124:127], v4, s[36:39], s44 offen offset:384 nt
    s_add_u32 s44, s44, 4096
    s_and_b32 s44, s44, 0xfffff
    v_dot2_f32_bf16 v11, v128, v16, 0
    v_dot2_f32_bf16 v12, v129, v17, 0
    v_dot2_f32_bf16 v11, v130, v18, v11
    v_dot2_f32_bf16 v12, v131, v19, v12
    v_add_f32 v13, v13, v14
    s_waitcnt vmcnt(17)
    buffer_load_dwordx4 v[128:131], v4, s[36:39], s44 offen offset:0 nt
    v_dot2_f32_bf16 v11, v132, v20, v11
    v_dot2_f32_bf16 v12, v133, v21, v12
    v_dot2_f32_bf16 v11, v134, v22, v11
    v_dot2_f32_bf16 v12, v135, v23, v12
    v_add_f32_dpp v9, v13, v13 row_half_mirror row_mask:0xf bank_mask:0xa
    s_waitcnt vmcnt(17)
    buffer_load_dwordx4 v[132:135], v4, s[36:39], s44 offen offset:128 nt
    v_dot2_f32_bf16 v11, v136, v24, v11
    v_dot2_f32_bf16 v12, v137, v25, v12
    v_dot2_f32_bf16 v11, v138, v26, v11
    v_dot2_f32_bf16 v12, v139, v27, v12
    v_add_f32_dpp v9, v9, v9 quad_perm:[1,0,3,2] row_mask:0xf bank_mask:0xf
    s_waitcnt vmcnt(17)
    buffer_load_dwordx4 v[136:139], v4, s[36:39], s44 offen offset:256 nt
    v_dot2_f32_bf16 v11, v140, v28, v11
    v_dot2_f32_bf16 v12, v141, v29, v12
    v_dot2_f32_bf16 v11, v142, v30, v11
    v_dot2_f32_bf16 v12, v143, v31, v12
    v_add_f32_dpp v9, v9, v9 quad_perm:[2,3,0,1] row_mask:0xf bank_mask:0xf
    s_waitcnt vmcnt(17)
    buffer_load_dwordx4 v[140:143], v4, s[36:39], s44 offen offset:384 nt
    s_add_u32 s44, s44, 4096
    s_and_b32 s44, s44, 0xfffff
    v_dot2_f32_bf16 v13, v144, v16, 0
    v_dot2_f32_bf16 v14, v145, v17, 0
    v_dot2_f32_bf16 v13, v146, v18, v13
    v_dot2_f32_bf16 v14, v147, v19, v14
    v_cvt_pk_bf16_f32 v10, 0, v9
    v_add_f32 v11, v11, v12
    s_waitcnt vmcnt(17)
    buffer_load_dwordx4 v[144:147], v4, s[36:39], s44 offen offset:0 nt
    v_dot2_f32_bf16 v13, v148, v20, v13
    v_dot2_f32_bf16 v14, v149, v21, v14
    v_dot2_f32_bf16 v13, v150, v22, v13
    v_dot2_f32_bf16 v14, v151, v23, v14
    v_max_f32 v8, v8, v10
    ds_write_b32 v6, v10 offset:1528
    v_add_f32_dpp v9, v11, v11 row_half_mirror row_mask:0xf bank_mask:0x5
    s_waitcnt vmcnt(17)
    buffer_load_dwordx4 v[148:151], v4, s[36:39], s44 offen offset:128 nt
    v_dot2_f32_bf16 v13, v152, v24, v13
    v_dot2_f32_bf16 v14, v153, v25, v14
    v_dot2_f32_bf16 v13, v154, v26, v13
    v_dot2_f32_bf16 v14, v155, v27, v14
    s_waitcnt vmcnt(17)
    buffer_load_dwordx4 v[152:155], v4, s[36:39], s44 offen offset:256 nt
    v_dot2_f32_bf16 v13, v156, v28, v13
    v_dot2_f32_bf16 v14, v157, v29, v14
    v_dot2_f32_bf16 v13, v158, v30, v13
    v_dot2_f32_bf16 v14, v159, v31, v14
    s_waitcnt vmcnt(17)
    buffer_load_dwordx4 v[156:159], v4, s[36:39], s44 offen offset:384 nt
    s_add_u32 s44, s44, 4096
    s_and_b32 s44, s44, 0xfffff
    v_dot2_f32_bf16 v11, v160, v16, 0
    v_dot2_f32_bf16 v12, v161, v17, 0
    v_dot2_f32_bf16 v11, v162, v18, v11
    v_dot2_f32_bf16 v12, v163, v19, v12
    v_add_f32 v13, v13, v14
    s_waitcnt vmcnt(17)
    buffer_load_dwordx4 v[160:163], v4, s[36:39], s44 offen offset:0 nt
    v_dot2_f32_bf16 v11, v164, v20, v11
    v_dot2_f32_bf16 v12, v165, v21, v12
    v_dot2_f32_bf16 v11, v166, v22, v11
    v_dot2_f32_bf16 v12, v167, v23, v12
    v_add_f32_dpp v9, v13, v13 row_half_mirror row_mask:0xf bank_mask:0xa
    s_waitcnt vmcnt(17)
    buffer_load_dwordx4 v[164:167], v4, s[36:39], s44 offen offset:128 nt
    v_dot2_f32_bf16 v11, v168, v24, v11
    v_dot2_f32_bf16 v12, v169, v25, v12
    v_dot2_f32_bf16 v11, v170, v26, v11
    v_dot2_f32_bf16 v12, v171, v27, v12
    v_add_f32_dpp v9, v9, v9 quad_perm:[1,0,3,2] row_mask:0xf bank_mask:0xf
    s_waitcnt vmcnt(17)
    buffer_load_dwordx4 v[168:171], v4, s[36:39], s44 offen offset:256 nt
    v_dot2_f32_bf16 v11, v172, v28, v11
    v_dot2_f32_bf16 v12, v173, v29, v12
    v_dot2_f32_bf16 v11, v174, v30, v11
    v_dot2_f32_bf16 v12, v175, v31, v12
    v_add_f32_dpp v9, v9, v9 quad_perm:[2,3,0,1] row_mask:0xf bank_mask:0xf
    s_waitcnt vmcnt(17)
    buffer_load_dwordx4 v[172:175], v4, s[36:39], s44 offen offset:384 nt
    s_add_u32 s44, s44, 4096
    s_and_b32 s44, s44, 0xfffff
    v_dot2_f32_bf16 v13, v176, v16, 0
    v_dot2_f32_bf16 v14, v177, v17, 0
    v_dot2_f32_bf16 v13, v178, v18, v13
    v_dot2_f32_bf16 v14, v179, v19, v14
    v_cvt_pk_bf16_f32 v10, 0, v9
    v_add_f32 v11, v11, v12
    ds_read_b32 v37, v36 offset:588
    s_waitcnt vmcnt(17)
    buffer_load_dwordx4 v[176:179], v4, s[36:39], s44 offen offset:0 nt
    v_dot2_f32_bf16 v13, v180, v20, v13
    v_dot2_f32_bf16 v14, v181, v21, v14
    v_dot2_f32_bf16 v13, v182, v22, v13
    v_dot2_f32_bf16 v14, v183, v23, v14
    v_max_f32 v8, v8, v10
    ds_write_b32 v6, v10 offset:1536
    v_add_f32_dpp v9, v11, v11 row_half_mirror row_mask:0xf bank_mask:0x5
    s_waitcnt vmcnt(17)
    buffer_load_dwordx4 v[180:183], v4, s[36:39], s44 offen offset:128 nt
    v_dot2_f32_bf16 v13, v184, v24, v13
    v_dot2_f32_bf16 v14, v185, v25, v14
    v_dot2_f32_bf16 v13, v186, v26, v13
    v_dot2_f32_bf16 v14, v187, v27, v14
    s_waitcnt vmcnt(17)
    buffer_load_dwordx4 v[184:187], v4, s[36:39], s44 offen offset:256 nt
    v_dot2_f32_bf16 v13, v188, v28, v13
    v_dot2_f32_bf16 v14, v189, v29, v14
    v_dot2_f32_bf16 v13, v190, v30, v13
    v_dot2_f32_bf16 v14, v191, v31, v14
    s_waitcnt lgkmcnt(0)
    v_readfirstlane_b32 s48, v37
    s_cmp_eq_u32 s48, 1
    s_cbranch_scc1 L_kloopm1
    s_cmp_eq_u32 s48, 2
    s_cbranch_scc1 L_kloopm2
L_kloopm0:
    s_waitcnt vmcnt(17)
    buffer_load_dwordx4 v[188:191], v4, s[36:39], s44 offen offset:384 nt
    s_add_u32 s44, s44, 4096
    s_and_b32 s44, s44, 0xfffff
    v_dot2_f32_bf16 v11, v192, v16, 0
    v_dot2_f32_bf16 v12, v193, v17, 0
    v_dot2_f32_bf16 v11, v194, v18, v11
    v_dot2_f32_bf16 v12, v195, v19, v12
    v_add_f32 v13, v13, v14
    s_waitcnt vmcnt(17)
    buffer_load_dwordx4 v[192:195], v4, s[36:39], s44 offen offset:0 nt
    v_dot2_f32_bf16 v11, v196, v20, v11
    v_dot2_f32_bf16 v12, v197, v21, v12
    v_dot2_f32_bf16 v11, v198, v22, v11
    v_dot2_f32_bf16 v12, v199, v23, v12
    v_add_f32_dpp v9, v13, v13 row_half_mirror row_mask:0xf bank_mask:0xa
    s_waitcnt vmcnt(17)
    buffer_load_dwordx4 v[196:199], v4, s[36:39], s44 offen offset:128 nt
    v_dot2_f32_bf16 v11, v200, v24, v11
    v_dot2_f32_bf16 v12, v201, v25, v12
    v_dot2_f32_bf16 v11, v202, v26, v11
    v_dot2_f32_bf16 v12, v203, v27, v12
    v_add_f32_dpp v9, v9, v9 quad_perm:[1,0,3,2] row_mask:0xf bank_mask:0xf
    s_waitcnt vmcnt(17)
    buffer_load_dwordx4 v[200:203], v4, s[36:39], s44 offen offset:256 nt
    v_dot2_f32_bf16 v11, v204, v28, v11
    v_dot2_f32_bf16 v12, v205, v29, v12
    v_dot2_f32_bf16 v11, v206, v30, v11
    v_dot2_f32_bf16 v12, v207, v31, v12
    v_add_f32_dpp v9, v9, v9 quad_perm:[2,3,0,1] row_mask:0xf bank_mask:0xf
    s_waitcnt vmcnt(17)
    buffer_load_dwordx4 v[204:207], v4, s[36:39], s44 offen offset:384 nt
    s_add_u32 s44, s44, 4096
    s_and_b32 s44, s44, 0xfffff
    v_dot2_f32_bf16 v13, v208, v16, 0
    v_dot2_f32_bf16 v14, v209, v17, 0
    v_dot2_f32_bf16 v13, v210, v18, v13
    v_dot2_f32_bf16 v14, v211, v19, v14
    v_cvt_pk_bf16_f32 v10, 0, v9
    v_add_f32 v11, v11, v12
    s_waitcnt vmcnt(17)
    buffer_load_dwordx4 v[208:211], v4, s[36:39], s44 offen offset:0 nt
    v_dot2_f32_bf16 v13, v212, v20, v13
    v_dot2_f32_bf16 v14, v213, v21, v14
    v_dot2_f32_bf16 v13, v214, v22, v13
    v_dot2_f32_bf16 v14, v215, v23, v14
    v_max_f32 v8, v8, v10
    ds_write_b32 v6, v10 offset:1544
    v_add_f32_dpp v9, v11, v11 row_half_mirror row_mask:0xf bank_mask:0x5
    s_waitcnt vmcnt(17)
    buffer_load_dwordx4 v[212:215], v4, s[36:39], s44 offen offset:128 nt
    v_dot2_f32_bf16 v13, v216, v24, v13
    v_dot2_f32_bf16 v14, v217, v25, v14
    v_dot2_f32_bf16 v13, v218, v26, v13
    v_dot2_f32_bf16 v14, v219, v27, v14
    s_waitcnt vmcnt(17)
    buffer_load_dwordx4 v[216:219], v4, s[36:39], s44 offen offset:256 nt
    v_dot2_f32_bf16 v13, v220, v28, v13
    v_dot2_f32_bf16 v14, v221, v29, v14
    v_dot2_f32_bf16 v13, v222, v30, v13
    v_dot2_f32_bf16 v14, v223, v31, v14
    s_waitcnt vmcnt(17)
    buffer_load_dwordx4 v[220:223], v4, s[36:39], s44 offen offset:384 nt
    s_add_u32 s44, s44, 4096
    s_and_b32 s44, s44, 0xfffff
    v_dot2_f32_bf16 v11, v224, v16, 0
    v_dot2_f32_bf16 v12, v225, v17, 0
    v_dot2_f32_bf16 v11, v226, v18, v11
    v_dot2_f32_bf16 v12, v227, v19, v12
    v_add_f32 v13, v13, v14
    s_waitcnt vmcnt(17)
    buffer_load_dwordx4 v[224:227], v4, s[36:39], s44 offen offset:0 nt
    v_dot2_f32_bf16 v11, v228, v20, v11
    v_dot2_f32_bf16 v12, v229, v21, v12
    v_dot2_f32_bf16 v11, v230, v22, v11
    v_dot2_f32_bf16 v12, v231, v23, v12
    v_add_f32_dpp v9, v13, v13 row_half_mirror row_mask:0xf bank_mask:0xa
    s_waitcnt vmcnt(17)
    buffer_load_dwordx4 v[228:231], v4, s[36:39], s44 offen offset:128 nt
    v_dot2_f32_bf16 v11, v232, v24, v11
    v_dot2_f32_bf16 v12, v233, v25, v12
    v_dot2_f32_bf16 v11, v234, v26, v11
    v_dot2_f32_bf16 v12, v235, v27, v12
    v_add_f32_dpp v9, v9, v9 quad_perm:[1,0,3,2] row_mask:0xf bank_mask:0xf
    s_waitcnt vmcnt(17)
    buffer_load_dwordx4 v[232:235], v4, s[36:39], s44 offen offset:256 nt
    v_dot2_f32_bf16 v11, v236, v28, v11
    v_dot2_f32_bf16 v12, v237, v29, v12
    v_dot2_f32_bf16 v11, v238, v30, v11
    v_dot2_f32_bf16 v12, v239, v31, v12
    v_add_f32_dpp v9, v9, v9 quad_perm:[2,3,0,1] row_mask:0xf bank_mask:0xf
    s_waitcnt vmcnt(17)
    buffer_load_dwordx4 v[236:239], v4, s[36:39], s44 offen offset:384 nt
    s_add_u32 s44, s44, 4096
    s_and_b32 s44, s44, 0xfffff
    v_dot2_f32_bf16 v13, v240, v16, 0
    v_dot2_f32_bf16 v14, v241, v17, 0
    v_dot2_f32_bf16 v13, v242, v18, v13
    v_dot2_f32_bf16 v14, v243, v19, v14
    v_cvt_pk_bf16_f32 v10, 0, v9
    v_add_f32 v11, v11, v12
    ds_read_b32 v37, v36 offset:588
    s_waitcnt vmcnt(17)
    buffer_load_dwordx4 v[240:243], v4, s[36:39], s44 offen offset:0 nt
    v_dot2_f32_bf16 v13, v244, v20, v13
    v_dot2_f32_bf16 v14, v245, v21, v14
    v_dot2_f32_bf16 v13, v246, v22, v13
    v_dot2_f32_bf16 v14, v247, v23, v14
    v_max_f32 v8, v8, v10
    ds_write_b32 v6, v10 offset:1552
    v_add_f32_dpp v9, v11, v11 row_half_mirror row_mask:0xf bank_mask:0x5
    s_waitcnt vmcnt(17)
    buffer_load_dwordx4 v[244:247], v4, s[36:39], s44 offen offset:128 nt
    v_dot2_f32_bf16 v13, v248, v24, v13
    v_dot2_f32_bf16 v14, v249, v25, v14
    v_dot2_f32_bf16 v13, v250, v26, v13
    v_dot2_f32_bf16 v14, v251, v27, v14
    s_waitcnt vmcnt(17)
    buffer_load_dwordx4 v[248:251], v4, s[36:39], s44 offen offset:256 nt
    v_dot2_f32_bf16 v13, v252, v28, v13
    v_dot2_f32_bf16 v14, v253, v29, v14
    v_dot2_f32_bf16 v13, v254, v30, v13
    v_dot2_f32_bf16 v14, v255, v31, v14
    v_add_u32 v6, 48, v6
    s_add_u32 s50, s50, 1
    v_mov_b32 v38, s50
    s_waitcnt lgkmcnt(0)
    v_readfirstlane_b32 s48, v37
    ds_write_b32 v36, v38 offset:584
    s_sub_u32 s46, s46, 1
    s_cmp_eq_u32 s46, 0
    s_cbranch_scc1 L_kloopx
    s_cmp_eq_u32 s48, 0
    s_cbranch_scc1 L_kloop0
    s_cmp_eq_u32 s48, 1
    s_cbranch_scc1 L_kloop1
    s_branch L_kloop2
L_kloop2:
    s_waitcnt vmcnt(31)
    buffer_load_dwordx4 v[252:255], v4, s[36:39], s44 offen offset:384 nt
    s_add_u32 s44, s44, 4096
    s_and_b32 s44, s44, 0xfffff
    v_dot2_f32_bf16 v11, v64, v16, 0
    v_dot2_f32_bf16 v12, v65, v17, 0
    v_dot2_f32_bf16 v11, v66, v18, v11
    v_dot2_f32_bf16 v12, v67, v19, v12
    v_add_f32 v13, v13, v14
    s_waitcnt vmcnt(31)
    buffer_load_dwordx4 v[64:67], v4, s[36:39], s44 offen offset:0 nt
    v_dot2_f32_bf16 v11, v68, v20, v11
    v_dot2_f32_bf16 v12, v69, v21, v12
    v_dot2_f32_bf16 v11, v70, v22, v11
    v_dot2_f32_bf16 v12, v71, v23, v12
    v_add_f32_dpp v9, v13, v13 row_half_mirror row_mask:0xf bank_mask:0xa
    s_waitcnt vmcnt(31)
    buffer_load_dwordx4 v[68:71], v4, s[36:39], s44 offen offset:128 nt
    v_dot2_f32_bf16 v11, v72, v24, v11
    v_dot2_f32_bf16 v12, v73, v25, v12
    v_dot2_f32_bf16 v11, v74, v26, v11
    v_dot2_f32_bf16 v12, v75, v27, v12
    v_add_f32_dpp v9, v9, v9 quad_perm:[1,0,3,2] row_mask:0xf bank_mask:0xf
    s_waitcnt vmcnt(31)
    buffer_load_dwordx4 v[72:75], v4, s[36:39], s44 offen offset:256 nt
    v_dot2_f32_bf16 v11, v76, v28, v11
    v_dot2_f32_bf16 v12, v77, v29, v12
    v_dot2_f32_bf16 v11, v78, v30, v11
    v_dot2_f32_bf16 v12, v79, v31, v12
    v_add_f32_dpp v9, v9, v9 quad_perm:[2,3,0,1] row_mask:0xf bank_mask:0xf
    s_waitcnt vmcnt(31)
    buffer_load_dwordx4 v[76:79], v4, s[36:39], s44 offen offset:384 nt
    s_add_u32 s44, s44, 4096
    s_and_b32 s44, s44, 0xfffff
    v_dot2_f32_bf16 v13, v80, v16, 0
    v_dot2_f32_bf16 v14, v81, v17, 0
    v_dot2_f32_bf16 v13, v82, v18, v13
    v_dot2_f32_bf16 v14, v83, v19, v14
    v_cvt_pk_bf16_f32 v10, 0, v9
    v_add_f32 v11, v11, v12
    s_waitcnt vmcnt(31)
    buffer_load_dwordx4 v[80:83], v4, s[36:39], s44 offen offset:0 nt
    v_dot2_f32_bf16 v13, v84, v20, v13
    v_dot2_f32_bf16 v14, v85, v21, v14
    v_dot2_f32_bf16 v13, v86, v22, v13
    v_dot2_f32_bf16 v14, v87, v23, v14
    v_max_f32 v8, v8, v10
    ds_write_b32 v6, v10 offset:1512
    v_add_f32_dpp v9, v11, v11 row_half_mirror row_mask:0xf bank_mask:0x5
    s_waitcnt vmcnt(31)
    buffer_load_dwordx4 v[84:87], v4, s[36:39], s44 offen offset:128 nt
    v_dot2_f32_bf16 v13, v88, v24, v13
    v_dot2_f32_bf16 v14, v89, v25, v14
    v_dot2_f32_bf16 v13, v90, v26, v13
    v_dot2_f32_bf16 v14, v91, v27, v14
    s_waitcnt vmcnt(31)
    buffer_load_dwordx4 v[88:91], v4, s[36:39], s44 offen offset:256 nt
    v_dot2_f32_bf16 v13, v92, v28, v13
    v_dot2_f32_bf16 v14, v93, v29, v14
    v_dot2_f32_bf16 v13, v94, v30, v13
    v_dot2_f32_bf16 v14, v95, v31, v14
    s_waitcnt vmcnt(31)
    buffer_load_dwordx4 v[92:95], v4, s[36:39], s44 offen offset:384 nt
    s_add_u32 s44, s44, 4096
    s_and_b32 s44, s44, 0xfffff
    v_dot2_f32_bf16 v11, v96, v16, 0
    v_dot2_f32_bf16 v12, v97, v17, 0
    v_dot2_f32_bf16 v11, v98, v18, v11
    v_dot2_f32_bf16 v12, v99, v19, v12
    v_add_f32 v13, v13, v14
    s_waitcnt vmcnt(31)
    buffer_load_dwordx4 v[96:99], v4, s[36:39], s44 offen offset:0 nt
    v_dot2_f32_bf16 v11, v100, v20, v11
    v_dot2_f32_bf16 v12, v101, v21, v12
    v_dot2_f32_bf16 v11, v102, v22, v11
    v_dot2_f32_bf16 v12, v103, v23, v12
    v_add_f32_dpp v9, v13, v13 row_half_mirror row_mask:0xf bank_mask:0xa
    s_waitcnt vmcnt(31)
    buffer_load_dwordx4 v[100:103], v4, s[36:39], s44 offen offset:128 nt
    v_dot2_f32_bf16 v11, v104, v24, v11
    v_dot2_f32_bf16 v12, v105, v25, v12
    v_dot2_f32_bf16 v11, v106, v26, v11
    v_dot2_f32_bf16 v12, v107, v27, v12
    v_add_f32_dpp v9, v9, v9 quad_perm:[1,0,3,2] row_mask:0xf bank_mask:0xf
    s_waitcnt vmcnt(31)
    buffer_load_dwordx4 v[104:107], v4, s[36:39], s44 offen offset:256 nt
    v_dot2_f32_bf16 v11, v108, v28, v11
    v_dot2_f32_bf16 v12, v109, v29, v12
    v_dot2_f32_bf16 v11, v110, v30, v11
    v_dot2_f32_bf16 v12, v111, v31, v12
    v_add_f32_dpp v9, v9, v9 quad_perm:[2,3,0,1] row_mask:0xf bank_mask:0xf
    s_waitcnt vmcnt(31)
    buffer_load_dwordx4 v[108:111], v4, s[36:39], s44 offen offset:384 nt
    s_add_u32 s44, s44, 4096
    s_and_b32 s44, s44, 0xfffff
    v_dot2_f32_bf16 v13, v112, v16, 0
    v_dot2_f32_bf16 v14, v113, v17, 0
    v_dot2_f32_bf16 v13, v114, v18, v13
    v_dot2_f32_bf16 v14, v115, v19, v14
    v_cvt_pk_bf16_f32 v10, 0, v9
    v_add_f32 v11, v11, v12
    s_waitcnt vmcnt(31)
    buffer_load_dwordx4 v[112:115], v4, s[36:39], s44 offen offset:0 nt
    v_dot2_f32_bf16 v13, v116, v20, v13
    v_dot2_f32_bf16 v14, v117, v21, v14
    v_dot2_f32_bf16 v13, v118, v22, v13
    v_dot2_f32_bf16 v14, v119, v23, v14
    v_max_f32 v8, v8, v10
    ds_write_b32 v6, v10 offset:1520
    v_add_f32_dpp v9, v11, v11 row_half_mirror row_mask:0xf bank_mask:0x5
    s_waitcnt vmcnt(31)
    buffer_load_dwordx4 v[116:119], v4, s[36:39], s44 offen offset:128 nt
    v_dot2_f32_bf16 v13, v120, v24, v13
    v_dot2_f32_bf16 v14, v121, v25, v14
    v_dot2_f32_bf16 v13, v122, v26, v13
    v_dot2_f32_bf16 v14, v123, v27, v14
    s_waitcnt vmcnt(31)
    buffer_load_dwordx4 v[120:123], v4, s[36:39], s44 offen offset:256 nt
    v_dot2_f32_bf16 v13, v124, v28, v13
    v_dot2_f32_bf16 v14, v125, v29, v14
    v_dot2_f32_bf16 v13, v126, v30, v13
    v_dot2_f32_bf16 v14, v127, v31, v14
    s_waitcnt vmcnt(31)
    buffer_load_dwordx4 v[124:127], v4, s[36:39], s44 offen offset:384 nt
    s_add_u32 s44, s44, 4096
    s_and_b32 s44, s44, 0xfffff
    v_dot2_f32_bf16 v11, v128, v16, 0
    v_dot2_f32_bf16 v12, v129, v17, 0
    v_dot2_f32_bf16 v11, v130, v18, v11
    v_dot2_f32_bf16 v12, v131, v19, v12
    v_add_f32 v13, v13, v14
    s_waitcnt vmcnt(31)
    buffer_load_dwordx4 v[128:131], v4, s[36:39], s44 offen offset:0 nt
    v_dot2_f32_bf16 v11, v132, v20, v11
    v_dot2_f32_bf16 v12, v133, v21, v12
    v_dot2_f32_bf16 v11, v134, v22, v11
    v_dot2_f32_bf16 v12, v135, v23, v12
    v_add_f32_dpp v9, v13, v13 row_half_mirror row_mask:0xf bank_mask:0xa
    s_waitcnt vmcnt(31)
    buffer_load_dwordx4 v[132:135], v4, s[36:39], s44 offen offset:128 nt
    v_dot2_f32_bf16 v11, v136, v24, v11
    v_dot2_f32_bf16 v12, v137, v25, v12
    v_dot2_f32_bf16 v11, v138, v26, v11
    v_dot2_f32_bf16 v12, v139, v27, v12
    v_add_f32_dpp v9, v9, v9 quad_perm:[1,0,3,2] row_mask:0xf bank_mask:0xf
    s_waitcnt vmcnt(31)
    buffer_load_dwordx4 v[136:139], v4, s[36:39], s44 offen offset:256 nt
    v_dot2_f32_bf16 v11, v140, v28, v11
    v_dot2_f32_bf16 v12, v141, v29, v12
    v_dot2_f32_bf16 v11, v142, v30, v11
    v_dot2_f32_bf16 v12, v143, v31, v12
    v_add_f32_dpp v9, v9, v9 quad_perm:[2,3,0,1] row_mask:0xf bank_mask:0xf
    s_waitcnt vmcnt(31)
    buffer_load_dwordx4 v[140:143], v4, s[36:39], s44 offen offset:384 nt
    s_add_u32 s44, s44, 4096
    s_and_b32 s44, s44, 0xfffff
    v_dot2_f32_bf16 v13, v144, v16, 0
    v_dot2_f32_bf16 v14, v145, v17, 0
    v_dot2_f32_bf16 v13, v146, v18, v13
    v_dot2_f32_bf16 v14, v147, v19, v14
    v_cvt_pk_bf16_f32 v10, 0, v9
    v_add_f32 v11, v11, v12
    s_waitcnt vmcnt(31)
    buffer_load_dwordx4 v[144:147], v4, s[36:39], s44 offen offset:0 nt
    v_dot2_f32_bf16 v13, v148, v20, v13
    v_dot2_f32_bf16 v14, v149, v21, v14
    v_dot2_f32_bf16 v13, v150, v22, v13
    v_dot2_f32_bf16 v14, v151, v23, v14
    v_max_f32 v8, v8, v10
    ds_write_b32 v6, v10 offset:1528
    v_add_f32_dpp v9, v11, v11 row_half_mirror row_mask:0xf bank_mask:0x5
    s_waitcnt vmcnt(31)
    buffer_load_dwordx4 v[148:151], v4, s[36:39], s44 offen offset:128 nt
    v_dot2_f32_bf16 v13, v152, v24, v13
    v_dot2_f32_bf16 v14, v153, v25, v14
    v_dot2_f32_bf16 v13, v154, v26, v13
    v_dot2_f32_bf16 v14, v155, v27, v14
    s_waitcnt vmcnt(31)
    buffer_load_dwordx4 v[152:155], v4, s[36:39], s44 offen offset:256 nt
    v_dot2_f32_bf16 v13, v156, v28, v13
    v_dot2_f32_bf16 v14, v157, v29, v14
    v_dot2_f32_bf16 v13, v158, v30, v13
    v_dot2_f32_bf16 v14, v159, v31, v14
    s_waitcnt vmcnt(31)
    buffer_load_dwordx4 v[156:159], v4, s[36:39], s44 offen offset:384 nt
    s_add_u32 s44, s44, 4096
    s_and_b32 s44, s44, 0xfffff
    v_dot2_f32_bf16 v11, v160, v16, 0
    v_dot2_f32_bf16 v12, v161, v17, 0
    v_dot2_f32_bf16 v11, v162, v18, v11
    v_dot2_f32_bf16 v12, v163, v19, v12
    v_add_f32 v13, v13, v14
    s_waitcnt vmcnt(31)
    buffer_load_dwordx4 v[160:163], v4, s[36:39], s44 offen offset:0 nt
    v_dot2_f32_bf16 v11, v164, v20, v11
    v_dot2_f32_bf16 v12, v165, v21, v12
    v_dot2_f32_bf16 v11, v166, v22, v11
    v_dot2_f32_bf16 v12, v167, v23, v12
    v_add_f32_dpp v9, v13, v13 row_half_mirror row_mask:0xf bank_mask:0xa
    s_waitcnt vmcnt(31)
    buffer_load_dwordx4 v[164:167], v4, s[36:39], s44 offen offset:128 nt
    v_dot2_f32_bf16 v11, v168, v24, v11
    v_dot2_f32_bf16 v12, v169, v25, v12
    v_dot2_f32_bf16 v11, v170, v26, v11
    v_dot2_f32_bf16 v12, v171, v27, v12
    v_add_f32_dpp v9, v9, v9 quad_perm:[1,0,3,2] row_mask:0xf bank_mask:0xf
    s_waitcnt vmcnt(31)
    buffer_load_dwordx4 v[168:171], v4, s[36:39], s44 offen offset:256 nt
    v_dot2_f32_bf16 v11, v172, v28, v11
    v_dot2_f32_bf16 v12, v173, v29, v12
    v_dot2_f32_bf16 v11, v174, v30, v11
    v_dot2_f32_bf16 v12, v175, v31, v12
    v_add_f32_dpp v9, v9, v9 quad_perm:[2,3,0,1] row_mask:0xf bank_mask:0xf
    s_waitcnt vmcnt(31)
    buffer_load_dwordx4 v[172:175], v4, s[36:39], s44 offen offset:384 nt
    s_add_u32 s44, s44, 4096
    s_and_b32 s44, s44, 0xfffff
    v_dot2_f32_bf16 v13, v176, v16, 0
    v_dot2_f32_bf16 v14, v177, v17, 0
    v_dot2_f32_bf16 v13, v178, v18, v13
    v_dot2_f32_bf16 v14, v179, v19, v14
    v_cvt_pk_bf16_f32 v10, 0, v9
    v_add_f32 v11, v11, v12
    ds_read_b32 v37, v36 offset:588
    s_waitcnt vmcnt(31)
    buffer_load_dwordx4 v[176:179], v4, s[36:39], s44 offen offset:0 nt
    v_dot2_f32_bf16 v13, v180, v20, v13
    v_dot2_f32_bf16 v14, v181, v21, v14
    v_dot2_f32_bf16 v13, v182, v22, v13
    v_dot2_f32_bf16 v14, v183, v23, v14
    v_max_f32 v8, v8, v10
    ds_write_b32 v6, v10 offset:1536
    v_add_f32_dpp v9, v11, v11 row_half_mirror row_mask:0xf bank_mask:0x5
    s_waitcnt vmcnt(31)
    buffer_load_dwordx4 v[180:183], v4, s[36:39], s44 offen offset:128 nt
    v_dot2_f32_bf16 v13, v184, v24, v13
    v_dot2_f32_bf16 v14, v185, v25, v14
    v_dot2_f32_bf16 v13, v186, v26, v13
    v_dot2_f32_bf16 v14, v187, v27, v14
    s_waitcnt vmcnt(31)
    buffer_load_dwordx4 v[184:187], v4, s[36:39], s44 offen offset:256 nt
    v_dot2_f32_bf16 v13, v188, v28, v13
    v_dot2_f32_bf16 v14, v189, v29, v14
    v_dot2_f32_bf16 v13, v190, v30, v13
    v_dot2_f32_bf16 v14, v191, v31, v14
    s_waitcnt lgkmcnt(0)
    v_readfirstlane_b32 s48, v37
    s_cmp_eq_u32 s48, 0
    s_cbranch_scc1 L_kloopm0
    s_cmp_eq_u32 s48, 1
    s_cbranch_scc1 L_kloopm1
L_kloopm2:
    s_waitcnt vmcnt(31)
    buffer_load_dwordx4 v[188:191], v4, s[36:39], s44 offen offset:384 nt
    s_add_u32 s44, s44, 4096
    s_and_b32 s44, s44, 0xfffff
    v_dot2_f32_bf16 v11, v192, v16, 0
    v_dot2_f32_bf16 v12, v193, v17, 0
    v_dot2_f32_bf16 v11, v194, v18, v11
    v_dot2_f32_bf16 v12, v195, v19, v12
    v_add_f32 v13, v13, v14
    s_waitcnt vmcnt(31)
    buffer_load_dwordx4 v[192:195], v4, s[36:39], s44 offen offset:0 nt
    v_dot2_f32_bf16 v11, v196, v20, v11
    v_dot2_f32_bf16 v12, v197, v21, v12
    v_dot2_f32_bf16 v11, v198, v22, v11
    v_dot2_f32_bf16 v12, v199, v23, v12
    v_add_f32_dpp v9, v13, v13 row_half_mirror row_mask:0xf bank_mask:0xa
    s_waitcnt vmcnt(31)
    buffer_load_dwordx4 v[196:199], v4, s[36:39], s44 offen offset:128 nt
    v_dot2_f32_bf16 v11, v200, v24, v11
    v_dot2_f32_bf16 v12, v201, v25, v12
    v_dot2_f32_bf16 v11, v202, v26, v11
    v_dot2_f32_bf16 v12, v203, v27, v12
    v_add_f32_dpp v9, v9, v9 quad_perm:[1,0,3,2] row_mask:0xf bank_mask:0xf
    s_waitcnt vmcnt(31)
    buffer_load_dwordx4 v[200:203], v4, s[36:39], s44 offen offset:256 nt
    v_dot2_f32_bf16 v11, v204, v28, v11
    v_dot2_f32_bf16 v12, v205, v29, v12
    v_dot2_f32_bf16 v11, v206, v30, v11
    v_dot2_f32_bf16 v12, v207, v31, v12
    v_add_f32_dpp v9, v9, v9 quad_perm:[2,3,0,1] row_mask:0xf bank_mask:0xf
    s_waitcnt vmcnt(31)
    buffer_load_dwordx4 v[204:207], v4, s[36:39], s44 offen offset:384 nt
    s_add_u32 s44, s44, 4096
    s_and_b32 s44, s44, 0xfffff
    v_dot2_f32_bf16 v13, v208, v16, 0
    v_dot2_f32_bf16 v14, v209, v17, 0
    v_dot2_f32_bf16 v13, v210, v18, v13
    v_dot2_f32_bf16 v14, v211, v19, v14
    v_cvt_pk_bf16_f32 v10, 0, v9
    v_add_f32 v11, v11, v12
    s_waitcnt vmcnt(31)
    buffer_load_dwordx4 v[208:211], v4, s[36:39], s44 offen offset:0 nt
    v_dot2_f32_bf16 v13, v212, v20, v13
    v_dot2_f32_bf16 v14, v213, v21, v14
    v_dot2_f32_bf16 v13, v214, v22, v13
    v_dot2_f32_bf16 v14, v215, v23, v14
    v_max_f32 v8, v8, v10
    ds_write_b32 v6, v10 offset:1544
    v_add_f32_dpp v9, v11, v11 row_half_mirror row_mask:0xf bank_mask:0x5
    s_waitcnt vmcnt(31)
    buffer_load_dwordx4 v[212:215], v4, s[36:39], s44 offen offset:128 nt
    v_dot2_f32_bf16 v13, v216, v24, v13
    v_dot2_f32_bf16 v14, v217, v25, v14
    v_dot2_f32_bf16 v13, v218, v26, v13
    v_dot2_f32_bf16 v14, v219, v27, v14
    s_waitcnt vmcnt(31)
    buffer_load_dwordx4 v[216:219], v4, s[36:39], s44 offen offset:256 nt
    v_dot2_f32_bf16 v13, v220, v28, v13
    v_dot2_f32_bf16 v14, v221, v29, v14
    v_dot2_f32_bf16 v13, v222, v30, v13
    v_dot2_f32_bf16 v14, v223, v31, v14
    s_waitcnt vmcnt(31)
    buffer_load_dwordx4 v[220:223], v4, s[36:39], s44 offen offset:384 nt
    s_add_u32 s44, s44, 4096
    s_and_b32 s44, s44, 0xfffff
    v_dot2_f32_bf16 v11, v224, v16, 0
    v_dot2_f32_bf16 v12, v225, v17, 0
    v_dot2_f32_bf16 v11, v226, v18, v11
    v_dot2_f32_bf16 v12, v227, v19, v12
    v_add_f32 v13, v13, v14
    s_waitcnt vmcnt(31)
    buffer_load_dwordx4 v[224:227], v4, s[36:39], s44 offen offset:0 nt
    v_dot2_f32_bf16 v11, v228, v20, v11
    v_dot2_f32_bf16 v12, v229, v21, v12
    v_dot2_f32_bf16 v11, v230, v22, v11
    v_dot2_f32_bf16 v12, v231, v23, v12
    v_add_f32_dpp v9, v13, v13 row_half_mirror row_mask:0xf bank_mask:0xa
    s_waitcnt vmcnt(31)
    buffer_load_dwordx4 v[228:231], v4, s[36:39], s44 offen offset:128 nt
    v_dot2_f32_bf16 v11, v232, v24, v11
    v_dot2_f32_bf16 v12, v233, v25, v12
    v_dot2_f32_bf16 v11, v234, v26, v11
    v_dot2_f32_bf16 v12, v235, v27, v12
    v_add_f32_dpp v9, v9, v9 quad_perm:[1,0,3,2] row_mask:0xf bank_mask:0xf
    s_waitcnt vmcnt(31)
    buffer_load_dwordx4 v[232:235], v4, s[36:39], s44 offen offset:256 nt
    v_dot2_f32_bf16 v11, v236, v28, v11
    v_dot2_f32_bf16 v12, v237, v29, v12
    v_dot2_f32_bf16 v11, v238, v30, v11
    v_dot2_f32_bf16 v12, v239, v31, v12
    v_add_f32_dpp v9, v9, v9 quad_perm:[2,3,0,1] row_mask:0xf bank_mask:0xf
    s_waitcnt vmcnt(31)
    buffer_load_dwordx4 v[236:239], v4, s[36:39], s44 offen offset:384 nt
    s_add_u32 s44, s44, 4096
    s_and_b32 s44, s44, 0xfffff
    v_dot2_f32_bf16 v13, v240, v16, 0
    v_dot2_f32_bf16 v14, v241, v17, 0
    v_dot2_f32_bf16 v13, v242, v18, v13
    v_dot2_f32_bf16 v14, v243, v19, v14
    v_cvt_pk_bf16_f32 v10, 0, v9
    v_add_f32 v11, v11, v12
    ds_read_b32 v37, v36 offset:588
    s_waitcnt vmcnt(31)
    buffer_load_dwordx4 v[240:243], v4, s[36:39], s44 offen offset:0 nt
    v_dot2_f32_bf16 v13, v244, v20, v13
    v_dot2_f32_bf16 v14, v245, v21, v14
    v_dot2_f32_bf16 v13, v246, v22, v13
    v_dot2_f32_bf16 v14, v247, v23, v14
    v_max_f32 v8, v8, v10
    ds_write_b32 v6, v10 offset:1552
    v_add_f32_dpp v9, v11, v11 row_half_mirror row_mask:0xf bank_mask:0x5
    s_waitcnt vmcnt(31)
    buffer_load_dwordx4 v[244:247], v4, s[36:39], s44 offen offset:128 nt
    v_dot2_f32_bf16 v13, v248, v24, v13
    v_dot2_f32_bf16 v14, v249, v25, v14
    v_dot2_f32_bf16 v13, v250, v26, v13
    v_dot2_f32_bf16 v14, v251, v27, v14
    s_waitcnt vmcnt(31)
    buffer_load_dwordx4 v[248:251], v4, s[36:39], s44 offen offset:256 nt
    v_dot2_f32_bf16 v13, v252, v28, v13
    v_dot2_f32_bf16 v14, v253, v29, v14
    v_dot2_f32_bf16 v13, v254, v30, v13
    v_dot2_f32_bf16 v14, v255, v31, v14
    v_add_u32 v6, 48, v6
    s_add_u32 s50, s50, 1
    v_mov_b32 v38, s50
    s_waitcnt lgkmcnt(0)
    v_readfirstlane_b32 s48, v37
    ds_write_b32 v36, v38 offset:584
    s_sub_u32 s46, s46, 1
    s_cmp_eq_u32 s46, 0
    s_cbranch_scc1 L_kloopx
    s_cmp_eq_u32 s48, 2
    s_cbranch_scc1 L_kloop2
    s_cmp_eq_u32 s48, 0
    s_cbranch_scc1 L_kloop0
    s_branch L_kloop1
L_kloopx:
    s_waitcnt vmcnt(23)
    buffer_load_dwordx4 v[252:255], v4, s[36:39], s44 offen offset:384 nt
    s_add_u32 s44, s44, 4096
    s_and_b32 s44, s44, 0xfffff
    v_dot2_f32_bf16 v11, v64, v16, 0
    v_dot2_f32_bf16 v12, v65, v17, 0
    v_dot2_f32_bf16 v11, v66, v18, v11
    v_dot2_f32_bf16 v12, v67, v19, v12
    v_add_f32 v13, v13, v14
    s_waitcnt vmcnt(23)
    buffer_load_dwordx4 v[64:67], v4, s[36:39], s44 offen offset:0 nt
    v_dot2_f32_bf16 v11, v68, v20, v11
    v_dot2_f32_bf16 v12, v69, v21, v12
    v_dot2_f32_bf16 v11, v70, v22, v11
    v_dot2_f32_bf16 v12, v71, v23, v12
    v_add_f32_dpp v9, v13, v13 row_half_mirror row_mask:0xf bank_mask:0xa
    s_waitcnt vmcnt(23)
    buffer_load_dwordx4 v[68:71], v4, s[36:39], s44 offen offset:128 nt
    v_dot2_f32_bf16 v11, v72, v24, v11
    v_dot2_f32_bf16 v12, v73, v25, v12
    v_dot2_f32_bf16 v11, v74, v26, v11
    v_dot2_f32_bf16 v12, v75, v27, v12
    v_add_f32_dpp v9, v9, v9 quad_perm:[1,0,3,2] row_mask:0xf bank_mask:0xf
    s_waitcnt vmcnt(23)
    buffer_load_dwordx4 v[72:75], v4, s[36:39], s44 offen offset:256 nt
    v_dot2_f32_bf16 v11, v76, v28, v11
    v_dot2_f32_bf16 v12, v77, v29, v12
    v_dot2_f32_bf16 v11, v78, v30, v11
    v_dot2_f32_bf16 v12, v79, v31, v12
    v_add_f32_dpp v9, v9, v9 quad_perm:[2,3,0,1] row_mask:0xf bank_mask:0xf
    s_waitcnt vmcnt(23)
    buffer_load_dwordx4 v[76:79], v4, s[36:39], s44 offen offset:384 nt
    s_add_u32 s44, s44, 4096
    s_and_b32 s44, s44, 0xfffff
    v_dot2_f32_bf16 v13, v80, v16, 0
    v_dot2_f32_bf16 v14, v81, v17, 0
    v_dot2_f32_bf16 v13, v82, v18, v13
    v_dot2_f32_bf16 v14, v83, v19, v14
    v_cvt_pk_bf16_f32 v10, 0, v9
    v_add_f32 v11, v11, v12
    s_waitcnt vmcnt(23)
    buffer_load_dwordx4 v[80:83], v4, s[36:39], s44 offen offset:0 nt
    v_dot2_f32_bf16 v13, v84, v20, v13
    v_dot2_f32_bf16 v14, v85, v21, v14
    v_dot2_f32_bf16 v13, v86, v22, v13
    v_dot2_f32_bf16 v14, v87, v23, v14
    v_max_f32 v8, v8, v10
    ds_write_b32 v6, v10 offset:1512
    v_add_f32_dpp v9, v11, v11 row_half_mirror row_mask:0xf bank_mask:0x5
    s_waitcnt vmcnt(23)
    buffer_load_dwordx4 v[84:87], v4, s[36:39], s44 offen offset:128 nt
    v_dot2_f32_bf16 v13, v88, v24, v13
    v_dot2_f32_bf16 v14, v89, v25, v14
    v_dot2_f32_bf16 v13, v90, v26, v13
    v_dot2_f32_bf16 v14, v91, v27, v14
    s_waitcnt vmcnt(23)
    buffer_load_dwordx4 v[88:91], v4, s[36:39], s44 offen offset:256 nt
    v_dot2_f32_bf16 v13, v92, v28, v13
    v_dot2_f32_bf16 v14, v93, v29, v14
    v_dot2_f32_bf16 v13, v94, v30, v13
    v_dot2_f32_bf16 v14, v95, v31, v14
    s_waitcnt vmcnt(23)
    buffer_load_dwordx4 v[92:95], v4, s[36:39], s44 offen offset:384 nt
    s_add_u32 s44, s44, 4096
    s_and_b32 s44, s44, 0xfffff
    v_dot2_f32_bf16 v11, v96, v16, 0
    v_dot2_f32_bf16 v12, v97, v17, 0
    v_dot2_f32_bf16 v11, v98, v18, v11
    v_dot2_f32_bf16 v12, v99, v19, v12
    v_add_f32 v13, v13, v14
    s_waitcnt vmcnt(23)
    buffer_load_dwordx4 v[96:99], v4, s[36:39], s44 offen offset:0 nt
    v_dot2_f32_bf16 v11, v100, v20, v11
    v_dot2_f32_bf16 v12, v101, v21, v12
    v_dot2_f32_bf16 v11, v102, v22, v11
    v_dot2_f32_bf16 v12, v103, v23, v12
    v_add_f32_dpp v9, v13, v13 row_half_mirror row_mask:0xf bank_mask:0xa
    s_waitcnt vmcnt(23)
    buffer_load_dwordx4 v[100:103], v4, s[36:39], s44 offen offset:128 nt
    v_dot2_f32_bf16 v11, v104, v24, v11
    v_dot2_f32_bf16 v12, v105, v25, v12
    v_dot2_f32_bf16 v11, v106, v26, v11
    v_dot2_f32_bf16 v12, v107, v27, v12
    v_add_f32_dpp v9, v9, v9 quad_perm:[1,0,3,2] row_mask:0xf bank_mask:0xf
    s_waitcnt vmcnt(23)
    buffer_load_dwordx4 v[104:107], v4, s[36:39], s44 offen offset:256 nt
    v_dot2_f32_bf16 v11, v108, v28, v11
    v_dot2_f32_bf16 v12, v109, v29, v12
    v_dot2_f32_bf16 v11, v110, v30, v11
    v_dot2_f32_bf16 v12, v111, v31, v12
    v_add_f32_dpp v9, v9, v9 quad_perm:[2,3,0,1] row_mask:0xf bank_mask:0xf
    s_waitcnt vmcnt(23)
    buffer_load_dwordx4 v[108:111], v4, s[36:39], s44 offen offset:384 nt
    s_add_u32 s44, s44, 4096
    s_and_b32 s44, s44, 0xfffff
    v_dot2_f32_bf16 v13, v112, v16, 0
    v_dot2_f32_bf16 v14, v113, v17, 0
    v_dot2_f32_bf16 v13, v114, v18, v13
    v_dot2_f32_bf16 v14, v115, v19, v14
    v_cvt_pk_bf16_f32 v10, 0, v9
    v_add_f32 v11, v11, v12
    s_waitcnt vmcnt(23)
    buffer_load_dwordx4 v[112:115], v4, s[36:39], s44 offen offset:0 nt
    v_dot2_f32_bf16 v13, v116, v20, v13
    v_dot2_f32_bf16 v14, v117, v21, v14
    v_dot2_f32_bf16 v13, v118, v22, v13
    v_dot2_f32_bf16 v14, v119, v23, v14
    v_max_f32 v8, v8, v10
    ds_write_b32 v6, v10 offset:1520
    v_add_f32_dpp v9, v11, v11 row_half_mirror row_mask:0xf bank_mask:0x5
    s_waitcnt vmcnt(23)
    buffer_load_dwordx4 v[116:119], v4, s[36:39], s44 offen offset:128 nt
    v_dot2_f32_bf16 v13, v120, v24, v13
    v_dot2_f32_bf16 v14, v121, v25, v14
    v_dot2_f32_bf16 v13, v122, v26, v13
    v_dot2_f32_bf16 v14, v123, v27, v14
    s_waitcnt vmcnt(23)
    buffer_load_dwordx4 v[120:123], v4, s[36:39], s44 offen offset:256 nt
    v_dot2_f32_bf16 v13, v124, v28, v13
    v_dot2_f32_bf16 v14, v125, v29, v14
    v_dot2_f32_bf16 v13, v126, v30, v13
    v_dot2_f32_bf16 v14, v127, v31, v14
    s_waitcnt vmcnt(23)
    buffer_load_dwordx4 v[124:127], v4, s[36:39], s44 offen offset:384 nt
    s_add_u32 s44, s44, 4096
    s_and_b32 s44, s44, 0xfffff
    v_dot2_f32_bf16 v11, v128, v16, 0
    v_dot2_f32_bf16 v12, v129, v17, 0
    v_dot2_f32_bf16 v11, v130, v18, v11
    v_dot2_f32_bf16 v12, v131, v19, v12
    v_add_f32 v13, v13, v14
    s_waitcnt vmcnt(23)
    buffer_load_dwordx4 v[128:131], v5, s[40:43], s45 offen offset:0 nt
    v_dot2_f32_bf16 v11, v132, v20, v11
    v_dot2_f32_bf16 v12, v133, v21, v12
    v_dot2_f32_bf16 v11, v134, v22, v11
    v_dot2_f32_bf16 v12, v135, v23, v12
    v_add_f32_dpp v9, v13, v13 row_half_mirror row_mask:0xf bank_mask:0xa
    s_waitcnt vmcnt(23)
    buffer_load_dwordx4 v[132:135], v5, s[40:43], s45 offen offset:128 nt
    v_dot2_f32_bf16 v11, v136, v24, v11
    v_dot2_f32_bf16 v12, v137, v25, v12
    v_dot2_f32_bf16 v11, v138, v26, v11
    v_dot2_f32_bf16 v12, v139, v27, v12
    v_add_f32_dpp v9, v9, v9 quad_perm:[1,0,3,2] row_mask:0xf bank_mask:0xf
    s_waitcnt vmcnt(23)
    buffer_load_dwordx4 v[136:139], v5, s[40:43], s45 offen offset:256 nt
    v_dot2_f32_bf16 v11, v140, v28, v11
    v_dot2_f32_bf16 v12, v141, v29, v12
    v_dot2_f32_bf16 v11, v142, v30, v11
    v_dot2_f32_bf16 v12, v143, v31, v12
    v_add_f32_dpp v9, v9, v9 quad_perm:[2,3,0,1] row_mask:0xf bank_mask:0xf
    s_waitcnt vmcnt(23)
    buffer_load_dwordx4 v[140:143], v5, s[40:43], s45 offen offset:384 nt
    s_add_u32 s45, s45, 4096
    s_and_b32 s45, s45, 0xfffff
    v_dot2_f32_bf16 v13, v144, v16, 0
    v_dot2_f32_bf16 v14, v145, v17, 0
    v_dot2_f32_bf16 v13, v146, v18, v13
    v_dot2_f32_bf16 v14, v147, v19, v14
    v_cvt_pk_bf16_f32 v10, 0, v9
    v_add_f32 v11, v11, v12
    s_waitcnt vmcnt(23)
    buffer_load_dwordx4 v[144:147], v5, s[40:43], s45 offen offset:0 nt
    v_dot2_f32_bf16 v13, v148, v20, v13
    v_dot2_f32_bf16 v14, v149, v21, v14
    v_dot2_f32_bf16 v13, v150, v22, v13
    v_dot2_f32_bf16 v14, v151, v23, v14
    v_max_f32 v8, v8, v10
    ds_write_b32 v6, v10 offset:1528
    v_add_f32_dpp v9, v11, v11 row_half_mirror row_mask:0xf bank_mask:0x5
    s_waitcnt vmcnt(23)
    buffer_load_dwordx4 v[148:151], v5, s[40:43], s45 offen offset:128 nt
    v_dot2_f32_bf16 v13, v152, v24, v13
    v_dot2_f32_bf16 v14, v153, v25, v14
    v_dot2_f32_bf16 v13, v154, v26, v13
    v_dot2_f32_bf16 v14, v155, v27, v14
    s_waitcnt vmcnt(23)
    buffer_load_dwordx4 v[152:155], v5, s[40:43], s45 offen offset:256 nt
    v_dot2_f32_bf16 v13, v156, v28, v13
    v_dot2_f32_bf16 v14, v157, v29, v14
    v_dot2_f32_bf16 v13, v158, v30, v13
    v_dot2_f32_bf16 v14, v159, v31, v14
    s_waitcnt vmcnt(23)
    buffer_load_dwordx4 v[156:159], v5, s[40:43], s45 offen offset:384 nt
    s_add_u32 s45, s45, 4096
    s_and_b32 s45, s45, 0xfffff
    v_dot2_f32_bf16 v11, v160, v16, 0
    v_dot2_f32_bf16 v12, v161, v17, 0
    v_dot2_f32_bf16 v11, v162, v18, v11
    v_dot2_f32_bf16 v12, v163, v19, v12
    v_add_f32 v13, v13, v14
    s_waitcnt vmcnt(23)
    buffer_load_dwordx4 v[160:163], v5, s[40:43], s45 offen offset:0 nt
    v_dot2_f32_bf16 v11, v164, v20, v11
    v_dot2_f32_bf16 v12, v165, v21, v12
    v_dot2_f32_bf16 v11, v166, v22, v11
    v_dot2_f32_bf16 v12, v167, v23, v12
    v_add_f32_dpp v9, v13, v13 row_half_mirror row_mask:0xf bank_mask:0xa
    s_waitcnt vmcnt(23)
    buffer_load_dwordx4 v[164:167], v5, s[40:43], s45 offen offset:128 nt
    v_dot2_f32_bf16 v11, v168, v24, v11
    v_dot2_f32_bf16 v12, v169, v25, v12
    v_dot2_f32_bf16 v11, v170, v26, v11
    v_dot2_f32_bf16 v12, v171, v27, v12
    v_add_f32_dpp v9, v9, v9 quad_perm:[1,0,3,2] row_mask:0xf bank_mask:0xf
    s_waitcnt vmcnt(23)
    buffer_load_dwordx4 v[168:171], v5, s[40:43], s45 offen offset:256 nt
    v_dot2_f32_bf16 v11, v172, v28, v11
    v_dot2_f32_bf16 v12, v173, v29, v12
    v_dot2_f32_bf16 v11, v174, v30, v11
    v_dot2_f32_bf16 v12, v175, v31, v12
    v_add_f32_dpp v9, v9, v9 quad_perm:[2,3,0,1] row_mask:0xf bank_mask:0xf
    s_waitcnt vmcnt(23)
    buffer_load_dwordx4 v[172:175], v5, s[40:43], s45 offen offset:384 nt
    s_add_u32 s45, s45, 4096
    s_and_b32 s45, s45, 0xfffff
    v_dot2_f32_bf16 v13, v176, v16, 0
    v_dot2_f32_bf16 v14, v177, v17, 0
    v_dot2_f32_bf16 v13, v178, v18, v13
    v_dot2_f32_bf16 v14, v179, v19, v14
    v_cvt_pk_bf16_f32 v10, 0, v9
    v_add_f32 v11, v11, v12
    s_waitcnt vmcnt(23)
    buffer_load_dwordx4 v[176:179], v5, s[40:43], s45 offen offset:0 nt
    v_dot2_f32_bf16 v13, v180, v20, v13
    v_dot2_f32_bf16 v14, v181, v21, v14
    v_dot2_f32_bf16 v13, v182, v22, v13
    v_dot2_f32_bf16 v14, v183, v23, v14
    v_max_f32 v8, v8, v10
    ds_write_b32 v6, v10 offset:1536
    v_add_f32_dpp v9, v11, v11 row_half_mirror row_mask:0xf bank_mask:0x5
    s_waitcnt vmcnt(23)
    buffer_load_dwordx4 v[180:183], v5, s[40:43], s45 offen offset:128 nt
    v_dot2_f32_bf16 v13, v184, v24, v13
    v_dot2_f32_bf16 v14, v185, v25, v14
    v_dot2_f32_bf16 v13, v186, v26, v13
    v_dot2_f32_bf16 v14, v187, v27, v14
    s_waitcnt vmcnt(23)
    buffer_load_dwordx4 v[184:187], v5, s[40:43], s45 offen offset:256 nt
    v_dot2_f32_bf16 v13, v188, v28, v13
    v_dot2_f32_bf16 v14, v189, v29, v14
    v_dot2_f32_bf16 v13, v190, v30, v13
    v_dot2_f32_bf16 v14, v191, v31, v14
    s_waitcnt vmcnt(23)
    buffer_load_dwordx4 v[188:191], v5, s[40:43], s45 offen offset:384 nt
    s_add_u32 s45, s45, 4096
    s_and_b32 s45, s45, 0xfffff
    v_dot2_f32_bf16 v11, v192, v16, 0
    v_dot2_f32_bf16 v12, v193, v17, 0
    v_dot2_f32_bf16 v11, v194, v18, v11
    v_dot2_f32_bf16 v12, v195, v19, v12
    v_add_f32 v13, v13, v14
    s_waitcnt vmcnt(23)
    buffer_load_dwordx4 v[192:195], v5, s[40:43], s45 offen offset:0 nt
    v_dot2_f32_bf16 v11, v196, v20, v11
    v_dot2_f32_bf16 v12, v197, v21, v12
    v_dot2_f32_bf16 v11, v198, v22, v11
    v_dot2_f32_bf16 v12, v199, v23, v12
    v_add_f32_dpp v9, v13, v13 row_half_mirror row_mask:0xf bank_mask:0xa
    s_waitcnt vmcnt(23)
    buffer_load_dwordx4 v[196:199], v5, s[40:43], s45 offen offset:128 nt
    v_dot2_f32_bf16 v11, v200, v24, v11
    v_dot2_f32_bf16 v12, v201, v25, v12
    v_dot2_f32_bf16 v11, v202, v26, v11
    v_dot2_f32_bf16 v12, v203, v27, v12
    v_add_f32_dpp v9, v9, v9 quad_perm:[1,0,3,2] row_mask:0xf bank_mask:0xf
    s_waitcnt vmcnt(23)
    buffer_load_dwordx4 v[200:203], v5, s[40:43], s45 offen offset:256 nt
    v_dot2_f32_bf16 v11, v204, v28, v11
    v_dot2_f32_bf16 v12, v205, v29, v12
    v_dot2_f32_bf16 v11, v206, v30, v11
    v_dot2_f32_bf16 v12, v207, v31, v12
    v_add_f32_dpp v9, v9, v9 quad_perm:[2,3,0,1] row_mask:0xf bank_mask:0xf
    s_waitcnt vmcnt(23)
    buffer_load_dwordx4 v[204:207], v5, s[40:43], s45 offen offset:384 nt
    s_add_u32 s45, s45, 4096
    s_and_b32 s45, s45, 0xfffff
    v_dot2_f32_bf16 v13, v208, v16, 0
    v_dot2_f32_bf16 v14, v209, v17, 0
    v_dot2_f32_bf16 v13, v210, v18, v13
    v_dot2_f32_bf16 v14, v211, v19, v14
    v_cvt_pk_bf16_f32 v10, 0, v9
    v_add_f32 v11, v11, v12
    s_waitcnt vmcnt(23)
    buffer_load_dwordx4 v[208:211], v5, s[40:43], s45 offen offset:0 nt
    v_dot2_f32_bf16 v13, v212, v20, v13
    v_dot2_f32_bf16 v14, v213, v21, v14
    v_dot2_f32_bf16 v13, v214, v22, v13
    v_dot2_f32_bf16 v14, v215, v23, v14
    v_max_f32 v8, v8, v10
    ds_write_b32 v6, v10 offset:1544
    v_add_f32_dpp v9, v11, v11 row_half_mirror row_mask:0xf bank_mask:0x5
    s_waitcnt vmcnt(23)
    buffer_load_dwordx4 v[212:215], v5, s[40:43], s45 offen offset:128 nt
    v_dot2_f32_bf16 v13, v216, v24, v13
    v_dot2_f32_bf16 v14, v217, v25, v14
    v_dot2_f32_bf16 v13, v218, v26, v13
    v_dot2_f32_bf16 v14, v219, v27, v14
    s_waitcnt vmcnt(23)
    buffer_load_dwordx4 v[216:219], v5, s[40:43], s45 offen offset:256 nt
    v_dot2_f32_bf16 v13, v220, v28, v13
    v_dot2_f32_bf16 v14, v221, v29, v14
    v_dot2_f32_bf16 v13, v222, v30, v13
    v_dot2_f32_bf16 v14, v223, v31, v14
    s_waitcnt vmcnt(23)
    buffer_load_dwordx4 v[220:223], v5, s[40:43], s45 offen offset:384 nt
    s_add_u32 s45, s45, 4096
    s_and_b32 s45, s45, 0xfffff
    v_dot2_f32_bf16 v11, v224, v16, 0
    v_dot2_f32_bf16 v12, v225, v17, 0
    v_dot2_f32_bf16 v11, v226, v18, v11
    v_dot2_f32_bf16 v12, v227, v19, v12
    v_add_f32 v13, v13, v14
    s_waitcnt vmcnt(23)
    buffer_load_dwordx4 v[224:227], v5, s[40:43], s45 offen offset:0 nt
    v_dot2_f32_bf16 v11, v228, v20, v11
    v_dot2_f32_bf16 v12, v229, v21, v12
    v_dot2_f32_bf16 v11, v230, v22, v11
    v_dot2_f32_bf16 v12, v231, v23, v12
    v_add_f32_dpp v9, v13, v13 row_half_mirror row_mask:0xf bank_mask:0xa
    s_waitcnt vmcnt(23)
    buffer_load_dwordx4 v[228:231], v5, s[40:43], s45 offen offset:128 nt
    v_dot2_f32_bf16 v11, v232, v24, v11
    v_dot2_f32_bf16 v12, v233, v25, v12
    v_dot2_f32_bf16 v11, v234, v26, v11
    v_dot2_f32_bf16 v12, v235, v27, v12
    v_add_f32_dpp v9, v9, v9 quad_perm:[1,0,3,2] row_mask:0xf bank_mask:0xf
    s_waitcnt vmcnt(23)
    buffer_load_dwordx4 v[232:235], v5, s[40:43], s45 offen offset:256 nt
    v_dot2_f32_bf16 v11, v236, v28, v11
    v_dot2_f32_bf16 v12, v237, v29, v12
    v_dot2_f32_bf16 v11, v238, v30, v11
    v_dot2_f32_bf16 v12, v239, v31, v12
    v_add_f32_dpp v9, v9, v9 quad_perm:[2,3,0,1] row_mask:0xf bank_mask:0xf
    s_waitcnt vmcnt(23)
    buffer_load_dwordx4 v[236:239], v5, s[40:43], s45 offen offset:384 nt
    s_add_u32 s45, s45, 4096
    s_and_b32 s45, s45, 0xfffff
    v_dot2_f32_bf16 v13, v240, v16, 0
    v_dot2_f32_bf16 v14, v241, v17, 0
    v_dot2_f32_bf16 v13, v242, v18, v13
    v_dot2_f32_bf16 v14, v243, v19, v14
    v_cvt_pk_bf16_f32 v10, 0, v9
    v_add_f32 v11, v11, v12
    s_waitcnt vmcnt(23)
    buffer_load_dwordx4 v[240:243], v5, s[40:43], s45 offen offset:0 nt
    v_dot2_f32_bf16 v13, v244, v20, v13
    v_dot2_f32_bf16 v14, v245, v21, v14
    v_dot2_f32_bf16 v13, v246, v22, v13
    v_dot2_f32_bf16 v14, v247, v23, v14
    v_max_f32 v8, v8, v10
    ds_write_b32 v6, v10 offset:1552
    v_add_f32_dpp v9, v11, v11 row_half_mirror row_mask:0xf bank_mask:0x5
    s_waitcnt vmcnt(23)
    buffer_load_dwordx4 v[244:247], v5, s[40:43], s45 offen offset:128 nt
    v_dot2_f32_bf16 v13, v248, v24, v13
    v_dot2_f32_bf16 v14, v249, v25, v14
    v_dot2_f32_bf16 v13, v250, v26, v13
    v_dot2_f32_bf16 v14, v251, v27, v14
    s_waitcnt vmcnt(23)
    buffer_load_dwordx4 v[248:251], v5, s[40:43], s45 offen offset:256 nt
    v_dot2_f32_bf16 v13, v252, v28, v13
    v_dot2_f32_bf16 v14, v253, v29, v14
    v_dot2_f32_bf16 v13, v254, v30, v13
    v_dot2_f32_bf16 v14, v255, v31, v14
    s_waitcnt vmcnt(23)
    buffer_load_dwordx4 v[252:255], v5, s[40:43], s45 offen offset:384 nt
    s_add_u32 s45, s45, 4096
    s_and_b32 s45, s45, 0xfffff
    v_dot2_f32_bf16 v11, v64, v16, 0
    v_dot2_f32_bf16 v12, v65, v17, 0
    v_dot2_f32_bf16 v11, v66, v18, v11
    v_dot2_f32_bf16 v12, v67, v19, v12
    v_add_f32 v13, v13, v14
    s_waitcnt vmcnt(23)
    buffer_load_dwordx4 v[64:67], v5, s[40:43], s45 offen offset:0 nt
    v_dot2_f32_bf16 v11, v68, v20, v11
    v_dot2_f32_bf16 v12, v69, v21, v12
    v_dot2_f32_bf16 v11, v70, v22, v11
    v_dot2_f32_bf16 v12, v71, v23, v12
    v_add_f32_dpp v9, v13, v13 row_half_mirror row_mask:0xf bank_mask:0xa
    s_waitcnt vmcnt(23)
    buffer_load_dwordx4 v[68:71], v5, s[40:43], s45 offen offset:128 nt
    v_dot2_f32_bf16 v11, v72, v24, v11
    v_dot2_f32_bf16 v12, v73, v25, v12
    v_dot2_f32_bf16 v11, v74, v26, v11
    v_dot2_f32_bf16 v12, v75, v27, v12
    v_add_f32_dpp v9, v9, v9 quad_perm:[1,0,3,2] row_mask:0xf bank_mask:0xf
    s_waitcnt vmcnt(23)
    buffer_load_dwordx4 v[72:75], v5, s[40:43], s45 offen offset:256 nt
    v_dot2_f32_bf16 v11, v76, v28, v11
    v_dot2_f32_bf16 v12, v77, v29, v12
    v_dot2_f32_bf16 v11, v78, v30, v11
    v_dot2_f32_bf16 v12, v79, v31, v12
    v_add_f32_dpp v9, v9, v9 quad_perm:[2,3,0,1] row_mask:0xf bank_mask:0xf
    s_waitcnt vmcnt(23)
    buffer_load_dwordx4 v[76:79], v5, s[40:43], s45 offen offset:384 nt
    s_add_u32 s45, s45, 4096
    s_and_b32 s45, s45, 0xfffff
    v_dot2_f32_bf16 v13, v80, v16, 0
    v_dot2_f32_bf16 v14, v81, v17, 0
    v_dot2_f32_bf16 v13, v82, v18, v13
    v_dot2_f32_bf16 v14, v83, v19, v14
    v_cvt_pk_bf16_f32 v10, 0, v9
    v_add_f32 v11, v11, v12
    s_waitcnt vmcnt(23)
    buffer_load_dwordx4 v[80:83], v5, s[40:43], s45 offen offset:0 nt
    v_dot2_f32_bf16 v13, v84, v20, v13
    v_dot2_f32_bf16 v14, v85, v21, v14
    v_dot2_f32_bf16 v13, v86, v22, v13
    v_dot2_f32_bf16 v14, v87, v23, v14
    v_max_f32 v8, v8, v10
    ds_write_b32 v6, v10 offset:1560
    v_add_f32_dpp v9, v11, v11 row_half_mirror row_mask:0xf bank_mask:0x5
    s_waitcnt vmcnt(23)
    buffer_load_dwordx4 v[84:87], v5, s[40:43], s45 offen offset:128 nt
    v_dot2_f32_bf16 v13, v88, v24, v13
    v_dot2_f32_bf16 v14, v89, v25, v14
    v_dot2_f32_bf16 v13, v90, v26, v13
    v_dot2_f32_bf16 v14, v91, v27, v14
    s_waitcnt vmcnt(23)
    buffer_load_dwordx4 v[88:91], v5, s[40:43], s45 offen offset:256 nt
    v_dot2_f32_bf16 v13, v92, v28, v13
    v_dot2_f32_bf16 v14, v93, v29, v14
    v_dot2_f32_bf16 v13, v94, v30, v13
    v_dot2_f32_bf16 v14, v95, v31, v14
    s_waitcnt vmcnt(23)
    buffer_load_dwordx4 v[92:95], v5, s[40:43], s45 offen offset:384 nt
    s_add_u32 s45, s45, 4096
    s_and_b32 s45, s45, 0xfffff
    v_dot2_f32_bf16 v11, v96, v16, 0
    v_dot2_f32_bf16 v12, v97, v17, 0
    v_dot2_f32_bf16 v11, v98, v18, v11
    v_dot2_f32_bf16 v12, v99, v19, v12
    v_add_f32 v13, v13, v14
    s_waitcnt vmcnt(23)
    buffer_load_dwordx4 v[96:99], v5, s[40:43], s45 offen offset:0 nt
    v_dot2_f32_bf16 v11, v100, v20, v11
    v_dot2_f32_bf16 v12, v101, v21, v12
    v_dot2_f32_bf16 v11, v102, v22, v11
    v_dot2_f32_bf16 v12, v103, v23, v12
    v_add_f32_dpp v9, v13, v13 row_half_mirror row_mask:0xf bank_mask:0xa
    s_waitcnt vmcnt(23)
    buffer_load_dwordx4 v[100:103], v5, s[40:43], s45 offen offset:128 nt
    v_dot2_f32_bf16 v11, v104, v24, v11
    v_dot2_f32_bf16 v12, v105, v25, v12
    v_dot2_f32_bf16 v11, v106, v26, v11
    v_dot2_f32_bf16 v12, v107, v27, v12
    v_add_f32_dpp v9, v9, v9 quad_perm:[1,0,3,2] row_mask:0xf bank_mask:0xf
    s_waitcnt vmcnt(23)
    buffer_load_dwordx4 v[104:107], v5, s[40:43], s45 offen offset:256 nt
    v_dot2_f32_bf16 v11, v108, v28, v11
    v_dot2_f32_bf16 v12, v109, v29, v12
    v_dot2_f32_bf16 v11, v110, v30, v11
    v_dot2_f32_bf16 v12, v111, v31, v12
    v_add_f32_dpp v9, v9, v9 quad_perm:[2,3,0,1] row_mask:0xf bank_mask:0xf
    s_waitcnt vmcnt(23)
    buffer_load_dwordx4 v[108:111], v5, s[40:43], s45 offen offset:384 nt
    s_add_u32 s45, s45, 4096
    s_and_b32 s45, s45, 0xfffff
    v_dot2_f32_bf16 v13, v112, v16, 0
    v_dot2_f32_bf16 v14, v113, v17, 0
    v_dot2_f32_bf16 v13, v114, v18, v13
    v_dot2_f32_bf16 v14, v115, v19, v14
    v_cvt_pk_bf16_f32 v10, 0, v9
    v_add_f32 v11, v11, v12
    s_waitcnt vmcnt(23)
    buffer_load_dwordx4 v[112:115], v5, s[40:43], s45 offen offset:0 nt
    v_dot2_f32_bf16 v13, v116, v20, v13
    v_dot2_f32_bf16 v14, v117, v21, v14
    v_dot2_f32_bf16 v13, v118, v22, v13
    v_dot2_f32_bf16 v14, v119, v23, v14
    v_max_f32 v8, v8, v10
    ds_write_b32 v6, v10 offset:1568
    v_add_f32_dpp v9, v11, v11 row_half_mirror row_mask:0xf bank_mask:0x5
    s_waitcnt vmcnt(23)
    buffer_load_dwordx4 v[116:119], v5, s[40:43], s45 offen offset:128 nt
    v_dot2_f32_bf16 v13, v120, v24, v13
    v_dot2_f32_bf16 v14, v121, v25, v14
    v_dot2_f32_bf16 v13, v122, v26, v13
    v_dot2_f32_bf16 v14, v123, v27, v14
    s_waitcnt vmcnt(23)
    buffer_load_dwordx4 v[120:123], v5, s[40:43], s45 offen offset:256 nt
    v_dot2_f32_bf16 v13, v124, v28, v13
    v_dot2_f32_bf16 v14, v125, v29, v14
    v_dot2_f32_bf16 v13, v126, v30, v13
    v_dot2_f32_bf16 v14, v127, v31, v14
    s_nop 2
    v_add_f32 v13, v13, v14
    s_nop 1
    v_add_f32_dpp v9, v13, v13 row_half_mirror row_mask:0xf bank_mask:0xa
    s_nop 1
    v_add_f32_dpp v9, v9, v9 quad_perm:[1,0,3,2] row_mask:0xf bank_mask:0xf
    s_nop 1
    v_add_f32_dpp v9, v9, v9 quad_perm:[2,3,0,1] row_mask:0xf bank_mask:0xf
    v_cvt_pk_bf16_f32 v10, 0, v9
    v_max_f32 v8, v8, v10
    ds_write_b32 v6, v10 offset:1576
    s_nop 1
    v_max_f32_dpp v8, v8, v8 row_ror:4 row_mask:0xf bank_mask:0xf
    s_nop 1
    v_max_f32_dpp v8, v8, v8 row_ror:8 row_mask:0xf bank_mask:0xf
    v_lshrrev_b32 v9, 4, v0
    v_lshlrev_b32 v9, 2, v9
    ds_write_b32 v9, v8 offset:512
    v_and_b32 v52, 1, v3
    v_lshlrev_b32 v52, 4, v52
    v_mov_b32 v53, 0xffff
    v_lshlrev_b32 v52, v52, v53
    v_lshrrev_b32 v53, 1, v3
    v_cmp_eq_u32 vcc, 0, v53
    s_nop 1
    v_cndmask_b32 v12, 0, v52, vcc
    v_cmp_eq_u32 vcc, 1, v53
    s_nop 1
    v_cndmask_b32 v13, 0, v52, vcc
    v_cmp_eq_u32 vcc, 2, v53
    s_nop 1
    v_cndmask_b32 v14, 0, v52, vcc
    v_cmp_eq_u32 vcc, 3, v53
    s_nop 1
    v_cndmask_b32 v15, 0, v52, vcc
    v_mul_u32_u24 v7, 1040, v2
    v_mov_b32 v9, 0
    s_waitcnt lgkmcnt(0)
    s_barrier
    ds_read_b128 v[16:19], v9 offset:512
    ds_read_b128 v[20:23], v9 offset:528
    ds_read_b128 v[24:27], v9 offset:544
    ds_read_b128 v[28:31], v9 offset:560
    ds_read_b128 v[40:43], v7 offset:1280
    s_waitcnt vmcnt(23)
    buffer_load_dwordx4 v[124:127], v5, s[40:43], s45 offen offset:384 nt
    s_add_u32 s45, s45, 4096
    s_and_b32 s45, s45, 0xfffff
    s_waitcnt lgkmcnt(0)
    v_max3_f32 v11, v16, v17, v18
    v_max3_f32 v11, v11, v19, v20
    v_max3_f32 v11, v11, v21, v22
    v_max3_f32 v11, v11, v23, v24
    v_max3_f32 v11, v11, v25, v26
    v_max3_f32 v11, v11, v27, v28
    v_max3_f32 v11, v11, v29, v30
    v_max_f32 v11, v11, v31
    v_mul_f32 v11, s34, v11
    v_sub_f32 v11, 0, v11
    v_mov_b32 v16, 0
    v_mov_b32 v17, 0
    v_mov_b32 v18, 0
    v_mov_b32 v19, 0
    v_mov_b32 v20, 0
    v_mov_b32 v21, 0
    v_mov_b32 v22, 0
    v_mov_b32 v23, 0
    v_mov_b32 v24, 0
    v_mov_b32 v25, 0
    v_mov_b32 v26, 0
    v_mov_b32 v27, 0
    v_mov_b32 v28, 0
    v_mov_b32 v29, 0
    v_mov_b32 v30, 0
    v_mov_b32 v31, 0
    v_fma_f32 v9, v40, s34, v11
    v_exp_f32 v9, v9
    s_nop 0
    v_cvt_pk_bf16_f32 v10, v9, v9
    v_and_b32 v32, v10, v12
    v_and_b32 v33, v10, v13
    v_and_b32 v34, v10, v14
    v_and_b32 v35, v10, v15
    s_nop 1
    ds_read_b128 v[44:47], v7 offset:1296
    s_nop 0
    v_mfma_f32_16x16x32_bf16 v[16:19], v[128:131], v[32:35], v[16:19]
    v_fma_f32 v9, v41, s34, v11
    s_waitcnt vmcnt(23)
    buffer_load_dwordx4 v[128:131], v5, s[40:43], s45 offen offset:0 nt
    v_mfma_f32_16x16x32_bf16 v[20:23], v[132:135], v[32:35], v[20:23]
    v_exp_f32 v9, v9
    v_mfma_f32_16x16x32_bf16 v[24:27], v[136:139], v[32:35], v[24:27]
    v_cvt_pk_bf16_f32 v10, v9, v9
    v_and_b32 v36, v10, v12
    s_waitcnt vmcnt(23)
    buffer_load_dwordx4 v[132:135], v5, s[40:43], s45 offen offset:128 nt
    v_mfma_f32_16x16x32_bf16 v[28:31], v[140:143], v[32:35], v[28:31]
    v_and_b32 v37, v10, v13
    v_and_b32 v38, v10, v14
    v_and_b32 v39, v10, v15
    s_nop 1
    v_mfma_f32_16x16x32_bf16 v[16:19], v[144:147], v[36:39], v[16:19]
    v_fma_f32 v9, v42, s34, v11
    s_waitcnt vmcnt(23)
    buffer_load_dwordx4 v[136:139], v5, s[40:43], s45 offen offset:256 nt
    v_mfma_f32_16x16x32_bf16 v[20:23], v[148:151], v[36:39], v[20:23]
    v_exp_f32 v9, v9
    v_mfma_f32_16x16x32_bf16 v[24:27], v[152:155], v[36:39], v[24:27]
    v_cvt_pk_bf16_f32 v10, v9, v9
    v_and_b32 v32, v10, v12
    s_waitcnt vmcnt(23)
    buffer_load_dwordx4 v[140:143], v5, s[40:43], s45 offen offset:384 nt
    s_add_u32 s45, s45, 4096
    s_and_b32 s45, s45, 0xfffff
    v_mfma_f32_16x16x32_bf16 v[28:31], v[156:159], v[36:39], v[28:31]
    v_and_b32 v33, v10, v13
    v_and_b32 v34, v10, v14
    v_and_b32 v35, v10, v15
    s_nop 1
    v_mfma_f32_16x16x32_bf16 v[16:19], v[160:163], v[32:35], v[16:19]
    v_fma_f32 v9, v43, s34, v11
    s_waitcnt vmcnt(23)
    buffer_load_dwordx4 v[144:147], v5, s[40:43], s45 offen offset:0 nt
    v_mfma_f32_16x16x32_bf16 v[20:23], v[164:167], v[32:35], v[20:23]
    v_exp_f32 v9, v9
    v_mfma_f32_16x16x32_bf16 v[24:27], v[168:171], v[32:35], v[24:27]
    v_cvt_pk_bf16_f32 v10, v9, v9
    v_and_b32 v36, v10, v12
    s_waitcnt vmcnt(23)
    buffer_load_dwordx4 v[148:151], v5, s[40:43], s45 offen offset:128 nt
    v_mfma_f32_16x16x32_bf16 v[28:31], v[172:175], v[32:35], v[28:31]
    v_and_b32 v37, v10, v13
    v_and_b32 v38, v10, v14
    v_and_b32 v39, v10, v15
    s_waitcnt lgkmcnt(0)
    s_nop 0
    v_mfma_f32_16x16x32_bf16 v[16:19], v[176:179], v[36:39], v[16:19]
    v_fma_f32 v9, v44, s34, v11
    s_waitcnt vmcnt(23)
    buffer_load_dwordx4 v[152:155], v5, s[40:43], s45 offen offset:256 nt
    v_mfma_f32_16x16x32_bf16 v[20:23], v[180:183], v[36:39], v[20:23]
    v_exp_f32 v9, v9
    v_mfma_f32_16x16x32_bf16 v[24:27], v[184:187], v[36:39], v[24:27]
    v_cvt_pk_bf16_f32 v10, v9, v9
    v_and_b32 v32, v10, v12
    s_waitcnt vmcnt(23)
    buffer_load_dwordx4 v[156:159], v5, s[40:43], s45 offen offset:384 nt
    s_add_u32 s45, s45, 4096
    s_and_b32 s45, s45, 0xfffff
    v_mfma_f32_16x16x32_bf16 v[28:31], v[188:191], v[36:39], v[28:31]
    v_and_b32 v33, v10, v13
    v_and_b32 v34, v10, v14
    v_and_b32 v35, v10, v15
    ds_read_b128 v[48:51], v7 offset:1312
    s_nop 0
    v_mfma_f32_16x16x32_bf16 v[16:19], v[192:195], v[32:35], v[16:19]
    v_fma_f32 v9, v45, s34, v11
    s_waitcnt vmcnt(23)
    buffer_load_dwordx4 v[160:163], v5, s[40:43], s45 offen offset:0 nt
    v_mfma_f32_16x16x32_bf16 v[20:23], v[196:199], v[32:35], v[20:23]
    v_exp_f32 v9, v9
    v_mfma_f32_16x16x32_bf16 v[24:27], v[200:203], v[32:35], v[24:27]
    v_cvt_pk_bf16_f32 v10, v9, v9
    v_and_b32 v36, v10, v12
    s_waitcnt vmcnt(23)
    buffer_load_dwordx4 v[164:167], v5, s[40:43], s45 offen offset:128 nt
    v_mfma_f32_16x16x32_bf16 v[28:31], v[204:207], v[32:35], v[28:31]
    v_and_b32 v37, v10, v13
    v_and_b32 v38, v10, v14
    v_and_b32 v39, v10, v15
    s_nop 1
    v_mfma_f32_16x16x32_bf16 v[16:19], v[208:211], v[36:39], v[16:19]
    v_fma_f32 v9, v46, s34, v11
    s_waitcnt vmcnt(23)
    buffer_load_dwordx4 v[168:171], v5, s[40:43], s45 offen offset:256 nt
    v_mfma_f32_16x16x32_bf16 v[20:23], v[212:215], v[36:39], v[20:23]
    v_exp_f32 v9, v9
    v_mfma_f32_16x16x32_bf16 v[24:27], v[216:219], v[36:39], v[24:27]
    v_cvt_pk_bf16_f32 v10, v9, v9
    v_and_b32 v32, v10, v12
    s_waitcnt vmcnt(23)
    buffer_load_dwordx4 v[172:175], v5, s[40:43], s45 offen offset:384 nt
    s_add_u32 s45, s45, 4096
    s_and_b32 s45, s45, 0xfffff
    v_mfma_f32_16x16x32_bf16 v[28:31], v[220:223], v[36:39], v[28:31]
    v_and_b32 v33, v10, v13
    v_and_b32 v34, v10, v14
    v_and_b32 v35, v10, v15
    s_nop 1
    v_mfma_f32_16x16x32_bf16 v[16:19], v[224:227], v[32:35], v[16:19]
    v_fma_f32 v9, v47, s34, v11
    s_waitcnt vmcnt(23)
    buffer_load_dwordx4 v[176:179], v5, s[40:43], s45 offen offset:0 nt
    v_mfma_f32_16x16x32_bf16 v[20:23], v[228:231], v[32:35], v[20:23]
    v_exp_f32 v9, v9
    v_mfma_f32_16x16x32_bf16 v[24:27], v[232:235], v[32:35], v[24:27]
    v_cvt_pk_bf16_f32 v10, v9, v9
    v_and_b32 v36, v10, v12
    s_waitcnt vmcnt(23)
    buffer_load_dwordx4 v[180:183], v5, s[40:43], s45 offen offset:128 nt
    v_mfma_f32_16x16x32_bf16 v[28:31], v[236:239], v[32:35], v[28:31]
    v_and_b32 v37, v10, v13
    v_and_b32 v38, v10, v14
    v_and_b32 v39, v10, v15
    s_waitcnt lgkmcnt(0)
    s_nop 0
    v_mfma_f32_16x16x32_bf16 v[16:19], v[240:243], v[36:39], v[16:19]
    v_fma_f32 v9, v48, s34, v11
    s_waitcnt vmcnt(23)
    buffer_load_dwordx4 v[184:187], v5, s[40:43], s45 offen offset:256 nt
    v_mfma_f32_16x16x32_bf16 v[20:23], v[244:247], v[36:39], v[20:23]
    v_exp_f32 v9, v9
    v_mfma_f32_16x16x32_bf16 v[24:27], v[248:251], v[36:39], v[24:27]
    v_cvt_pk_bf16_f32 v10, v9, v9
    v_and_b32 v32, v10, v12
    s_waitcnt vmcnt(23)
    buffer_load_dwordx4 v[188:191], v5, s[40:43], s45 offen offset:384 nt
    s_add_u32 s45, s45, 4096
    s_and_b32 s45, s45, 0xfffff
    v_mfma_f32_16x16x32_bf16 v[28:31], v[252:255], v[36:39], v[28:31]
    v_and_b32 v33, v10, v13
    v_and_b32 v34, v10, v14
    v_and_b32 v35, v10, v15
    s_waitcnt vmcnt(23)
    buffer_load_dwordx4 v[192:195], v5, s[40:43], s45 offen offset:0 nt
    ds_read_b128 v[40:43], v7 offset:1328
    v_mfma_f32_16x16x32_bf16 v[16:19], v[64:67], v[32:35], v[16:19]
    v_fma_f32 v9, v49, s34, v11
    s_waitcnt vmcnt(23)
    buffer_load_dwordx4 v[196:199], v5, s[40:43], s45 offen offset:128 nt
    v_mfma_f32_16x16x32_bf16 v[20:23], v[68:71], v[32:35], v[20:23]
    v_exp_f32 v9, v9
    s_waitcnt vmcnt(23)
    buffer_load_dwordx4 v[200:203], v5, s[40:43], s45 offen offset:256 nt
    v_mfma_f32_16x16x32_bf16 v[24:27], v[72:75], v[32:35], v[24:27]
    v_cvt_pk_bf16_f32 v10, v9, v9
    v_and_b32 v36, v10, v12
    s_waitcnt vmcnt(23)
    buffer_load_dwordx4 v[204:207], v5, s[40:43], s45 offen offset:384 nt
    s_add_u32 s45, s45, 4096
    s_and_b32 s45, s45, 0xfffff
    v_mfma_f32_16x16x32_bf16 v[28:31], v[76:79], v[32:35], v[28:31]
    v_and_b32 v37, v10, v13
    v_and_b32 v38, v10, v14
    v_and_b32 v39, v10, v15
    s_waitcnt vmcnt(23)
    buffer_load_dwordx4 v[208:211], v5, s[40:43], s45 offen offset:0 nt
    v_mfma_f32_16x16x32_bf16 v[16:19], v[80:83], v[36:39], v[16:19]
    v_fma_f32 v9, v50, s34, v11
    s_waitcnt vmcnt(23)
    buffer_load_dwordx4 v[212:215], v5, s[40:43], s45 offen offset:128 nt
    v_mfma_f32_16x16x32_bf16 v[20:23], v[84:87], v[36:39], v[20:23]
    v_exp_f32 v9, v9
    s_waitcnt vmcnt(23)
    buffer_load_dwordx4 v[216:219], v5, s[40:43], s45 offen offset:256 nt
    v_mfma_f32_16x16x32_bf16 v[24:27], v[88:91], v[36:39], v[24:27]
    v_cvt_pk_bf16_f32 v10, v9, v9
    v_and_b32 v32, v10, v12
    s_waitcnt vmcnt(23)
    buffer_load_dwordx4 v[220:223], v5, s[40:43], s45 offen offset:384 nt
    s_add_u32 s45, s45, 4096
    s_and_b32 s45, s45, 0xfffff
    v_mfma_f32_16x16x32_bf16 v[28:31], v[92:95], v[36:39], v[28:31]
    v_and_b32 v33, v10, v13
    v_and_b32 v34, v10, v14
    v_and_b32 v35, v10, v15
    s_waitcnt vmcnt(23)
    buffer_load_dwordx4 v[224:227], v5, s[40:43], s45 offen offset:0 nt
    v_mfma_f32_16x16x32_bf16 v[16:19], v[96:99], v[32:35], v[16:19]
    v_fma_f32 v9, v51, s34, v11
    s_waitcnt vmcnt(23)
    buffer_load_dwordx4 v[228:231], v5, s[40:43], s45 offen offset:128 nt
    v_mfma_f32_16x16x32_bf16 v[20:23], v[100:103], v[32:35], v[20:23]
    v_exp_f32 v9, v9
    s_waitcnt vmcnt(23)
    buffer_load_dwordx4 v[232:235], v5, s[40:43], s45 offen offset:256 nt
    v_mfma_f32_16x16x32_bf16 v[24:27], v[104:107], v[32:35], v[24:27]
    v_cvt_pk_bf16_f32 v10, v9, v9
    v_and_b32 v36, v10, v12
    s_waitcnt vmcnt(23)
    buffer_load_dwordx4 v[236:239], v5, s[40:43], s45 offen offset:384 nt
    s_add_u32 s45, s45, 4096
    s_and_b32 s45, s45, 0xfffff
    v_mfma_f32_16x16x32_bf16 v[28:31], v[108:111], v[32:35], v[28:31]
    v_and_b32 v37, v10, v13
    v_and_b32 v38, v10, v14
    v_and_b32 v39, v10, v15
    s_waitcnt vmcnt(23)
    buffer_load_dwordx4 v[240:243], v5, s[40:43], s45 offen offset:0 nt
    s_waitcnt lgkmcnt(0)
    v_mfma_f32_16x16x32_bf16 v[16:19], v[112:115], v[36:39], v[16:19]
    v_fma_f32 v9, v40, s34, v11
    s_waitcnt vmcnt(23)
    buffer_load_dwordx4 v[244:247], v5, s[40:43], s45 offen offset:128 nt
    v_mfma_f32_16x16x32_bf16 v[20:23], v[116:119], v[36:39], v[20:23]
    v_exp_f32 v9, v9
    s_waitcnt vmcnt(23)
    buffer_load_dwordx4 v[248:251], v5, s[40:43], s45 offen offset:256 nt
    v_mfma_f32_16x16x32_bf16 v[24:27], v[120:123], v[36:39], v[24:27]
    v_cvt_pk_bf16_f32 v10, v9, v9
    v_and_b32 v32, v10, v12
    s_waitcnt vmcnt(23)
    buffer_load_dwordx4 v[252:255], v5, s[40:43], s45 offen offset:384 nt
    s_add_u32 s45, s45, 4096
    s_and_b32 s45, s45, 0xfffff
    v_mfma_f32_16x16x32_bf16 v[28:31], v[124:127], v[36:39], v[28:31]
    v_and_b32 v33, v10, v13
    v_and_b32 v34, v10, v14
    v_and_b32 v35, v10, v15
    s_mov_b32 s46, 19
    v_mov_b32 v6, 0
    s_mov_b32 s50, 19
L_vloop1:
    s_waitcnt vmcnt(23)
    buffer_load_dwordx4 v[64:67], v5, s[40:43], s45 offen offset:0 nt
    ds_read_b128 v[44:47], v7 offset:1344
    v_mfma_f32_16x16x32_bf16 v[16:19], v[128:131], v[32:35], v[16:19]
    v_fma_f32 v9, v41, s34, v11
    s_waitcnt vmcnt(23)
    buffer_load_dwordx4 v[68:71], v5, s[40:43], s45 offen offset:128 nt
    v_mfma_f32_16x16x32_bf16 v[20:23], v[132:135], v[32:35], v[20:23]
    v_exp_f32 v9, v9
    s_waitcnt vmcnt(23)
    buffer_load_dwordx4 v[72:75], v5, s[40:43], s45 offen offset:256 nt
    v_mfma_f32_16x16x32_bf16 v[24:27], v[136:139], v[32:35], v[24:27]
    v_cvt_pk_bf16_f32 v10, v9, v9
    v_and_b32 v36, v10, v12
    s_waitcnt vmcnt(23)
    buffer_load_dwordx4 v[76:79], v5, s[40:43], s45 offen offset:384 nt
    s_add_u32 s45, s45, 4096
    s_and_b32 s45, s45, 0xfffff
    v_mfma_f32_16x16x32_bf16 v[28:31], v[140:143], v[32:35], v[28:31]
    v_and_b32 v37, v10, v13
    v_and_b32 v38, v10, v14
    v_and_b32 v39, v10, v15
    s_waitcnt vmcnt(23)
    buffer_load_dwordx4 v[80:83], v5, s[40:43], s45 offen offset:0 nt
    v_mfma_f32_16x16x32_bf16 v[16:19], v[144:147], v[36:39], v[16:19]
    v_fma_f32 v9, v42, s34, v11
    s_waitcnt vmcnt(23)
    buffer_load_dwordx4 v[84:87], v5, s[40:43], s45 offen offset:128 nt
    v_mfma_f32_16x16x32_bf16 v[20:23], v[148:151], v[36:39], v[20:23]
    v_exp_f32 v9, v9
    s_waitcnt vmcnt(23)
    buffer_load_dwordx4 v[88:91], v5, s[40:43], s45 offen offset:256 nt
    v_mfma_f32_16x16x32_bf16 v[24:27], v[152:155], v[36:39], v[24:27]
    v_cvt_pk_bf16_f32 v10, v9, v9
    v_and_b32 v32, v10, v12
    s_waitcnt vmcnt(23)
    buffer_load_dwordx4 v[92:95], v5, s[40:43], s45 offen offset:384 nt
    s_add_u32 s45, s45, 4096
    s_and_b32 s45, s45, 0xfffff
    v_mfma_f32_16x16x32_bf16 v[28:31], v[156:159], v[36:39], v[28:31]
    v_and_b32 v33, v10, v13
    v_and_b32 v34, v10, v14
    v_and_b32 v35, v10, v15
    s_waitcnt vmcnt(23)
    buffer_load_dwordx4 v[96:99], v5, s[40:43], s45 offen offset:0 nt
    v_mfma_f32_16x16x32_bf16 v[16:19], v[160:163], v[32:35], v[16:19]
    v_fma_f32 v9, v43, s34, v11
    s_waitcnt vmcnt(23)
    buffer_load_dwordx4 v[100:103], v5, s[40:43], s45 offen offset:128 nt
    v_mfma_f32_16x16x32_bf16 v[20:23], v[164:167], v[32:35], v[20:23]
    v_exp_f32 v9, v9
    s_waitcnt vmcnt(23)
    buffer_load_dwordx4 v[104:107], v5, s[40:43], s45 offen offset:256 nt
    v_mfma_f32_16x16x32_bf16 v[24:27], v[168:171], v[32:35], v[24:27]
    v_cvt_pk_bf16_f32 v10, v9, v9
    v_and_b32 v36, v10, v12
    s_waitcnt vmcnt(23)
    buffer_load_dwordx4 v[108:111], v5, s[40:43], s45 offen offset:384 nt
    s_add_u32 s45, s45, 4096
    s_and_b32 s45, s45, 0xfffff
    v_mfma_f32_16x16x32_bf16 v[28:31], v[172:175], v[32:35], v[28:31]
    v_and_b32 v37, v10, v13
    v_and_b32 v38, v10, v14
    v_and_b32 v39, v10, v15
    s_waitcnt vmcnt(23)
    buffer_load_dwordx4 v[112:115], v5, s[40:43], s45 offen offset:0 nt
    s_waitcnt lgkmcnt(0)
    v_mfma_f32_16x16x32_bf16 v[16:19], v[176:179], v[36:39], v[16:19]
    v_fma_f32 v9, v44, s34, v11
    s_waitcnt vmcnt(23)
    buffer_load_dwordx4 v[116:119], v5, s[40:43], s45 offen offset:128 nt
    v_mfma_f32_16x16x32_bf16 v[20:23], v[180:183], v[36:39], v[20:23]
    v_exp_f32 v9, v9
    s_waitcnt vmcnt(23)
    buffer_load_dwordx4 v[120:123], v5, s[40:43], s45 offen offset:256 nt
    v_mfma_f32_16x16x32_bf16 v[24:27], v[184:187], v[36:39], v[24:27]
    v_cvt_pk_bf16_f32 v10, v9, v9
    v_and_b32 v32, v10, v12
    s_waitcnt vmcnt(23)
    buffer_load_dwordx4 v[124:127], v5, s[40:43], s45 offen offset:384 nt
    s_add_u32 s45, s45, 4096
    s_and_b32 s45, s45, 0xfffff
    v_mfma_f32_16x16x32_bf16 v[28:31], v[188:191], v[36:39], v[28:31]
    v_and_b32 v33, v10, v13
    v_and_b32 v34, v10, v14
    v_and_b32 v35, v10, v15
    s_waitcnt vmcnt(23)
    buffer_load_dwordx4 v[128:131], v5, s[40:43], s45 offen offset:0 nt
    ds_read_b128 v[48:51], v7 offset:1360
    v_mfma_f32_16x16x32_bf16 v[16:19], v[192:195], v[32:35], v[16:19]
    v_fma_f32 v9, v45, s34, v11
    s_waitcnt vmcnt(23)
    buffer_load_dwordx4 v[132:135], v5, s[40:43], s45 offen offset:128 nt
    v_mfma_f32_16x16x32_bf16 v[20:23], v[196:199], v[32:35], v[20:23]
    v_exp_f32 v9, v9
    s_waitcnt vmcnt(23)
    buffer_load_dwordx4 v[136:139], v5, s[40:43], s45 offen offset:256 nt
    v_mfma_f32_16x16x32_bf16 v[24:27], v[200:203], v[32:35], v[24:27]
    v_cvt_pk_bf16_f32 v10, v9, v9
    v_and_b32 v36, v10, v12
    s_waitcnt vmcnt(23)
    buffer_load_dwordx4 v[140:143], v5, s[40:43], s45 offen offset:384 nt
    s_add_u32 s45, s45, 4096
    s_and_b32 s45, s45, 0xfffff
    v_mfma_f32_16x16x32_bf16 v[28:31], v[204:207], v[32:35], v[28:31]
    v_and_b32 v37, v10, v13
    v_and_b32 v38, v10, v14
    v_and_b32 v39, v10, v15
    s_waitcnt vmcnt(23)
    buffer_load_dwordx4 v[144:147], v5, s[40:43], s45 offen offset:0 nt
    v_mfma_f32_16x16x32_bf16 v[16:19], v[208:211], v[36:39], v[16:19]
    v_fma_f32 v9, v46, s34, v11
    s_waitcnt vmcnt(23)
    buffer_load_dwordx4 v[148:151], v5, s[40:43], s45 offen offset:128 nt
    v_mfma_f32_16x16x32_bf16 v[20:23], v[212:215], v[36:39], v[20:23]
    v_exp_f32 v9, v9
    s_waitcnt vmcnt(23)
    buffer_load_dwordx4 v[152:155], v5, s[40:43], s45 offen offset:256 nt
    v_mfma_f32_16x16x32_bf16 v[24:27], v[216:219], v[36:39], v[24:27]
    v_cvt_pk_bf16_f32 v10, v9, v9
    v_and_b32 v32, v10, v12
    s_waitcnt vmcnt(23)
    buffer_load_dwordx4 v[156:159], v5, s[40:43], s45 offen offset:384 nt
    s_add_u32 s45, s45, 4096
    s_and_b32 s45, s45, 0xfffff
    v_mfma_f32_16x16x32_bf16 v[28:31], v[220:223], v[36:39], v[28:31]
    v_and_b32 v33, v10, v13
    v_and_b32 v34, v10, v14
    v_and_b32 v35, v10, v15
    s_waitcnt vmcnt(23)
    buffer_load_dwordx4 v[160:163], v5, s[40:43], s45 offen offset:0 nt
    v_mfma_f32_16x16x32_bf16 v[16:19], v[224:227], v[32:35], v[16:19]
    v_fma_f32 v9, v47, s34, v11
    s_waitcnt vmcnt(23)
    buffer_load_dwordx4 v[164:167], v5, s[40:43], s45 offen offset:128 nt
    v_mfma_f32_16x16x32_bf16 v[20:23], v[228:231], v[32:35], v[20:23]
    v_exp_f32 v9, v9
    s_waitcnt vmcnt(23)
    buffer_load_dwordx4 v[168:171], v5, s[40:43], s45 offen offset:256 nt
    v_mfma_f32_16x16x32_bf16 v[24:27], v[232:235], v[32:35], v[24:27]
    v_cvt_pk_bf16_f32 v10, v9, v9
    v_and_b32 v36, v10, v12
    s_waitcnt vmcnt(23)
    buffer_load_dwordx4 v[172:175], v5, s[40:43], s45 offen offset:384 nt
    s_add_u32 s45, s45, 4096
    s_and_b32 s45, s45, 0xfffff
    v_mfma_f32_16x16x32_bf16 v[28:31], v[236:239], v[32:35], v[28:31]
    v_and_b32 v37, v10, v13
    v_and_b32 v38, v10, v14
    v_and_b32 v39, v10, v15
    s_waitcnt vmcnt(23)
    buffer_load_dwordx4 v[176:179], v5, s[40:43], s45 offen offset:0 nt
    s_waitcnt lgkmcnt(0)
    v_mfma_f32_16x16x32_bf16 v[16:19], v[240:243], v[36:39], v[16:19]
    v_fma_f32 v9, v48, s34, v11
    ds_read_b32 v4, v6 offset:588
    s_waitcnt vmcnt(23)
    buffer_load_dwordx4 v[180:183], v5, s[40:43], s45 offen offset:128 nt
    v_mfma_f32_16x16x32_bf16 v[20:23], v[244:247], v[36:39], v[20:23]
    v_exp_f32 v9, v9
    s_waitcnt vmcnt(23)
    buffer_load_dwordx4 v[184:187], v5, s[40:43], s45 offen offset:256 nt
    v_mfma_f32_16x16x32_bf16 v[24:27], v[248:251], v[36:39], v[24:27]
    v_cvt_pk_bf16_f32 v10, v9, v9
    v_and_b32 v32, v10, v12
    s_waitcnt vmcnt(23)
    buffer_load_dwordx4 v[188:191], v5, s[40:43], s45 offen offset:384 nt
    s_add_u32 s45, s45, 4096
    s_and_b32 s45, s45, 0xfffff
    v_mfma_f32_16x16x32_bf16 v[28:31], v[252:255], v[36:39], v[28:31]
    v_and_b32 v33, v10, v13
    v_and_b32 v34, v10, v14
    v_and_b32 v35, v10, v15
    s_waitcnt lgkmcnt(0)
    v_readfirstlane_b32 s48, v4
    s_cmp_eq_u32 s48, 0
    s_cbranch_scc1 L_vloopm0
    s_cmp_eq_u32 s48, 2
    s_cbranch_scc1 L_vloopm2
L_vloopm1:
    s_waitcnt vmcnt(23)
    buffer_load_dwordx4 v[192:195], v5, s[40:43], s45 offen offset:0 nt
    ds_read_b128 v[40:43], v7 offset:1376
    v_mfma_f32_16x16x32_bf16 v[16:19], v[64:67], v[32:35], v[16:19]
    v_fma_f32 v9, v49, s34, v11
    s_waitcnt vmcnt(23)
    buffer_load_dwordx4 v[196:199], v5, s[40:43], s45 offen offset:128 nt
    v_mfma_f32_16x16x32_bf16 v[20:23], v[68:71], v[32:35], v[20:23]
    v_exp_f32 v9, v9
    s_waitcnt vmcnt(23)
    buffer_load_dwordx4 v[200:203], v5, s[40:43], s45 offen offset:256 nt
    v_mfma_f32_16x16x32_bf16 v[24:27], v[72:75], v[32:35], v[24:27]
    v_cvt_pk_bf16_f32 v10, v9, v9
    v_and_b32 v36, v10, v12
    s_waitcnt vmcnt(23)
    buffer_load_dwordx4 v[204:207], v5, s[40:43], s45 offen offset:384 nt
    s_add_u32 s45, s45, 4096
    s_and_b32 s45, s45, 0xfffff
    v_mfma_f32_16x16x32_bf16 v[28:31], v[76:79], v[32:35], v[28:31]
    v_and_b32 v37, v10, v13
    v_and_b32 v38, v10, v14
    v_and_b32 v39, v10, v15
    s_waitcnt vmcnt(23)
    buffer_load_dwordx4 v[208:211], v5, s[40:43], s45 offen offset:0 nt
    v_mfma_f32_16x16x32_bf16 v[16:19], v[80:83], v[36:39], v[16:19]
    v_fma_f32 v9, v50, s34, v11
    s_waitcnt vmcnt(23)
    buffer_load_dwordx4 v[212:215], v5, s[40:43], s45 offen offset:128 nt
    v_mfma_f32_16x16x32_bf16 v[20:23], v[84:87], v[36:39], v[20:23]
    v_exp_f32 v9, v9
    s_waitcnt vmcnt(23)
    buffer_load_dwordx4 v[216:219], v5, s[40:43], s45 offen offset:256 nt
    v_mfma_f32_16x16x32_bf16 v[24:27], v[88:91], v[36:39], v[24:27]
    v_cvt_pk_bf16_f32 v10, v9, v9
    v_and_b32 v32, v10, v12
    s_waitcnt vmcnt(23)
    buffer_load_dwordx4 v[220:223], v5, s[40:43], s45 offen offset:384 nt
    s_add_u32 s45, s45, 4096
    s_and_b32 s45, s45, 0xfffff
    v_mfma_f32_16x16x32_bf16 v[28:31], v[92:95], v[36:39], v[28:31]
    v_and_b32 v33, v10, v13
    v_and_b32 v34, v10, v14
    v_and_b32 v35, v10, v15
    s_waitcnt vmcnt(23)
    buffer_load_dwordx4 v[224:227], v5, s[40:43], s45 offen offset:0 nt
    v_mfma_f32_16x16x32_bf16 v[16:19], v[96:99], v[32:35], v[16:19]
    v_fma_f32 v9, v51, s34, v11
    s_waitcnt vmcnt(23)
    buffer_load_dwordx4 v[228:231], v5, s[40:43], s45 offen offset:128 nt
    v_mfma_f32_16x16x32_bf16 v[20:23], v[100:103], v[32:35], v[20:23]
    v_exp_f32 v9, v9
    s_waitcnt vmcnt(23)
    buffer_load_dwordx4 v[232:235], v5, s[40:43], s45 offen offset:256 nt
    v_mfma_f32_16x16x32_bf16 v[24:27], v[104:107], v[32:35], v[24:27]
    v_cvt_pk_bf16_f32 v10, v9, v9
    v_and_b32 v36, v10, v12
    s_waitcnt vmcnt(23)
    buffer_load_dwordx4 v[236:239], v5, s[40:43], s45 offen offset:384 nt
    s_add_u32 s45, s45, 4096
    s_and_b32 s45, s45, 0xfffff
    v_mfma_f32_16x16x32_bf16 v[28:31], v[108:111], v[32:35], v[28:31]
    v_and_b32 v37, v10, v13
    v_and_b32 v38, v10, v14
    v_and_b32 v39, v10, v15
    s_waitcnt vmcnt(23)
    buffer_load_dwordx4 v[240:243], v5, s[40:43], s45 offen offset:0 nt
    s_waitcnt lgkmcnt(0)
    v_mfma_f32_16x16x32_bf16 v[16:19], v[112:115], v[36:39], v[16:19]
    v_fma_f32 v9, v40, s34, v11
    ds_read_b32 v4, v6 offset:588
    s_waitcnt vmcnt(23)
    buffer_load_dwordx4 v[244:247], v5, s[40:43], s45 offen offset:128 nt
    v_mfma_f32_16x16x32_bf16 v[20:23], v[116:119], v[36:39], v[20:23]
    v_exp_f32 v9, v9
    s_waitcnt vmcnt(23)
    buffer_load_dwordx4 v[248:251], v5, s[40:43], s45 offen offset:256 nt
    v_mfma_f32_16x16x32_bf16 v[24:27], v[120:123], v[36:39], v[24:27]
    v_cvt_pk_bf16_f32 v10, v9, v9
    v_and_b32 v32, v10, v12
    s_waitcnt vmcnt(23)
    buffer_load_dwordx4 v[252:255], v5, s[40:43], s45 offen offset:384 nt
    s_add_u32 s45, s45, 4096
    s_and_b32 s45, s45, 0xfffff
    v_mfma_f32_16x16x32_bf16 v[28:31], v[124:127], v[36:39], v[28:31]
    v_and_b32 v33, v10, v13
    v_and_b32 v34, v10, v14
    v_and_b32 v35, v10, v15
    v_add_u32 v7, 48, v7
    s_add_u32 s50, s50, 1
    v_mov_b32 v8, s50
    s_waitcnt lgkmcnt(0)
    v_readfirstlane_b32 s48, v4
    ds_write_b32 v6, v8 offset:584
    s_sub_u32 s46, s46, 1
    s_cmp_eq_u32 s46, 0
    s_cbranch_scc1 L_vloopx
    s_cmp_eq_u32 s48, 1
    s_cbranch_scc1 L_vloop1
    s_cmp_eq_u32 s48, 0
    s_cbranch_scc1 L_vloop0
    s_branch L_vloop2
L_vloop0:
    s_waitcnt vmcnt(17)
    buffer_load_dwordx4 v[64:67], v5, s[40:43], s45 offen offset:0 nt
    ds_read_b128 v[44:47], v7 offset:1344
    v_mfma_f32_16x16x32_bf16 v[16:19], v[128:131], v[32:35], v[16:19]
    v_fma_f32 v9, v41, s34, v11
    s_waitcnt vmcnt(17)
    buffer_load_dwordx4 v[68:71], v5, s[40:43], s45 offen offset:128 nt
    v_mfma_f32_16x16x32_bf16 v[20:23], v[132:135], v[32:35], v[20:23]
    v_exp_f32 v9, v9
    s_waitcnt vmcnt(17)
    buffer_load_dwordx4 v[72:75], v5, s[40:43], s45 offen offset:256 nt
    v_mfma_f32_16x16x32_bf16 v[24:27], v[136:139], v[32:35], v[24:27]
    v_cvt_pk_bf16_f32 v10, v9, v9
    v_and_b32 v36, v10, v12
    s_waitcnt vmcnt(17)
    buffer_load_dwordx4 v[76:79], v5, s[40:43], s45 offen offset:384 nt
    s_add_u32 s45, s45, 4096
    s_and_b32 s45, s45, 0xfffff
    v_mfma_f32_16x16x32_bf16 v[28:31], v[140:143], v[32:35], v[28:31]
    v_and_b32 v37, v10, v13
    v_and_b32 v38, v10, v14
    v_and_b32 v39, v10, v15
    s_waitcnt vmcnt(17)
    buffer_load_dwordx4 v[80:83], v5, s[40:43], s45 offen offset:0 nt
    v_mfma_f32_16x16x32_bf16 v[16:19], v[144:147], v[36:39], v[16:19]
    v_fma_f32 v9, v42, s34, v11
    s_waitcnt vmcnt(17)
    buffer_load_dwordx4 v[84:87], v5, s[40:43], s45 offen offset:128 nt
    v_mfma_f32_16x16x32_bf16 v[20:23], v[148:151], v[36:39], v[20:23]
    v_exp_f32 v9, v9
    s_waitcnt vmcnt(17)
    buffer_load_dwordx4 v[88:91], v5, s[40:43], s45 offen offset:256 nt
    v_mfma_f32_16x16x32_bf16 v[24:27], v[152:155], v[36:39], v[24:27]
    v_cvt_pk_bf16_f32 v10, v9, v9
    v_and_b32 v32, v10, v12
    s_waitcnt vmcnt(17)
    buffer_load_dwordx4 v[92:95], v5, s[40:43], s45 offen offset:384 nt
    s_add_u32 s45, s45, 4096
    s_and_b32 s45, s45, 0xfffff
    v_mfma_f32_16x16x32_bf16 v[28:31], v[156:159], v[36:39], v[28:31]
    v_and_b32 v33, v10, v13
    v_and_b32 v34, v10, v14
    v_and_b32 v35, v10, v15
    s_waitcnt vmcnt(17)
    buffer_load_dwordx4 v[96:99], v5, s[40:43], s45 offen offset:0 nt
    v_mfma_f32_16x16x32_bf16 v[16:19], v[160:163], v[32:35], v[16:19]
    v_fma_f32 v9, v43, s34, v11
    s_waitcnt vmcnt(17)
    buffer_load_dwordx4 v[100:103], v5, s[40:43], s45 offen offset:128 nt
    v_mfma_f32_16x16x32_bf16 v[20:23], v[164:167], v[32:35], v[20:23]
    v_exp_f32 v9, v9
    s_waitcnt vmcnt(17)
    buffer_load_dwordx4 v[104:107], v5, s[40:43], s45 offen offset:256 nt
    v_mfma_f32_16x16x32_bf16 v[24:27], v[168:171], v[32:35], v[24:27]
    v_cvt_pk_bf16_f32 v10, v9, v9
    v_and_b32 v36, v10, v12
    s_waitcnt vmcnt(17)
    buffer_load_dwordx4 v[108:111], v5, s[40:43], s45 offen offset:384 nt
    s_add_u32 s45, s45, 4096
    s_and_b32 s45, s45, 0xfffff
    v_mfma_f32_16x16x32_bf16 v[28:31], v[172:175], v[32:35], v[28:31]
    v_and_b32 v37, v10, v13
    v_and_b32 v38, v10, v14
    v_and_b32 v39, v10, v15
    s_waitcnt vmcnt(17)
    buffer_load_dwordx4 v[112:115], v5, s[40:43], s45 offen offset:0 nt
    s_waitcnt lgkmcnt(0)
    v_mfma_f32_16x16x32_bf16 v[16:19], v[176:179], v[36:39], v[16:19]
    v_fma_f32 v9, v44, s34, v11
    s_waitcnt vmcnt(17)
    buffer_load_dwordx4 v[116:119], v5, s[40:43], s45 offen offset:128 nt
    v_mfma_f32_16x16x32_bf16 v[20:23], v[180:183], v[36:39], v[20:23]
    v_exp_f32 v9, v9
    s_waitcnt vmcnt(17)
    buffer_load_dwordx4 v[120:123], v5, s[40:43], s45 offen offset:256 nt
    v_mfma_f32_16x16x32_bf16 v[24:27], v[184:187], v[36:39], v[24:27]
    v_cvt_pk_bf16_f32 v10, v9, v9
    v_and_b32 v32, v10, v12
    s_waitcnt vmcnt(17)
    buffer_load_dwordx4 v[124:127], v5, s[40:43], s45 offen offset:384 nt
    s_add_u32 s45, s45, 4096
    s_and_b32 s45, s45, 0xfffff
    v_mfma_f32_16x16x32_bf16 v[28:31], v[188:191], v[36:39], v[28:31]
    v_and_b32 v33, v10, v13
    v_and_b32 v34, v10, v14
    v_and_b32 v35, v10, v15
    s_waitcnt vmcnt(17)
    buffer_load_dwordx4 v[128:131], v5, s[40:43], s45 offen offset:0 nt
    ds_read_b128 v[48:51], v7 offset:1360
    v_mfma_f32_16x16x32_bf16 v[16:19], v[192:195], v[32:35], v[16:19]
    v_fma_f32 v9, v45, s34, v11
    s_waitcnt vmcnt(17)
    buffer_load_dwordx4 v[132:135], v5, s[40:43], s45 offen offset:128 nt
    v_mfma_f32_16x16x32_bf16 v[20:23], v[196:199], v[32:35], v[20:23]
    v_exp_f32 v9, v9
    s_waitcnt vmcnt(17)
    buffer_load_dwordx4 v[136:139], v5, s[40:43], s45 offen offset:256 nt
    v_mfma_f32_16x16x32_bf16 v[24:27], v[200:203], v[32:35], v[24:27]
    v_cvt_pk_bf16_f32 v10, v9, v9
    v_and_b32 v36, v10, v12
    s_waitcnt vmcnt(17)
    buffer_load_dwordx4 v[140:143], v5, s[40:43], s45 offen offset:384 nt
    s_add_u32 s45, s45, 4096
    s_and_b32 s45, s45, 0xfffff
    v_mfma_f32_16x16x32_bf16 v[28:31], v[204:207], v[32:35], v[28:31]
    v_and_b32 v37, v10, v13
    v_and_b32 v38, v10, v14
    v_and_b32 v39, v10, v15
    s_waitcnt vmcnt(17)
    buffer_load_dwordx4 v[144:147], v5, s[40:43], s45 offen offset:0 nt
    v_mfma_f32_16x16x32_bf16 v[16:19], v[208:211], v[36:39], v[16:19]
    v_fma_f32 v9, v46, s34, v11
    s_waitcnt vmcnt(17)
    buffer_load_dwordx4 v[148:151], v5, s[40:43], s45 offen offset:128 nt
    v_mfma_f32_16x16x32_bf16 v[20:23], v[212:215], v[36:39], v[20:23]
    v_exp_f32 v9, v9
    s_waitcnt vmcnt(17)
    buffer_load_dwordx4 v[152:155], v5, s[40:43], s45 offen offset:256 nt
    v_mfma_f32_16x16x32_bf16 v[24:27], v[216:219], v[36:39], v[24:27]
    v_cvt_pk_bf16_f32 v10, v9, v9
    v_and_b32 v32, v10, v12
    s_waitcnt vmcnt(17)
    buffer_load_dwordx4 v[156:159], v5, s[40:43], s45 offen offset:384 nt
    s_add_u32 s45, s45, 4096
    s_and_b32 s45, s45, 0xfffff
    v_mfma_f32_16x16x32_bf16 v[28:31], v[220:223], v[36:39], v[28:31]
    v_and_b32 v33, v10, v13
    v_and_b32 v34, v10, v14
    v_and_b32 v35, v10, v15
    s_waitcnt vmcnt(17)
    buffer_load_dwordx4 v[160:163], v5, s[40:43], s45 offen offset:0 nt
    v_mfma_f32_16x16x32_bf16 v[16:19], v[224:227], v[32:35], v[16:19]
    v_fma_f32 v9, v47, s34, v11
    s_waitcnt vmcnt(17)
    buffer_load_dwordx4 v[164:167], v5, s[40:43], s45 offen offset:128 nt
    v_mfma_f32_16x16x32_bf16 v[20:23], v[228:231], v[32:35], v[20:23]
    v_exp_f32 v9, v9
    s_waitcnt vmcnt(17)
    buffer_load_dwordx4 v[168:171], v5, s[40:43], s45 offen offset:256 nt
    v_mfma_f32_16x16x32_bf16 v[24:27], v[232:235], v[32:35], v[24:27]
    v_cvt_pk_bf16_f32 v10, v9, v9
    v_and_b32 v36, v10, v12
    s_waitcnt vmcnt(17)
    buffer_load_dwordx4 v[172:175], v5, s[40:43], s45 offen offset:384 nt
    s_add_u32 s45, s45, 4096
    s_and_b32 s45, s45, 0xfffff
    v_mfma_f32_16x16x32_bf16 v[28:31], v[236:239], v[32:35], v[28:31]
    v_and_b32 v37, v10, v13
    v_and_b32 v38, v10, v14
    v_and_b32 v39, v10, v15
    s_waitcnt vmcnt(17)
    buffer_load_dwordx4 v[176:179], v5, s[40:43], s45 offen offset:0 nt
    s_waitcnt lgkmcnt(0)
    v_mfma_f32_16x16x32_bf16 v[16:19], v[240:243], v[36:39], v[16:19]
    v_fma_f32 v9, v48, s34, v11
    ds_read_b32 v4, v6 offset:588
    s_waitcnt vmcnt(17)
    buffer_load_dwordx4 v[180:183], v5, s[40:43], s45 offen offset:128 nt
    v_mfma_f32_16x16x32_bf16 v[20:23], v[244:247], v[36:39], v[20:23]
    v_exp_f32 v9, v9
    s_waitcnt vmcnt(17)
    buffer_load_dwordx4 v[184:187], v5, s[40:43], s45 offen offset:256 nt
    v_mfma_f32_16x16x32_bf16 v[24:27], v[248:251], v[36:39], v[24:27]
    v_cvt_pk_bf16_f32 v10, v9, v9
    v_and_b32 v32, v10, v12
    s_waitcnt vmcnt(17)
    buffer_load_dwordx4 v[188:191], v5, s[40:43], s45 offen offset:384 nt
    s_add_u32 s45, s45, 4096
    s_and_b32 s45, s45, 0xfffff
    v_mfma_f32_16x16x32_bf16 v[28:31], v[252:255], v[36:39], v[28:31]
    v_and_b32 v33, v10, v13
    v_and_b32 v34, v10, v14
    v_and_b32 v35, v10, v15
    s_waitcnt lgkmcnt(0)
    v_readfirstlane_b32 s48, v4
    s_cmp_eq_u32 s48, 1
    s_cbranch_scc1 L_vloopm1
    s_cmp_eq_u32 s48, 2
    s_cbranch_scc1 L_vloopm2
L_vloopm0:
    s_waitcnt vmcnt(17)
    buffer_load_dwordx4 v[192:195], v5, s[40:43], s45 offen offset:0 nt
    ds_read_b128 v[40:43], v7 offset:1376
    v_mfma_f32_16x16x32_bf16 v[16:19], v[64:67], v[32:35], v[16:19]
    v_fma_f32 v9, v49, s34, v11
    s_waitcnt vmcnt(17)
    buffer_load_dwordx4 v[196:199], v5, s[40:43], s45 offen offset:128 nt
    v_mfma_f32_16x16x32_bf16 v[20:23], v[68:71], v[32:35], v[20:23]
    v_exp_f32 v9, v9
    s_waitcnt vmcnt(17)
    buffer_load_dwordx4 v[200:203], v5, s[40:43], s45 offen offset:256 nt
    v_mfma_f32_16x16x32_bf16 v[24:27], v[72:75], v[32:35], v[24:27]
    v_cvt_pk_bf16_f32 v10, v9, v9
    v_and_b32 v36, v10, v12
    s_waitcnt vmcnt(17)
    buffer_load_dwordx4 v[204:207], v5, s[40:43], s45 offen offset:384 nt
    s_add_u32 s45, s45, 4096
    s_and_b32 s45, s45, 0xfffff
    v_mfma_f32_16x16x32_bf16 v[28:31], v[76:79], v[32:35], v[28:31]
    v_and_b32 v37, v10, v13
    v_and_b32 v38, v10, v14
    v_and_b32 v39, v10, v15
    s_waitcnt vmcnt(17)
    buffer_load_dwordx4 v[208:211], v5, s[40:43], s45 offen offset:0 nt
    v_mfma_f32_16x16x32_bf16 v[16:19], v[80:83], v[36:39], v[16:19]
    v_fma_f32 v9, v50, s34, v11
    s_waitcnt vmcnt(17)
    buffer_load_dwordx4 v[212:215], v5, s[40:43], s45 offen offset:128 nt
    v_mfma_f32_16x16x32_bf16 v[20:23], v[84:87], v[36:39], v[20:23]
    v_exp_f32 v9, v9
    s_waitcnt vmcnt(17)
    buffer_load_dwordx4 v[216:219], v5, s[40:43], s45 offen offset:256 nt
    v_mfma_f32_16x16x32_bf16 v[24:27], v[88:91], v[36:39], v[24:27]
    v_cvt_pk_bf16_f32 v10, v9, v9
    v_and_b32 v32, v10, v12
    s_waitcnt vmcnt(17)
    buffer_load_dwordx4 v[220:223], v5, s[40:43], s45 offen offset:384 nt
    s_add_u32 s45, s45, 4096
    s_and_b32 s45, s45, 0xfffff
    v_mfma_f32_16x16x32_bf16 v[28:31], v[92:95], v[36:39], v[28:31]
    v_and_b32 v33, v10, v13
    v_and_b32 v34, v10, v14
    v_and_b32 v35, v10, v15
    s_waitcnt vmcnt(17)
    buffer_load_dwordx4 v[224:227], v5, s[40:43], s45 offen offset:0 nt
    v_mfma_f32_16x16x32_bf16 v[16:19], v[96:99], v[32:35], v[16:19]
    v_fma_f32 v9, v51, s34, v11
    s_waitcnt vmcnt(17)
    buffer_load_dwordx4 v[228:231], v5, s[40:43], s45 offen offset:128 nt
    v_mfma_f32_16x16x32_bf16 v[20:23], v[100:103], v[32:35], v[20:23]
    v_exp_f32 v9, v9
    s_waitcnt vmcnt(17)
    buffer_load_dwordx4 v[232:235], v5, s[40:43], s45 offen offset:256 nt
    v_mfma_f32_16x16x32_bf16 v[24:27], v[104:107], v[32:35], v[24:27]
    v_cvt_pk_bf16_f32 v10, v9, v9
    v_and_b32 v36, v10, v12
    s_waitcnt vmcnt(17)
    buffer_load_dwordx4 v[236:239], v5, s[40:43], s45 offen offset:384 nt
    s_add_u32 s45, s45, 4096
    s_and_b32 s45, s45, 0xfffff
    v_mfma_f32_16x16x32_bf16 v[28:31], v[108:111], v[32:35], v[28:31]
    v_and_b32 v37, v10, v13
    v_and_b32 v38, v10, v14
    v_and_b32 v39, v10, v15
    s_waitcnt vmcnt(17)
    buffer_load_dwordx4 v[240:243], v5, s[40:43], s45 offen offset:0 nt
    s_waitcnt lgkmcnt(0)
    v_mfma_f32_16x16x32_bf16 v[16:19], v[112:115], v[36:39], v[16:19]
    v_fma_f32 v9, v40, s34, v11
    ds_read_b32 v4, v6 offset:588
    s_waitcnt vmcnt(17)
    buffer_load_dwordx4 v[244:247], v5, s[40:43], s45 offen offset:128 nt
    v_mfma_f32_16x16x32_bf16 v[20:23], v[116:119], v[36:39], v[20:23]
    v_exp_f32 v9, v9
    s_waitcnt vmcnt(17)
    buffer_load_dwordx4 v[248:251], v5, s[40:43], s45 offen offset:256 nt
    v_mfma_f32_16x16x32_bf16 v[24:27], v[120:123], v[36:39], v[24:27]
    v_cvt_pk_bf16_f32 v10, v9, v9
    v_and_b32 v32, v10, v12
    s_waitcnt vmcnt(17)
    buffer_load_dwordx4 v[252:255], v5, s[40:43], s45 offen offset:384 nt
    s_add_u32 s45, s45, 4096
    s_and_b32 s45, s45, 0xfffff
    v_mfma_f32_16x16x32_bf16 v[28:31], v[124:127], v[36:39], v[28:31]
    v_and_b32 v33, v10, v13
    v_and_b32 v34, v10, v14
    v_and_b32 v35, v10, v15
    v_add_u32 v7, 48, v7
    s_add_u32 s50, s50, 1
    v_mov_b32 v8, s50
    s_waitcnt lgkmcnt(0)
    v_readfirstlane_b32 s48, v4
    ds_write_b32 v6, v8 offset:584
    s_sub_u32 s46, s46, 1
    s_cmp_eq_u32 s46, 0
    s_cbranch_scc1 L_vloopx
    s_cmp_eq_u32 s48, 0
    s_cbranch_scc1 L_vloop0
    s_cmp_eq_u32 s48, 1
    s_cbranch_scc1 L_vloop1
    s_branch L_vloop2
L_vloop2:
    s_waitcnt vmcnt(31)
    buffer_load_dwordx4 v[64:67], v5, s[40:43], s45 offen offset:0 nt
    ds_read_b128 v[44:47], v7 offset:1344
    v_mfma_f32_16x16x32_bf16 v[16:19], v[128:131], v[32:35], v[16:19]
    v_fma_f32 v9, v41, s34, v11
    s_waitcnt vmcnt(31)
    buffer_load_dwordx4 v[68:71], v5, s[40:43], s45 offen offset:128 nt
    v_mfma_f32_16x16x32_bf16 v[20:23], v[132:135], v[32:35], v[20:23]
    v_exp_f32 v9, v9
    s_waitcnt vmcnt(31)
    buffer_load_dwordx4 v[72:75], v5, s[40:43], s45 offen offset:256 nt
    v_mfma_f32_16x16x32_bf16 v[24:27], v[136:139], v[32:35], v[24:27]
    v_cvt_pk_bf16_f32 v10, v9, v9
    v_and_b32 v36, v10, v12
    s_waitcnt vmcnt(31)
    buffer_load_dwordx4 v[76:79], v5, s[40:43], s45 offen offset:384 nt
    s_add_u32 s45, s45, 4096
    s_and_b32 s45, s45, 0xfffff
    v_mfma_f32_16x16x32_bf16 v[28:31], v[140:143], v[32:35], v[28:31]
    v_and_b32 v37, v10, v13
    v_and_b32 v38, v10, v14
    v_and_b32 v39, v10, v15
    s_waitcnt vmcnt(31)
    buffer_load_dwordx4 v[80:83], v5, s[40:43], s45 offen offset:0 nt
    v_mfma_f32_16x16x32_bf16 v[16:19], v[144:147], v[36:39], v[16:19]
    v_fma_f32 v9, v42, s34, v11
    s_waitcnt vmcnt(31)
    buffer_load_dwordx4 v[84:87], v5, s[40:43], s45 offen offset:128 nt
    v_mfma_f32_16x16x32_bf16 v[20:23], v[148:151], v[36:39], v[20:23]
    v_exp_f32 v9, v9
    s_waitcnt vmcnt(31)
    buffer_load_dwordx4 v[88:91], v5, s[40:43], s45 offen offset:256 nt
    v_mfma_f32_16x16x32_bf16 v[24:27], v[152:155], v[36:39], v[24:27]
    v_cvt_pk_bf16_f32 v10, v9, v9
    v_and_b32 v32, v10, v12
    s_waitcnt vmcnt(31)
    buffer_load_dwordx4 v[92:95], v5, s[40:43], s45 offen offset:384 nt
    s_add_u32 s45, s45, 4096
    s_and_b32 s45, s45, 0xfffff
    v_mfma_f32_16x16x32_bf16 v[28:31], v[156:159], v[36:39], v[28:31]
    v_and_b32 v33, v10, v13
    v_and_b32 v34, v10, v14
    v_and_b32 v35, v10, v15
    s_waitcnt vmcnt(31)
    buffer_load_dwordx4 v[96:99], v5, s[40:43], s45 offen offset:0 nt
    v_mfma_f32_16x16x32_bf16 v[16:19], v[160:163], v[32:35], v[16:19]
    v_fma_f32 v9, v43, s34, v11
    s_waitcnt vmcnt(31)
    buffer_load_dwordx4 v[100:103], v5, s[40:43], s45 offen offset:128 nt
    v_mfma_f32_16x16x32_bf16 v[20:23], v[164:167], v[32:35], v[20:23]
    v_exp_f32 v9, v9
    s_waitcnt vmcnt(31)
    buffer_load_dwordx4 v[104:107], v5, s[40:43], s45 offen offset:256 nt
    v_mfma_f32_16x16x32_bf16 v[24:27], v[168:171], v[32:35], v[24:27]
    v_cvt_pk_bf16_f32 v10, v9, v9
    v_and_b32 v36, v10, v12
    s_waitcnt vmcnt(31)
    buffer_load_dwordx4 v[108:111], v5, s[40:43], s45 offen offset:384 nt
    s_add_u32 s45, s45, 4096
    s_and_b32 s45, s45, 0xfffff
    v_mfma_f32_16x16x32_bf16 v[28:31], v[172:175], v[32:35], v[28:31]
    v_and_b32 v37, v10, v13
    v_and_b32 v38, v10, v14
    v_and_b32 v39, v10, v15
    s_waitcnt vmcnt(31)
    buffer_load_dwordx4 v[112:115], v5, s[40:43], s45 offen offset:0 nt
    s_waitcnt lgkmcnt(0)
    v_mfma_f32_16x16x32_bf16 v[16:19], v[176:179], v[36:39], v[16:19]
    v_fma_f32 v9, v44, s34, v11
    s_waitcnt vmcnt(31)
    buffer_load_dwordx4 v[116:119], v5, s[40:43], s45 offen offset:128 nt
    v_mfma_f32_16x16x32_bf16 v[20:23], v[180:183], v[36:39], v[20:23]
    v_exp_f32 v9, v9
    s_waitcnt vmcnt(31)
    buffer_load_dwordx4 v[120:123], v5, s[40:43], s45 offen offset:256 nt
    v_mfma_f32_16x16x32_bf16 v[24:27], v[184:187], v[36:39], v[24:27]
    v_cvt_pk_bf16_f32 v10, v9, v9
    v_and_b32 v32, v10, v12
    s_waitcnt vmcnt(31)
    buffer_load_dwordx4 v[124:127], v5, s[40:43], s45 offen offset:384 nt
    s_add_u32 s45, s45, 4096
    s_and_b32 s45, s45, 0xfffff
    v_mfma_f32_16x16x32_bf16 v[28:31], v[188:191], v[36:39], v[28:31]
    v_and_b32 v33, v10, v13
    v_and_b32 v34, v10, v14
    v_and_b32 v35, v10, v15
    s_waitcnt vmcnt(31)
    buffer_load_dwordx4 v[128:131], v5, s[40:43], s45 offen offset:0 nt
    ds_read_b128 v[48:51], v7 offset:1360
    v_mfma_f32_16x16x32_bf16 v[16:19], v[192:195], v[32:35], v[16:19]
    v_fma_f32 v9, v45, s34, v11
    s_waitcnt vmcnt(31)
    buffer_load_dwordx4 v[132:135], v5, s[40:43], s45 offen offset:128 nt
    v_mfma_f32_16x16x32_bf16 v[20:23], v[196:199], v[32:35], v[20:23]
    v_exp_f32 v9, v9
    s_waitcnt vmcnt(31)
    buffer_load_dwordx4 v[136:139], v5, s[40:43], s45 offen offset:256 nt
    v_mfma_f32_16x16x32_bf16 v[24:27], v[200:203], v[32:35], v[24:27]
    v_cvt_pk_bf16_f32 v10, v9, v9
    v_and_b32 v36, v10, v12
    s_waitcnt vmcnt(31)
    buffer_load_dwordx4 v[140:143], v5, s[40:43], s45 offen offset:384 nt
    s_add_u32 s45, s45, 4096
    s_and_b32 s45, s45, 0xfffff
    v_mfma_f32_16x16x32_bf16 v[28:31], v[204:207], v[32:35], v[28:31]
    v_and_b32 v37, v10, v13
    v_and_b32 v38, v10, v14
    v_and_b32 v39, v10, v15
    s_waitcnt vmcnt(31)
    buffer_load_dwordx4 v[144:147], v5, s[40:43], s45 offen offset:0 nt
    v_mfma_f32_16x16x32_bf16 v[16:19], v[208:211], v[36:39], v[16:19]
    v_fma_f32 v9, v46, s34, v11
    s_waitcnt vmcnt(31)
    buffer_load_dwordx4 v[148:151], v5, s[40:43], s45 offen offset:128 nt
    v_mfma_f32_16x16x32_bf16 v[20:23], v[212:215], v[36:39], v[20:23]
    v_exp_f32 v9, v9
    s_waitcnt vmcnt(31)
    buffer_load_dwordx4 v[152:155], v5, s[40:43], s45 offen offset:256 nt
    v_mfma_f32_16x16x32_bf16 v[24:27], v[216:219], v[36:39], v[24:27]
    v_cvt_pk_bf16_f32 v10, v9, v9
    v_and_b32 v32, v10, v12
    s_waitcnt vmcnt(31)
    buffer_load_dwordx4 v[156:159], v5, s[40:43], s45 offen offset:384 nt
    s_add_u32 s45, s45, 4096
    s_and_b32 s45, s45, 0xfffff
    v_mfma_f32_16x16x32_bf16 v[28:31], v[220:223], v[36:39], v[28:31]
    v_and_b32 v33, v10, v13
    v_and_b32 v34, v10, v14
    v_and_b32 v35, v10, v15
    s_waitcnt vmcnt(31)
    buffer_load_dwordx4 v[160:163], v5, s[40:43], s45 offen offset:0 nt
    v_mfma_f32_16x16x32_bf16 v[16:19], v[224:227], v[32:35], v[16:19]
    v_fma_f32 v9, v47, s34, v11
    s_waitcnt vmcnt(31)
    buffer_load_dwordx4 v[164:167], v5, s[40:43], s45 offen offset:128 nt
    v_mfma_f32_16x16x32_bf16 v[20:23], v[228:231], v[32:35], v[20:23]
    v_exp_f32 v9, v9
    s_waitcnt vmcnt(31)
    buffer_load_dwordx4 v[168:171], v5, s[40:43], s45 offen offset:256 nt
    v_mfma_f32_16x16x32_bf16 v[24:27], v[232:235], v[32:35], v[24:27]
    v_cvt_pk_bf16_f32 v10, v9, v9
    v_and_b32 v36, v10, v12
    s_waitcnt vmcnt(31)
    buffer_load_dwordx4 v[172:175], v5, s[40:43], s45 offen offset:384 nt
    s_add_u32 s45, s45, 4096
    s_and_b32 s45, s45, 0xfffff
    v_mfma_f32_16x16x32_bf16 v[28:31], v[236:239], v[32:35], v[28:31]
    v_and_b32 v37, v10, v13
    v_and_b32 v38, v10, v14
    v_and_b32 v39, v10, v15
    s_waitcnt vmcnt(31)
    buffer_load_dwordx4 v[176:179], v5, s[40:43], s45 offen offset:0 nt
    s_waitcnt lgkmcnt(0)
    v_mfma_f32_16x16x32_bf16 v[16:19], v[240:243], v[36:39], v[16:19]
    v_fma_f32 v9, v48, s34, v11
    ds_read_b32 v4, v6 offset:588
    s_waitcnt vmcnt(31)
    buffer_load_dwordx4 v[180:183], v5, s[40:43], s45 offen offset:128 nt
    v_mfma_f32_16x16x32_bf16 v[20:23], v[244:247], v[36:39], v[20:23]
    v_exp_f32 v9, v9
    s_waitcnt vmcnt(31)
    buffer_load_dwordx4 v[184:187], v5, s[40:43], s45 offen offset:256 nt
    v_mfma_f32_16x16x32_bf16 v[24:27], v[248:251], v[36:39], v[24:27]
    v_cvt_pk_bf16_f32 v10, v9, v9
    v_and_b32 v32, v10, v12
    s_waitcnt vmcnt(31)
    buffer_load_dwordx4 v[188:191], v5, s[40:43], s45 offen offset:384 nt
    s_add_u32 s45, s45, 4096
    s_and_b32 s45, s45, 0xfffff
    v_mfma_f32_16x16x32_bf16 v[28:31], v[252:255], v[36:39], v[28:31]
    v_and_b32 v33, v10, v13
    v_and_b32 v34, v10, v14
    v_and_b32 v35, v10, v15
    s_waitcnt lgkmcnt(0)
    v_readfirstlane_b32 s48, v4
    s_cmp_eq_u32 s48, 0
    s_cbranch_scc1 L_vloopm0
    s_cmp_eq_u32 s48, 1
    s_cbranch_scc1 L_vloopm1
L_vloopm2:
    s_waitcnt vmcnt(31)
    buffer_load_dwordx4 v[192:195], v5, s[40:43], s45 offen offset:0 nt
    ds_read_b128 v[40:43], v7 offset:1376
    v_mfma_f32_16x16x32_bf16 v[16:19], v[64:67], v[32:35], v[16:19]
    v_fma_f32 v9, v49, s34, v11
    s_waitcnt vmcnt(31)
    buffer_load_dwordx4 v[196:199], v5, s[40:43], s45 offen offset:128 nt
    v_mfma_f32_16x16x32_bf16 v[20:23], v[68:71], v[32:35], v[20:23]
    v_exp_f32 v9, v9
    s_waitcnt vmcnt(31)
    buffer_load_dwordx4 v[200:203], v5, s[40:43], s45 offen offset:256 nt
    v_mfma_f32_16x16x32_bf16 v[24:27], v[72:75], v[32:35], v[24:27]
    v_cvt_pk_bf16_f32 v10, v9, v9
    v_and_b32 v36, v10, v12
    s_waitcnt vmcnt(31)
    buffer_load_dwordx4 v[204:207], v5, s[40:43], s45 offen offset:384 nt
    s_add_u32 s45, s45, 4096
    s_and_b32 s45, s45, 0xfffff
    v_mfma_f32_16x16x32_bf16 v[28:31], v[76:79], v[32:35], v[28:31]
    v_and_b32 v37, v10, v13
    v_and_b32 v38, v10, v14
    v_and_b32 v39, v10, v15
    s_waitcnt vmcnt(31)
    buffer_load_dwordx4 v[208:211], v5, s[40:43], s45 offen offset:0 nt
    v_mfma_f32_16x16x32_bf16 v[16:19], v[80:83], v[36:39], v[16:19]
    v_fma_f32 v9, v50, s34, v11
    s_waitcnt vmcnt(31)
    buffer_load_dwordx4 v[212:215], v5, s[40:43], s45 offen offset:128 nt
    v_mfma_f32_16x16x32_bf16 v[20:23], v[84:87], v[36:39], v[20:23]
    v_exp_f32 v9, v9
    s_waitcnt vmcnt(31)
    buffer_load_dwordx4 v[216:219], v5, s[40:43], s45 offen offset:256 nt
    v_mfma_f32_16x16x32_bf16 v[24:27], v[88:91], v[36:39], v[24:27]
    v_cvt_pk_bf16_f32 v10, v9, v9
    v_and_b32 v32, v10, v12
    s_waitcnt vmcnt(31)
    buffer_load_dwordx4 v[220:223], v5, s[40:43], s45 offen offset:384 nt
    s_add_u32 s45, s45, 4096
    s_and_b32 s45, s45, 0xfffff
    v_mfma_f32_16x16x32_bf16 v[28:31], v[92:95], v[36:39], v[28:31]
    v_and_b32 v33, v10, v13
    v_and_b32 v34, v10, v14
    v_and_b32 v35, v10, v15
    s_waitcnt vmcnt(31)
    buffer_load_dwordx4 v[224:227], v5, s[40:43], s45 offen offset:0 nt
    v_mfma_f32_16x16x32_bf16 v[16:19], v[96:99], v[32:35], v[16:19]
    v_fma_f32 v9, v51, s34, v11
    s_waitcnt vmcnt(31)
    buffer_load_dwordx4 v[228:231], v5, s[40:43], s45 offen offset:128 nt
    v_mfma_f32_16x16x32_bf16 v[20:23], v[100:103], v[32:35], v[20:23]
    v_exp_f32 v9, v9
    s_waitcnt vmcnt(31)
    buffer_load_dwordx4 v[232:235], v5, s[40:43], s45 offen offset:256 nt
    v_mfma_f32_16x16x32_bf16 v[24:27], v[104:107], v[32:35], v[24:27]
    v_cvt_pk_bf16_f32 v10, v9, v9
    v_and_b32 v36, v10, v12
    s_waitcnt vmcnt(31)
    buffer_load_dwordx4 v[236:239], v5, s[40:43], s45 offen offset:384 nt
    s_add_u32 s45, s45, 4096
    s_and_b32 s45, s45, 0xfffff
    v_mfma_f32_16x16x32_bf16 v[28:31], v[108:111], v[32:35], v[28:31]
    v_and_b32 v37, v10, v13
    v_and_b32 v38, v10, v14
    v_and_b32 v39, v10, v15
    s_waitcnt vmcnt(31)
    buffer_load_dwordx4 v[240:243], v5, s[40:43], s45 offen offset:0 nt
    s_waitcnt lgkmcnt(0)
    v_mfma_f32_16x16x32_bf16 v[16:19], v[112:115], v[36:39], v[16:19]
    v_fma_f32 v9, v40, s34, v11
    ds_read_b32 v4, v6 offset:588
    s_waitcnt vmcnt(31)
    buffer_load_dwordx4 v[244:247], v5, s[40:43], s45 offen offset:128 nt
    v_mfma_f32_16x16x32_bf16 v[20:23], v[116:119], v[36:39], v[20:23]
    v_exp_f32 v9, v9
    s_waitcnt vmcnt(31)
    buffer_load_dwordx4 v[248:251], v5, s[40:43], s45 offen offset:256 nt
    v_mfma_f32_16x16x32_bf16 v[24:27], v[120:123], v[36:39], v[24:27]
    v_cvt_pk_bf16_f32 v10, v9, v9
    v_and_b32 v32, v10, v12
    s_waitcnt vmcnt(31)
    buffer_load_dwordx4 v[252:255], v5, s[40:43], s45 offen offset:384 nt
    s_add_u32 s45, s45, 4096
    s_and_b32 s45, s45, 0xfffff
    v_mfma_f32_16x16x32_bf16 v[28:31], v[124:127], v[36:39], v[28:31]
    v_and_b32 v33, v10, v13
    v_and_b32 v34, v10, v14
    v_and_b32 v35, v10, v15
    v_add_u32 v7, 48, v7
    s_add_u32 s50, s50, 1
    v_mov_b32 v8, s50
    s_waitcnt lgkmcnt(0)
    v_readfirstlane_b32 s48, v4
    ds_write_b32 v6, v8 offset:584
    s_sub_u32 s46, s46, 1
    s_cmp_eq_u32 s46, 0
    s_cbranch_scc1 L_vloopx
    s_cmp_eq_u32 s48, 2
    s_cbranch_scc1 L_vloop2
    s_cmp_eq_u32 s48, 0
    s_cbranch_scc1 L_vloop0
    s_branch L_vloop1
L_vloopx:
    v_lshrrev_b32 v4, 2, v0
    v_and_b32 v8, 3, v0
    v_and_b32 v6, 3, v4
    v_lshlrev_b32 v4, 12, v4
    v_lshl_add_u32 v4, v8, 4, v4
    s_lshl_b32 s47, s32, 6
    v_add_u32 v4, s47, v4
    v_lshl_add_u32 v6, v8, 2, v6
    s_lshl_b32 s47, s32, 5
    v_lshl_add_u32 v6, v6, 1, s47
    v_bfe_u32 v8, v0, 4, 1
    v_lshlrev_b32 v8, 6, v8
    v_lshrrev_b32 v52, 5, v0
    v_lshl_add_u32 v8, v52, 5, v8
    v_lshl_add_u32 v8, v3, 2, v8
    s_mov_b32 s47, 65536
    s_mov_b32 s49, 400000
    s_waitcnt vmcnt(23)
    buffer_load_dwordx4 v[64:67], v5, s[40:43], s45 offen offset:0 nt
    s_add_u32 s45, s45, 4096
    s_and_b32 s45, s45, 0xfffff
    ds_read_b128 v[44:47], v7 offset:1344
    v_mfma_f32_16x16x32_bf16 v[16:19], v[128:131], v[32:35], v[16:19]
    v_fma_f32 v9, v41, s34, v11
    s_waitcnt vmcnt(23)
    buffer_load_dwordx4 v[68:71], v5, s[40:43], s45 offen offset:0 nt
    s_add_u32 s45, s45, 4096
    s_and_b32 s45, s45, 0xfffff
    v_mfma_f32_16x16x32_bf16 v[20:23], v[132:135], v[32:35], v[20:23]
    v_exp_f32 v9, v9
    s_waitcnt vmcnt(23)
    buffer_load_dwordx4 v[72:75], v5, s[40:43], s45 offen offset:0 nt
    s_add_u32 s45, s45, 4096
    s_and_b32 s45, s45, 0xfffff
    v_mfma_f32_16x16x32_bf16 v[24:27], v[136:139], v[32:35], v[24:27]
    v_cvt_pk_bf16_f32 v10, v9, v9
    v_and_b32 v36, v10, v12
    s_waitcnt vmcnt(23)
    buffer_load_dwordx4 v[76:79], v5, s[40:43], s45 offen offset:0 nt
    s_add_u32 s45, s45, 4096
    s_and_b32 s45, s45, 0xfffff
    v_mfma_f32_16x16x32_bf16 v[28:31], v[140:143], v[32:35], v[28:31]
    v_and_b32 v37, v10, v13
    v_and_b32 v38, v10, v14
    v_and_b32 v39, v10, v15
    s_waitcnt vmcnt(23)
    buffer_load_dwordx4 v[80:83], v5, s[40:43], s45 offen offset:0 nt
    s_add_u32 s45, s45, 4096
    s_and_b32 s45, s45, 0xfffff
    v_mfma_f32_16x16x32_bf16 v[16:19], v[144:147], v[36:39], v[16:19]
    v_fma_f32 v9, v42, s34, v11
    s_waitcnt vmcnt(23)
    buffer_load_dwordx4 v[84:87], v5, s[40:43], s45 offen offset:0 nt
    s_add_u32 s45, s45, 4096
    s_and_b32 s45, s45, 0xfffff
    v_mfma_f32_16x16x32_bf16 v[20:23], v[148:151], v[36:39], v[20:23]
    v_exp_f32 v9, v9
    s_waitcnt vmcnt(23)
    buffer_load_dwordx4 v[88:91], v5, s[40:43], s45 offen offset:0 nt
    s_add_u32 s45, s45, 4096
    s_and_b32 s45, s45, 0xfffff
    v_mfma_f32_16x16x32_bf16 v[24:27], v[152:155], v[36:39], v[24:27]
    v_cvt_pk_bf16_f32 v10, v9, v9
    v_and_b32 v32, v10, v12
    s_waitcnt vmcnt(23)
    buffer_load_dwordx4 v[92:95], v5, s[40:43], s45 offen offset:0 nt
    s_sub_u32 s45, s45, 28672
    s_and_b32 s45, s45, 0xfffff
    v_mfma_f32_16x16x32_bf16 v[28:31], v[156:159], v[36:39], v[28:31]
    v_and_b32 v33, v10, v13
    v_and_b32 v34, v10, v14
    v_and_b32 v35, v10, v15
    s_waitcnt vmcnt(23)
    buffer_load_dwordx4 v[96:99], v5, s[40:43], s45 offen offset:128 nt
    s_add_u32 s45, s45, 4096
    s_and_b32 s45, s45, 0xfffff
    v_mfma_f32_16x16x32_bf16 v[16:19], v[160:163], v[32:35], v[16:19]
    v_fma_f32 v9, v43, s34, v11
    s_waitcnt vmcnt(23)
    buffer_load_dwordx4 v[100:103], v5, s[40:43], s45 offen offset:128 nt
    s_add_u32 s45, s45, 4096
    s_and_b32 s45, s45, 0xfffff
    v_mfma_f32_16x16x32_bf16 v[20:23], v[164:167], v[32:35], v[20:23]
    v_exp_f32 v9, v9
    s_waitcnt vmcnt(23)
    buffer_load_dwordx4 v[104:107], v5, s[40:43], s45 offen offset:128 nt
    s_add_u32 s45, s45, 4096
    s_and_b32 s45, s45, 0xfffff
    v_mfma_f32_16x16x32_bf16 v[24:27], v[168:171], v[32:35], v[24:27]
    v_cvt_pk_bf16_f32 v10, v9, v9
    v_and_b32 v36, v10, v12
    s_waitcnt vmcnt(23)
    buffer_load_dwordx4 v[108:111], v5, s[40:43], s45 offen offset:128 nt
    s_add_u32 s45, s45, 4096
    s_and_b32 s45, s45, 0xfffff
    v_mfma_f32_16x16x32_bf16 v[28:31], v[172:175], v[32:35], v[28:31]
    v_and_b32 v37, v10, v13
    v_and_b32 v38, v10, v14
    v_and_b32 v39, v10, v15
    s_waitcnt vmcnt(23)
    buffer_load_dwordx4 v[112:115], v5, s[40:43], s45 offen offset:128 nt
    s_add_u32 s45, s45, 4096
    s_and_b32 s45, s45, 0xfffff
    s_waitcnt lgkmcnt(0)
    v_mfma_f32_16x16x32_bf16 v[16:19], v[176:179], v[36:39], v[16:19]
    v_fma_f32 v9, v44, s34, v11
    s_waitcnt vmcnt(23)
    buffer_load_dwordx4 v[116:119], v5, s[40:43], s45 offen offset:128 nt
    s_add_u32 s45, s45, 4096
    s_and_b32 s45, s45, 0xfffff
    v_mfma_f32_16x16x32_bf16 v[20:23], v[180:183], v[36:39], v[20:23]
    v_exp_f32 v9, v9
    s_waitcnt vmcnt(23)
    buffer_load_dwordx4 v[120:123], v5, s[40:43], s45 offen offset:128 nt
    s_add_u32 s45, s45, 4096
    s_and_b32 s45, s45, 0xfffff
    v_mfma_f32_16x16x32_bf16 v[24:27], v[184:187], v[36:39], v[24:27]
    v_cvt_pk_bf16_f32 v10, v9, v9
    v_and_b32 v32, v10, v12
    s_waitcnt vmcnt(23)
    buffer_load_dwordx4 v[124:127], v5, s[40:43], s45 offen offset:128 nt
    s_sub_u32 s45, s45, 28672
    s_and_b32 s45, s45, 0xfffff
    v_mfma_f32_16x16x32_bf16 v[28:31], v[188:191], v[36:39], v[28:31]
    v_and_b32 v33, v10, v13
    v_and_b32 v34, v10, v14
    v_and_b32 v35, v10, v15
    s_waitcnt vmcnt(23)
    buffer_load_dwordx4 v[128:131], v5, s[40:43], s45 offen offset:256 nt
    s_add_u32 s45, s45, 4096
    s_and_b32 s45, s45, 0xfffff
    ds_read_b128 v[48:51], v7 offset:1360
    v_mfma_f32_16x16x32_bf16 v[16:19], v[192:195], v[32:35], v[16:19]
    v_fma_f32 v9, v45, s34, v11
    s_waitcnt vmcnt(23)
    buffer_load_dwordx4 v[132:135], v5, s[40:43], s45 offen offset:256 nt
    s_add_u32 s45, s45, 4096
    s_and_b32 s45, s45, 0xfffff
    v_mfma_f32_16x16x32_bf16 v[20:23], v[196:199], v[32:35], v[20:23]
    v_exp_f32 v9, v9
    s_waitcnt vmcnt(23)
    buffer_load_dwordx4 v[136:139], v5, s[40:43], s45 offen offset:256 nt
    s_add_u32 s45, s45, 4096
    s_and_b32 s45, s45, 0xfffff
    v_mfma_f32_16x16x32_bf16 v[24:27], v[200:203], v[32:35], v[24:27]
    v_cvt_pk_bf16_f32 v10, v9, v9
    v_and_b32 v36, v10, v12
    s_waitcnt vmcnt(23)
    buffer_load_dwordx4 v[140:143], v5, s[40:43], s45 offen offset:256 nt
    s_add_u32 s45, s45, 4096
    s_and_b32 s45, s45, 0xfffff
    v_mfma_f32_16x16x32_bf16 v[28:31], v[204:207], v[32:35], v[28:31]
    v_and_b32 v37, v10, v13
    v_and_b32 v38, v10, v14
    v_and_b32 v39, v10, v15
    s_waitcnt vmcnt(23)
    buffer_load_dwordx4 v[144:147], v5, s[40:43], s45 offen offset:256 nt
    s_add_u32 s45, s45, 4096
    s_and_b32 s45, s45, 0xfffff
    v_mfma_f32_16x16x32_bf16 v[16:19], v[208:211], v[36:39], v[16:19]
    v_fma_f32 v9, v46, s34, v11
    s_waitcnt vmcnt(23)
    buffer_load_dwordx4 v[148:151], v5, s[40:43], s45 offen offset:256 nt
    s_add_u32 s45, s45, 4096
    s_and_b32 s45, s45, 0xfffff
    v_mfma_f32_16x16x32_bf16 v[20:23], v[212:215], v[36:39], v[20:23]
    v_exp_f32 v9, v9
    s_waitcnt vmcnt(23)
    buffer_load_dwordx4 v[152:155], v5, s[40:43], s45 offen offset:256 nt
    s_add_u32 s45, s45, 4096
    s_and_b32 s45, s45, 0xfffff
    v_mfma_f32_16x16x32_bf16 v[24:27], v[216:219], v[36:39], v[24:27]
    v_cvt_pk_bf16_f32 v10, v9, v9
    v_and_b32 v32, v10, v12
    s_waitcnt vmcnt(23)
    buffer_load_dwordx4 v[156:159], v5, s[40:43], s45 offen offset:256 nt
    s_sub_u32 s45, s45, 28672
    s_and_b32 s45, s45, 0xfffff
    v_mfma_f32_16x16x32_bf16 v[28:31], v[220:223], v[36:39], v[28:31]
    v_and_b32 v33, v10, v13
    v_and_b32 v34, v10, v14
    v_and_b32 v35, v10, v15
    s_waitcnt vmcnt(23)
    buffer_load_dwordx4 v[160:163], v5, s[40:43], s45 offen offset:384 nt
    s_add_u32 s45, s45, 4096
    s_and_b32 s45, s45, 0xfffff
    v_mfma_f32_16x16x32_bf16 v[16:19], v[224:227], v[32:35], v[16:19]
    v_fma_f32 v9, v47, s34, v11
    s_waitcnt vmcnt(23)
    buffer_load_dwordx4 v[164:167], v5, s[40:43], s45 offen offset:384 nt
    s_add_u32 s45, s45, 4096
    s_and_b32 s45, s45, 0xfffff
    v_mfma_f32_16x16x32_bf16 v[20:23], v[228:231], v[32:35], v[20:23]
    v_exp_f32 v9, v9
    s_waitcnt vmcnt(23)
    buffer_load_dwordx4 v[168:171], v5, s[40:43], s45 offen offset:384 nt
    s_add_u32 s45, s45, 4096
    s_and_b32 s45, s45, 0xfffff
    v_mfma_f32_16x16x32_bf16 v[24:27], v[232:235], v[32:35], v[24:27]
    v_cvt_pk_bf16_f32 v10, v9, v9
    v_and_b32 v36, v10, v12
    s_waitcnt vmcnt(23)
    buffer_load_dwordx4 v[172:175], v5, s[40:43], s45 offen offset:384 nt
    s_add_u32 s45, s45, 4096
    s_and_b32 s45, s45, 0xfffff
    v_mfma_f32_16x16x32_bf16 v[28:31], v[236:239], v[32:35], v[28:31]
    v_and_b32 v37, v10, v13
    v_and_b32 v38, v10, v14
    v_and_b32 v39, v10, v15
    s_waitcnt vmcnt(23)
    buffer_load_dwordx4 v[176:179], v5, s[40:43], s45 offen offset:384 nt
    s_add_u32 s45, s45, 4096
    s_and_b32 s45, s45, 0xfffff
    s_waitcnt lgkmcnt(0)
    v_mfma_f32_16x16x32_bf16 v[16:19], v[240:243], v[36:39], v[16:19]
    v_fma_f32 v9, v48, s34, v11
    s_waitcnt vmcnt(23)
    buffer_load_dwordx4 v[180:183], v5, s[40:43], s45 offen offset:384 nt
    s_add_u32 s45, s45, 4096
    s_and_b32 s45, s45, 0xfffff
    v_mfma_f32_16x16x32_bf16 v[20:23], v[244:247], v[36:39], v[20:23]
    v_exp_f32 v9, v9
    s_waitcnt vmcnt(23)
    buffer_load_dwordx4 v[184:187], v5, s[40:43], s45 offen offset:384 nt
    s_add_u32 s45, s45, 4096
    s_and_b32 s45, s45, 0xfffff
    v_mfma_f32_16x16x32_bf16 v[24:27], v[248:251], v[36:39], v[24:27]
    v_cvt_pk_bf16_f32 v10, v9, v9
    v_and_b32 v192, v10, v12
    s_waitcnt vmcnt(23)
    buffer_load_dwordx4 v[188:191], v5, s[40:43], s45 offen offset:384 nt
    v_mfma_f32_16x16x32_bf16 v[28:31], v[252:255], v[36:39], v[28:31]
    v_and_b32 v193, v10, v13
    v_and_b32 v194, v10, v14
    v_and_b32 v195, v10, v15
    ds_read_b128 v[40:43], v7 offset:1376
    s_nop 0
    v_mfma_f32_16x16x32_bf16 v[16:19], v[64:67], v[192:195], v[16:19]
    v_fma_f32 v9, v49, s34, v11
    v_exp_f32 v9, v9
    s_nop 0
    v_cvt_pk_bf16_f32 v10, v9, v9
    v_and_b32 v196, v10, v12
    v_and_b32 v197, v10, v13
    v_and_b32 v198, v10, v14
    v_and_b32 v199, v10, v15
    s_nop 1
    v_mfma_f32_16x16x32_bf16 v[16:19], v[68:71], v[196:199], v[16:19]
    v_fma_f32 v9, v50, s34, v11
    v_exp_f32 v9, v9
    s_nop 0
    v_cvt_pk_bf16_f32 v10, v9, v9
    v_and_b32 v200, v10, v12
    v_and_b32 v201, v10, v13
    v_and_b32 v202, v10, v14
    v_and_b32 v203, v10, v15
    s_nop 1
    v_mfma_f32_16x16x32_bf16 v[16:19], v[72:75], v[200:203], v[16:19]
    v_fma_f32 v9, v51, s34, v11
    v_exp_f32 v9, v9
    s_nop 0
    v_cvt_pk_bf16_f32 v10, v9, v9
    v_and_b32 v204, v10, v12
    v_and_b32 v205, v10, v13
    v_and_b32 v206, v10, v14
    v_and_b32 v207, v10, v15
    s_waitcnt lgkmcnt(0)
    s_nop 0
    v_mfma_f32_16x16x32_bf16 v[16:19], v[76:79], v[204:207], v[16:19]
    v_fma_f32 v9, v40, s34, v11
    v_exp_f32 v9, v9
    s_nop 0
    v_cvt_pk_bf16_f32 v10, v9, v9
    v_and_b32 v208, v10, v12
    v_and_b32 v209, v10, v13
    v_and_b32 v210, v10, v14
    v_and_b32 v211, v10, v15
    s_nop 1
    v_mfma_f32_16x16x32_bf16 v[16:19], v[80:83], v[208:211], v[16:19]
    v_fma_f32 v9, v41, s34, v11
    v_exp_f32 v9, v9
    s_nop 0
    v_cvt_pk_bf16_f32 v10, v9, v9
    v_and_b32 v212, v10, v12
    v_and_b32 v213, v10, v13
    v_and_b32 v214, v10, v14
    v_and_b32 v215, v10, v15
    s_nop 1
    v_mfma_f32_16x16x32_bf16 v[16:19], v[84:87], v[212:215], v[16:19]
    v_fma_f32 v9, v42, s34, v11
    v_exp_f32 v9, v9
    s_nop 0
    v_cvt_pk_bf16_f32 v10, v9, v9
    v_and_b32 v216, v10, v12
    v_and_b32 v217, v10, v13
    v_and_b32 v218, v10, v14
    v_and_b32 v219, v10, v15
    s_nop 1
    v_mfma_f32_16x16x32_bf16 v[16:19], v[88:91], v[216:219], v[16:19]
    v_fma_f32 v9, v43, s34, v11
    v_exp_f32 v9, v9
    s_nop 0
    v_cvt_pk_bf16_f32 v10, v9, v9
    v_and_b32 v220, v10, v12
    v_and_b32 v221, v10, v13
    v_and_b32 v222, v10, v14
    v_and_b32 v223, v10, v15
    s_nop 1
    v_mfma_f32_16x16x32_bf16 v[16:19], v[92:95], v[220:223], v[16:19]
    s_waitcnt vmcnt(23)
    s_nop 0
    v_mfma_f32_16x16x32_bf16 v[20:23], v[96:99], v[192:195], v[20:23]
    s_waitcnt vmcnt(22)
    s_nop 0
    v_mfma_f32_16x16x32_bf16 v[20:23], v[100:103], v[196:199], v[20:23]
    s_waitcnt vmcnt(21)
    s_nop 0
    v_mfma_f32_16x16x32_bf16 v[20:23], v[104:107], v[200:203], v[20:23]
    v_permlane32_swap_b32 v16, v17
    v_permlane32_swap_b32 v18, v19
    s_nop 1
    v_add_f32_dpp v52, v17, v16 row_ror:8 row_mask:0xf bank_mask:0xf
    v_add_f32_dpp v53, v19, v18 row_ror:8 row_mask:0xf bank_mask:0xf
    v_cvt_pk_bf16_f32 v52, v52, v53
    s_mov_b64 exec, s[60:61]
    ds_write_b32 v8, v52 offset:768
    s_mov_b64 exec, -1
    s_waitcnt vmcnt(20)
    s_nop 0
    v_mfma_f32_16x16x32_bf16 v[20:23], v[108:111], v[204:207], v[20:23]
    s_waitcnt lgkmcnt(0)
    s_barrier
    s_waitcnt vmcnt(19)
    s_nop 0
    v_mfma_f32_16x16x32_bf16 v[20:23], v[112:115], v[208:211], v[20:23]
    s_waitcnt vmcnt(18)
    s_nop 0
    v_mfma_f32_16x16x32_bf16 v[20:23], v[116:119], v[212:215], v[20:23]
    s_waitcnt vmcnt(17)
    s_nop 0
    v_mfma_f32_16x16x32_bf16 v[20:23], v[120:123], v[216:219], v[20:23]
    s_waitcnt vmcnt(16)
    s_nop 0
    v_mfma_f32_16x16x32_bf16 v[20:23], v[124:127], v[220:223], v[20:23]
    s_waitcnt vmcnt(15)
    s_nop 0
    v_mfma_f32_16x16x32_bf16 v[24:27], v[128:131], v[192:195], v[24:27]
    s_waitcnt vmcnt(14)
    s_nop 0
    v_mfma_f32_16x16x32_bf16 v[24:27], v[132:135], v[196:199], v[24:27]
    s_waitcnt vmcnt(13)
    s_nop 0
    v_mfma_f32_16x16x32_bf16 v[24:27], v[136:139], v[200:203], v[24:27]
    v_permlane32_swap_b32 v20, v21
    v_permlane32_swap_b32 v22, v23
    s_nop 1
    v_add_f32_dpp v52, v21, v20 row_ror:8 row_mask:0xf bank_mask:0xf
    v_add_f32_dpp v53, v23, v22 row_ror:8 row_mask:0xf bank_mask:0xf
    v_cvt_pk_bf16_f32 v52, v52, v53
    s_mov_b64 exec, s[60:61]
    ds_write_b32 v8, v52 offset:896
    s_mov_b64 exec, -1
    s_waitcnt vmcnt(12)
    s_nop 0
    v_mfma_f32_16x16x32_bf16 v[24:27], v[140:143], v[204:207], v[24:27]
    s_waitcnt lgkmcnt(0)
    s_barrier
    s_waitcnt vmcnt(11)
    s_nop 0
    v_mfma_f32_16x16x32_bf16 v[24:27], v[144:147], v[208:211], v[24:27]
    s_waitcnt vmcnt(10)
    s_nop 0
    v_mfma_f32_16x16x32_bf16 v[24:27], v[148:151], v[212:215], v[24:27]
    s_waitcnt vmcnt(9)
    s_nop 0
    v_mfma_f32_16x16x32_bf16 v[24:27], v[152:155], v[216:219], v[24:27]
    s_waitcnt vmcnt(8)
    s_nop 0
    v_mfma_f32_16x16x32_bf16 v[24:27], v[156:159], v[220:223], v[24:27]
    s_waitcnt vmcnt(7)
    s_nop 0
    v_mfma_f32_16x16x32_bf16 v[28:31], v[160:163], v[192:195], v[28:31]
    s_waitcnt vmcnt(6)
    s_nop 0
    v_mfma_f32_16x16x32_bf16 v[28:31], v[164:167], v[196:199], v[28:31]
    s_waitcnt vmcnt(5)
    s_nop 0
    v_mfma_f32_16x16x32_bf16 v[28:31], v[168:171], v[200:203], v[28:31]
    v_permlane32_swap_b32 v24, v25
    v_permlane32_swap_b32 v26, v27
    s_nop 1
    v_add_f32_dpp v52, v25, v24 row_ror:8 row_mask:0xf bank_mask:0xf
    v_add_f32_dpp v53, v27, v26 row_ror:8 row_mask:0xf bank_mask:0xf
    v_cvt_pk_bf16_f32 v52, v52, v53
    s_mov_b64 exec, s[60:61]
    ds_write_b32 v8, v52 offset:1024
    s_mov_b64 exec, -1
    s_waitcnt vmcnt(4)
    s_nop 0
    v_mfma_f32_16x16x32_bf16 v[28:31], v[172:175], v[204:207], v[28:31]
    s_waitcnt lgkmcnt(0)
    s_barrier
    s_waitcnt vmcnt(3)
    s_nop 0
    v_mfma_f32_16x16x32_bf16 v[28:31], v[176:179], v[208:211], v[28:31]
    s_waitcnt vmcnt(2)
    s_nop 0
    v_mfma_f32_16x16x32_bf16 v[28:31], v[180:183], v[212:215], v[28:31]
    s_waitcnt vmcnt(1)
    s_nop 0
    v_mfma_f32_16x16x32_bf16 v[28:31], v[184:187], v[216:219], v[28:31]
    s_waitcnt vmcnt(0)
    s_nop 0
    v_mfma_f32_16x16x32_bf16 v[28:31], v[188:191], v[220:223], v[28:31]
    v_and_b32 v7, 15, v0
    v_lshlrev_b32 v7, 3, v7
    v_mov_b32 v5, 0
    s_nop 4
    v_permlane32_swap_b32 v28, v29
    v_permlane32_swap_b32 v30, v31
    s_nop 1
    v_add_f32_dpp v52, v29, v28 row_ror:8 row_mask:0xf bank_mask:0xf
    v_add_f32_dpp v53, v31, v30 row_ror:8 row_mask:0xf bank_mask:0xf
    v_cvt_pk_bf16_f32 v52, v52, v53
    s_mov_b64 exec, s[60:61]
    ds_write_b32 v8, v52 offset:1152
    s_mov_b64 exec, -1
    s_waitcnt lgkmcnt(0)
    s_barrier
    s_cmp_ge_u32 s32, 28
    s_cbranch_scc1 L_sdone
    ds_read_b32 v12, v5 offset:580
    ds_read_b64 v[14:15], v7 offset:640
    s_barrier
    buffer_load_dwordx4 v[16:19], v4, s[52:55], 0 offen offset:0 sc1
    buffer_load_dwordx4 v[20:23], v4, s[52:55], s47 offen offset:0 sc1
    buffer_load_dwordx4 v[32:35], v4, s[52:55], 0 offen offset:0 sc1
    buffer_load_dwordx4 v[36:39], v4, s[52:55], s47 offen offset:0 sc1
    s_waitcnt lgkmcnt(0)
L_fp:
    s_waitcnt vmcnt(3)
    v_xor_b32 v13, v16, v12
    v_bitop3_b32 v13, v17, v12, v13 bitop3:0xbe
    v_bitop3_b32 v13, v18, v12, v13 bitop3:0xbe
    v_bitop3_b32 v13, v19, v12, v13 bitop3:0xbe
    s_waitcnt vmcnt(2)
    v_bitop3_b32 v13, v20, v12, v13 bitop3:0xbe
    v_bitop3_b32 v13, v21, v12, v13 bitop3:0xbe
    v_bitop3_b32 v13, v22, v12, v13 bitop3:0xbe
    v_bitop3_b32 v13, v23, v12, v13 bitop3:0xbe
    v_and_b32 v13, 0xfff, v13
    v_cmp_ne_u32 vcc, 0, v13
    s_sub_u32 s49, s49, 1
    s_cbranch_scc1 L_fa
    s_cbranch_vccz L_fa
    buffer_load_dwordx4 v[16:19], v4, s[52:55], 0 offen offset:0 sc1
    buffer_load_dwordx4 v[20:23], v4, s[52:55], s47 offen offset:0 sc1
    s_waitcnt vmcnt(3)
    v_xor_b32 v13, v32, v12
    v_bitop3_b32 v13, v33, v12, v13 bitop3:0xbe
    v_bitop3_b32 v13, v34, v12, v13 bitop3:0xbe
    v_bitop3_b32 v13, v35, v12, v13 bitop3:0xbe
    s_waitcnt vmcnt(2)
    v_bitop3_b32 v13, v36, v12, v13 bitop3:0xbe
    v_bitop3_b32 v13, v37, v12, v13 bitop3:0xbe
    v_bitop3_b32 v13, v38, v12, v13 bitop3:0xbe
    v_bitop3_b32 v13, v39, v12, v13 bitop3:0xbe
    v_and_b32 v13, 0xfff, v13
    v_cmp_ne_u32 vcc, 0, v13
    s_cbranch_vccz L_fb
    buffer_load_dwordx4 v[32:35], v4, s[52:55], 0 offen offset:0 sc1
    buffer_load_dwordx4 v[36:39], v4, s[52:55], s47 offen offset:0 sc1
    s_branch L_fp
L_fb:
    v_xor_b32 v32, v32, v12
    v_xor_b32 v33, v33, v12
    v_xor_b32 v34, v34, v12
    v_xor_b32 v35, v35, v12
    v_xor_b32 v36, v36, v12
    v_xor_b32 v37, v37, v12
    v_xor_b32 v38, v38, v12
    v_xor_b32 v39, v39, v12
    v_add_f32 v32, v32, v36
    v_add_f32 v33, v33, v37
    v_add_f32 v34, v34, v38
    v_add_f32 v35, v35, v39
    v_add_f32_dpp v32, v32, v32 row_ror:4 row_mask:0xf bank_mask:0xf
    v_add_f32_dpp v33, v33, v33 row_ror:4 row_mask:0xf bank_mask:0xf
    v_add_f32_dpp v34, v34, v34 row_ror:4 row_mask:0xf bank_mask:0xf
    v_add_f32_dpp v35, v35, v35 row_ror:4 row_mask:0xf bank_mask:0xf
    v_add_f32_dpp v32, v32, v32 row_ror:8 row_mask:0xf bank_mask:0xf
    v_add_f32_dpp v33, v33, v33 row_ror:8 row_mask:0xf bank_mask:0xf
    v_add_f32_dpp v34, v34, v34 row_ror:8 row_mask:0xf bank_mask:0xf
    v_add_f32_dpp v35, v35, v35 row_ror:8 row_mask:0xf bank_mask:0xf
    v_mov_b32_dpp v32, v33 quad_perm:[0,1,2,3] row_mask:0xf bank_mask:0x2
    v_mov_b32_dpp v32, v34 quad_perm:[0,1,2,3] row_mask:0xf bank_mask:0x4
    v_mov_b32_dpp v32, v35 quad_perm:[0,1,2,3] row_mask:0xf bank_mask:0x8
    v_mov_b32 v33, v32
    s_nop 1
    v_permlane16_swap_b32 v32, v33
    v_add_f32 v32, v32, v33
    v_mov_b32 v33, v32
    s_nop 1
    v_permlane32_swap_b32 v32, v33
    v_add_f32 v32, v32, v33
    v_cvt_pk_bf16_f32 v32, 0, v32
    v_add_f32 v32, v14, v32
    v_cvt_pk_bf16_f32 v32, 0, v32
    v_add_f32 v32, v32, v15
    v_cvt_pk_bf16_f32 v32, v32, v32
    s_mov_b64 exec, 0xffff
    buffer_store_short v32, v6, s[92:95], 0 offen
    s_branch L_sdone
L_fa:
    v_xor_b32 v16, v16, v12
    v_xor_b32 v17, v17, v12
    v_xor_b32 v18, v18, v12
    v_xor_b32 v19, v19, v12
    v_xor_b32 v20, v20, v12
    v_xor_b32 v21, v21, v12
    v_xor_b32 v22, v22, v12
    v_xor_b32 v23, v23, v12
    v_add_f32 v16, v16, v20
    v_add_f32 v17, v17, v21
    v_add_f32 v18, v18, v22
    v_add_f32 v19, v19, v23
    v_add_f32_dpp v16, v16, v16 row_ror:4 row_mask:0xf bank_mask:0xf
    v_add_f32_dpp v17, v17, v17 row_ror:4 row_mask:0xf bank_mask:0xf
    v_add_f32_dpp v18, v18, v18 row_ror:4 row_mask:0xf bank_mask:0xf
    v_add_f32_dpp v19, v19, v19 row_ror:4 row_mask:0xf bank_mask:0xf
    v_add_f32_dpp v16, v16, v16 row_ror:8 row_mask:0xf bank_mask:0xf
    v_add_f32_dpp v17, v17, v17 row_ror:8 row_mask:0xf bank_mask:0xf
    v_add_f32_dpp v18, v18, v18 row_ror:8 row_mask:0xf bank_mask:0xf
    v_add_f32_dpp v19, v19, v19 row_ror:8 row_mask:0xf bank_mask:0xf
    v_mov_b32_dpp v16, v17 quad_perm:[0,1,2,3] row_mask:0xf bank_mask:0x2
    v_mov_b32_dpp v16, v18 quad_perm:[0,1,2,3] row_mask:0xf bank_mask:0x4
    v_mov_b32_dpp v16, v19 quad_perm:[0,1,2,3] row_mask:0xf bank_mask:0x8
    v_mov_b32 v17, v16
    s_nop 1
    v_permlane16_swap_b32 v16, v17
    v_add_f32 v16, v16, v17
    v_mov_b32 v17, v16
    s_nop 1
    v_permlane32_swap_b32 v16, v17
    v_add_f32 v16, v16, v17
    v_cvt_pk_bf16_f32 v16, 0, v16
    v_add_f32 v16, v14, v16
    v_cvt_pk_bf16_f32 v16, 0, v16
    v_add_f32 v16, v16, v15
    v_cvt_pk_bf16_f32 v16, v16, v16
    s_mov_b64 exec, 0xffff
    buffer_store_short v16, v6, s[92:95], 0 offen
L_sdone:
    s_endpgm
L_buf:
    s_setprio 3
    v_mov_b32 v32, 0
    v_mov_b32 v33, 1
    ds_write_b32 v32, v33 offset:588
    v_lshlrev_b32 v4, 9, v2
    v_lshl_add_u32 v4, v3, 4, v4
    v_mul_u32_u24 v6, 1040, v2
    v_lshrrev_b32 v7, 2, v3
    v_lshl_add_u32 v6, v7, 2, v6
    v_mov_b32 v8, 0xff800000
    s_lshl_b32 s35, s33, 20
    s_waitcnt lgkmcnt(0)
    s_add_u32 s84, s6, s35
    s_addc_u32 s85, s7, 0
    s_mov_b32 s86, 1048576
    s_mov_b32 s87, 0x20000
    s_sub_u32 s47, s3, 4
    s_lshl_b32 s44, s47, 13
    s_add_u32 s44, s44, s98
    s_and_b32 s44, s44, 0xfffff
    s_lshl_b32 s47, s47, 3
    v_add_u32 v6, s47, v6
    s_cmp_eq_u32 s28, 1
    s_cbranch_scc1 L_b0_3
    s_barrier
L_b0_3:
    buffer_load_dwordx4 v[64:67], v4, s[84:87], s44 offen offset:0 nt
    buffer_load_dwordx4 v[68:71], v4, s[84:87], s44 offen offset:128 nt
    buffer_load_dwordx4 v[72:75], v4, s[84:87], s44 offen offset:256 nt
    buffer_load_dwordx4 v[76:79], v4, s[84:87], s44 offen offset:384 nt
    s_add_u32 s44, s44, 4096
    s_and_b32 s44, s44, 0xfffff
    buffer_load_dwordx4 v[80:83], v4, s[84:87], s44 offen offset:0 nt
    buffer_load_dwordx4 v[84:87], v4, s[84:87], s44 offen offset:128 nt
    buffer_load_dwordx4 v[88:91], v4, s[84:87], s44 offen offset:256 nt
    buffer_load_dwordx4 v[92:95], v4, s[84:87], s44 offen offset:384 nt
    s_add_u32 s44, s44, 28672
    s_and_b32 s44, s44, 0xfffff
    buffer_load_dwordx4 v[96:99], v4, s[84:87], s44 offen offset:0 nt
    buffer_load_dwordx4 v[100:103], v4, s[84:87], s44 offen offset:128 nt
    s_lshl_b32 s47, s33, 12
    s_add_u32 s36, s24, s47
    s_addc_u32 s37, s25, 0
    s_mov_b32 s38, 4096
    s_mov_b32 s39, 0x20000
    s_lshl_b32 s47, s30, 17
    s_add_u32 s40, s24, s47
    s_addc_u32 s41, s25, 0
    s_mov_b32 s42, 131072
    s_mov_b32 s43, 0x20000
    s_mov_b32 s56, s22
    s_mov_b32 s57, s23
    s_mov_b32 s58, 256
    s_mov_b32 s59, 0x20000
    s_cmp_lg_u32 s3, 5
    s_cbranch_scc1 L_notag
    s_cmp_lg_u32 s2, 0
    s_cbranch_scc1 L_notag
    s_add_u32 s92, s24, 0x100000
    s_addc_u32 s93, s25, 0
    s_mov_b32 s94, 256
    s_mov_b32 s95, 0x20000
    s_memrealtime s[62:63]
    buffer_load_dword v32, off, s[92:95], 0 sc1
    s_waitcnt vmcnt(0) lgkmcnt(0)
    s_and_b32 s62, s62, 0x7ff
    s_add_u32 s62, s62, 1
    v_add_u32 v32, s62, v32
    v_and_b32 v32, 0xfff, v32
    v_or_b32 v33, 0x1000, v32
    s_mov_b64 exec, 1
    buffer_store_dword v33, off, s[56:59], 0 sc1
    buffer_store_dword v32, off, s[92:95], 0 sc1
    s_mov_b64 exec, -1
L_notag:
    s_waitcnt vmcnt(9)
    buffer_load_dwordx4 v[104:107], v4, s[84:87], s44 offen offset:256 nt
    s_waitcnt vmcnt(9)
    buffer_load_dwordx4 v[108:111], v4, s[84:87], s44 offen offset:384 nt
    s_add_u32 s44, s44, 4096
    s_and_b32 s44, s44, 0xfffff
    s_waitcnt vmcnt(9)
    buffer_load_dwordx4 v[112:115], v4, s[84:87], s44 offen offset:0 nt
    s_waitcnt vmcnt(9)
    buffer_load_dwordx4 v[116:119], v4, s[84:87], s44 offen offset:128 nt
    s_waitcnt vmcnt(9)
    buffer_load_dwordx4 v[120:123], v4, s[84:87], s44 offen offset:256 nt
    s_waitcnt vmcnt(9)
    buffer_load_dwordx4 v[124:127], v4, s[84:87], s44 offen offset:384 nt
    s_add_u32 s44, s44, 28672
    s_and_b32 s44, s44, 0xfffff
    s_waitcnt vmcnt(9)
    buffer_load_dwordx4 v[128:131], v4, s[84:87], s44 offen offset:0 nt
    s_waitcnt vmcnt(9)
    buffer_load_dwordx4 v[132:135], v4, s[84:87], s44 offen offset:128 nt
    s_waitcnt vmcnt(9)
    buffer_load_dwordx4 v[136:139], v4, s[84:87], s44 offen offset:256 nt
    s_waitcnt vmcnt(9)
    buffer_load_dwordx4 v[140:143], v4, s[84:87], s44 offen offset:384 nt
    s_add_u32 s44, s44, 4096
    s_and_b32 s44, s44, 0xfffff
    s_waitcnt vmcnt(9)
    buffer_load_dwordx4 v[144:147], v4, s[84:87], s44 offen offset:0 nt
    s_waitcnt vmcnt(9)
    buffer_load_dwordx4 v[148:151], v4, s[84:87], s44 offen offset:128 nt
    s_waitcnt vmcnt(9)
    buffer_load_dwordx4 v[152:155], v4, s[84:87], s44 offen offset:256 nt
    s_waitcnt vmcnt(9)
    buffer_load_dwordx4 v[156:159], v4, s[84:87], s44 offen offset:384 nt
    s_add_u32 s44, s44, 28672
    s_and_b32 s44, s44, 0xfffff
    s_waitcnt vmcnt(9)
    buffer_load_dwordx4 v[160:163], v4, s[84:87], s44 offen offset:0 nt
    s_waitcnt vmcnt(9)
    buffer_load_dwordx4 v[164:167], v4, s[84:87], s44 offen offset:128 nt
    s_waitcnt vmcnt(9)
    buffer_load_dwordx4 v[168:171], v4, s[84:87], s44 offen offset:256 nt
    s_waitcnt vmcnt(9)
    buffer_load_dwordx4 v[172:175], v4, s[84:87], s44 offen offset:384 nt
    s_add_u32 s44, s44, 4096
    s_and_b32 s44, s44, 0xfffff
    s_waitcnt vmcnt(9)
    buffer_load_dwordx4 v[176:179], v4, s[84:87], s44 offen offset:0 nt
    s_waitcnt vmcnt(9)
    buffer_load_dwordx4 v[180:183], v4, s[84:87], s44 offen offset:128 nt
    s_waitcnt vmcnt(9)
    buffer_load_dwordx4 v[184:187], v4, s[84:87], s44 offen offset:256 nt
    s_waitcnt vmcnt(9)
    buffer_load_dwordx4 v[188:191], v4, s[84:87], s44 offen offset:384 nt
    s_add_u32 s44, s44, 28672
    s_and_b32 s44, s44, 0xfffff
    s_waitcnt vmcnt(9)
    buffer_load_dwordx4 v[192:195], v4, s[84:87], s44 offen offset:0 nt
    s_waitcnt vmcnt(9)
    buffer_load_dwordx4 v[196:199], v4, s[84:87], s44 offen offset:128 nt
    s_waitcnt vmcnt(9)
    buffer_load_dwordx4 v[200:203], v4, s[84:87], s44 offen offset:256 nt
    s_waitcnt vmcnt(9)
    buffer_load_dwordx4 v[204:207], v4, s[84:87], s44 offen offset:384 nt
    s_add_u32 s44, s44, 4096
    s_and_b32 s44, s44, 0xfffff
    s_waitcnt vmcnt(9)
    buffer_load_dwordx4 v[208:211], v4, s[84:87], s44 offen offset:0 nt
    s_waitcnt vmcnt(9)
    buffer_load_dwordx4 v[212:215], v4, s[84:87], s44 offen offset:128 nt
    s_waitcnt vmcnt(9)
    buffer_load_dwordx4 v[216:219], v4, s[84:87], s44 offen offset:256 nt
    s_waitcnt vmcnt(9)
    buffer_load_dwordx4 v[220:223], v4, s[84:87], s44 offen offset:384 nt
    s_add_u32 s44, s44, 28672
    s_and_b32 s44, s44, 0xfffff
    s_waitcnt vmcnt(9)
    buffer_load_dwordx4 v[224:227], v4, s[84:87], s44 offen offset:0 nt
    s_waitcnt vmcnt(9)
    buffer_load_dwordx4 v[228:231], v4, s[84:87], s44 offen offset:128 nt
    s_waitcnt vmcnt(9)
    buffer_load_dwordx4 v[232:235], v4, s[84:87], s44 offen offset:256 nt
    s_waitcnt vmcnt(9)
    buffer_load_dwordx4 v[236:239], v4, s[84:87], s44 offen offset:384 nt
    s_add_u32 s44, s44, 4096
    s_and_b32 s44, s44, 0xfffff
    s_waitcnt vmcnt(9)
    buffer_load_dwordx4 v[240:243], v4, s[84:87], s44 offen offset:0 nt
    s_waitcnt vmcnt(9)
    buffer_load_dwordx4 v[244:247], v4, s[84:87], s44 offen offset:128 nt
    s_waitcnt vmcnt(9)
    buffer_load_dwordx4 v[248:251], v4, s[84:87], s44 offen offset:256 nt
    s_waitcnt vmcnt(9)
    buffer_load_dwordx4 v[252:255], v4, s[84:87], s44 offen offset:384 nt
    s_add_u32 s44, s44, 28672
    s_and_b32 s44, s44, 0xfffff
    s_cmp_eq_u32 s28, 0
    s_cbranch_scc1 L_b0_4
    s_barrier
L_b0_4:
    s_barrier
    s_setprio 0
    v_lshlrev_b32 v9, 4, v3
    ds_read_b128 v[16:19], v9 offset:0
    ds_read_b128 v[20:23], v9 offset:128
    ds_read_b128 v[24:27], v9 offset:256
    ds_read_b128 v[28:31], v9 offset:384
    s_waitcnt lgkmcnt(0)
    s_waitcnt vmcnt(47)
    v_dot2_f32_bf16 v11, v64, v16, 0
    v_dot2_f32_bf16 v12, v65, v17, 0
    v_dot2_f32_bf16 v11, v66, v18, v11
    v_dot2_f32_bf16 v12, v67, v19, v12
    s_waitcnt vmcnt(46)
    v_dot2_f32_bf16 v11, v68, v20, v11
    v_dot2_f32_bf16 v12, v69, v21, v12
    v_dot2_f32_bf16 v11, v70, v22, v11
    v_dot2_f32_bf16 v12, v71, v23, v12
    s_waitcnt vmcnt(45)
    v_dot2_f32_bf16 v11, v72, v24, v11
    v_dot2_f32_bf16 v12, v73, v25, v12
    v_dot2_f32_bf16 v11, v74, v26, v11
    v_dot2_f32_bf16 v12, v75, v27, v12
    s_waitcnt vmcnt(44)
    v_dot2_f32_bf16 v11, v76, v28, v11
    v_dot2_f32_bf16 v12, v77, v29, v12
    v_dot2_f32_bf16 v11, v78, v30, v11
    v_dot2_f32_bf16 v12, v79, v31, v12
    s_waitcnt vmcnt(43)
    v_dot2_f32_bf16 v13, v80, v16, 0
    v_dot2_f32_bf16 v14, v81, v17, 0
    v_dot2_f32_bf16 v13, v82, v18, v13
    v_dot2_f32_bf16 v14, v83, v19, v14
    v_add_f32 v11, v11, v12
    s_waitcnt vmcnt(42)
    v_dot2_f32_bf16 v13, v84, v20, v13
    v_dot2_f32_bf16 v14, v85, v21, v14
    v_dot2_f32_bf16 v13, v86, v22, v13
    v_dot2_f32_bf16 v14, v87, v23, v14
    v_add_f32_dpp v9, v11, v11 row_half_mirror row_mask:0xf bank_mask:0x5
    s_waitcnt vmcnt(41)
    v_dot2_f32_bf16 v13, v88, v24, v13
    v_dot2_f32_bf16 v14, v89, v25, v14
    v_dot2_f32_bf16 v13, v90, v26, v13
    v_dot2_f32_bf16 v14, v91, v27, v14
    s_waitcnt vmcnt(40)
    v_dot2_f32_bf16 v13, v92, v28, v13
    v_dot2_f32_bf16 v14, v93, v29, v14
    v_dot2_f32_bf16 v13, v94, v30, v13
    v_dot2_f32_bf16 v14, v95, v31, v14
    s_waitcnt vmcnt(39)
    v_dot2_f32_bf16 v11, v96, v16, 0
    v_dot2_f32_bf16 v12, v97, v17, 0
    v_dot2_f32_bf16 v11, v98, v18, v11
    v_dot2_f32_bf16 v12, v99, v19, v12
    v_add_f32 v13, v13, v14
    s_waitcnt vmcnt(38)
    v_dot2_f32_bf16 v11, v100, v20, v11
    v_dot2_f32_bf16 v12, v101, v21, v12
    v_dot2_f32_bf16 v11, v102, v22, v11
    v_dot2_f32_bf16 v12, v103, v23, v12
    v_add_f32_dpp v9, v13, v13 row_half_mirror row_mask:0xf bank_mask:0xa
    s_waitcnt vmcnt(37)
    v_dot2_f32_bf16 v11, v104, v24, v11
    v_dot2_f32_bf16 v12, v105, v25, v12
    v_dot2_f32_bf16 v11, v106, v26, v11
    v_dot2_f32_bf16 v12, v107, v27, v12
    v_add_f32_dpp v9, v9, v9 quad_perm:[1,0,3,2] row_mask:0xf bank_mask:0xf
    s_waitcnt vmcnt(36)
    v_dot2_f32_bf16 v11, v108, v28, v11
    v_dot2_f32_bf16 v12, v109, v29, v12
    v_dot2_f32_bf16 v11, v110, v30, v11
    v_dot2_f32_bf16 v12, v111, v31, v12
    v_add_f32_dpp v9, v9, v9 quad_perm:[2,3,0,1] row_mask:0xf bank_mask:0xf
    s_waitcnt vmcnt(35)
    v_dot2_f32_bf16 v13, v112, v16, 0
    v_dot2_f32_bf16 v14, v113, v17, 0
    v_dot2_f32_bf16 v13, v114, v18, v13
    v_dot2_f32_bf16 v14, v115, v19, v14
    v_cvt_pk_bf16_f32 v10, 0, v9
    v_add_f32 v11, v11, v12
    s_waitcnt vmcnt(34)
    v_dot2_f32_bf16 v13, v116, v20, v13
    v_dot2_f32_bf16 v14, v117, v21, v14
    v_dot2_f32_bf16 v13, v118, v22, v13
    v_dot2_f32_bf16 v14, v119, v23, v14
    v_max_f32 v8, v8, v10
    ds_write_b32 v6, v10 offset:1280
    v_add_f32_dpp v9, v11, v11 row_half_mirror row_mask:0xf bank_mask:0x5
    s_waitcnt vmcnt(33)
    v_dot2_f32_bf16 v13, v120, v24, v13
    v_dot2_f32_bf16 v14, v121, v25, v14
    v_dot2_f32_bf16 v13, v122, v26, v13
    v_dot2_f32_bf16 v14, v123, v27, v14
    s_waitcnt vmcnt(32)
    v_dot2_f32_bf16 v13, v124, v28, v13
    v_dot2_f32_bf16 v14, v125, v29, v14
    v_dot2_f32_bf16 v13, v126, v30, v13
    v_dot2_f32_bf16 v14, v127, v31, v14
    s_waitcnt vmcnt(31)
    v_dot2_f32_bf16 v11, v128, v16, 0
    v_dot2_f32_bf16 v12, v129, v17, 0
    v_dot2_f32_bf16 v11, v130, v18, v11
    v_dot2_f32_bf16 v12, v131, v19, v12
    v_add_f32 v13, v13, v14
    s_waitcnt vmcnt(30)
    v_dot2_f32_bf16 v11, v132, v20, v11
    v_dot2_f32_bf16 v12, v133, v21, v12
    v_dot2_f32_bf16 v11, v134, v22, v11
    v_dot2_f32_bf16 v12, v135, v23, v12
    v_add_f32_dpp v9, v13, v13 row_half_mirror row_mask:0xf bank_mask:0xa
    s_waitcnt vmcnt(29)
    v_dot2_f32_bf16 v11, v136, v24, v11
    v_dot2_f32_bf16 v12, v137, v25, v12
    v_dot2_f32_bf16 v11, v138, v26, v11
    v_dot2_f32_bf16 v12, v139, v27, v12
    v_add_f32_dpp v9, v9, v9 quad_perm:[1,0,3,2] row_mask:0xf bank_mask:0xf
    s_waitcnt vmcnt(28)
    v_dot2_f32_bf16 v11, v140, v28, v11
    v_dot2_f32_bf16 v12, v141, v29, v12
    v_dot2_f32_bf16 v11, v142, v30, v11
    v_dot2_f32_bf16 v12, v143, v31, v12
    v_add_f32_dpp v9, v9, v9 quad_perm:[2,3,0,1] row_mask:0xf bank_mask:0xf
    s_waitcnt vmcnt(27)
    v_dot2_f32_bf16 v13, v144, v16, 0
    v_dot2_f32_bf16 v14, v145, v17, 0
    v_dot2_f32_bf16 v13, v146, v18, v13
    v_dot2_f32_bf16 v14, v147, v19, v14
    v_cvt_pk_bf16_f32 v10, 0, v9
    v_add_f32 v11, v11, v12
    s_waitcnt vmcnt(26)
    v_dot2_f32_bf16 v13, v148, v20, v13
    v_dot2_f32_bf16 v14, v149, v21, v14
    v_dot2_f32_bf16 v13, v150, v22, v13
    v_dot2_f32_bf16 v14, v151, v23, v14
    v_max_f32 v8, v8, v10
    ds_write_b32 v6, v10 offset:1312
    v_add_f32_dpp v9, v11, v11 row_half_mirror row_mask:0xf bank_mask:0x5
    s_waitcnt vmcnt(25)
    v_dot2_f32_bf16 v13, v152, v24, v13
    v_dot2_f32_bf16 v14, v153, v25, v14
    v_dot2_f32_bf16 v13, v154, v26, v13
    v_dot2_f32_bf16 v14, v155, v27, v14
    s_waitcnt vmcnt(24)
    v_dot2_f32_bf16 v13, v156, v28, v13
    v_dot2_f32_bf16 v14, v157, v29, v14
    v_dot2_f32_bf16 v13, v158, v30, v13
    v_dot2_f32_bf16 v14, v159, v31, v14
    s_waitcnt vmcnt(23)
    v_dot2_f32_bf16 v11, v160, v16, 0
    v_dot2_f32_bf16 v12, v161, v17, 0
    v_dot2_f32_bf16 v11, v162, v18, v11
    v_dot2_f32_bf16 v12, v163, v19, v12
    v_add_f32 v13, v13, v14
    s_waitcnt vmcnt(22)
    v_dot2_f32_bf16 v11, v164, v20, v11
    v_dot2_f32_bf16 v12, v165, v21, v12
    v_dot2_f32_bf16 v11, v166, v22, v11
    v_dot2_f32_bf16 v12, v167, v23, v12
    v_add_f32_dpp v9, v13, v13 row_half_mirror row_mask:0xf bank_mask:0xa
    s_waitcnt vmcnt(21)
    v_dot2_f32_bf16 v11, v168, v24, v11
    v_dot2_f32_bf16 v12, v169, v25, v12
    v_dot2_f32_bf16 v11, v170, v26, v11
    v_dot2_f32_bf16 v12, v171, v27, v12
    v_add_f32_dpp v9, v9, v9 quad_perm:[1,0,3,2] row_mask:0xf bank_mask:0xf
    s_waitcnt vmcnt(20)
    v_dot2_f32_bf16 v11, v172, v28, v11
    v_dot2_f32_bf16 v12, v173, v29, v12
    v_dot2_f32_bf16 v11, v174, v30, v11
    v_dot2_f32_bf16 v12, v175, v31, v12
    v_add_f32_dpp v9, v9, v9 quad_perm:[2,3,0,1] row_mask:0xf bank_mask:0xf
    s_waitcnt vmcnt(19)
    v_dot2_f32_bf16 v13, v176, v16, 0
    v_dot2_f32_bf16 v14, v177, v17, 0
    v_dot2_f32_bf16 v13, v178, v18, v13
    v_dot2_f32_bf16 v14, v179, v19, v14
    v_cvt_pk_bf16_f32 v10, 0, v9
    v_add_f32 v11, v11, v12
    s_waitcnt vmcnt(18)
    v_dot2_f32_bf16 v13, v180, v20, v13
    v_dot2_f32_bf16 v14, v181, v21, v14
    v_dot2_f32_bf16 v13, v182, v22, v13
    v_dot2_f32_bf16 v14, v183, v23, v14
    v_max_f32 v8, v8, v10
    ds_write_b32 v6, v10 offset:1344
    v_add_f32_dpp v9, v11, v11 row_half_mirror row_mask:0xf bank_mask:0x5
    s_waitcnt vmcnt(17)
    v_dot2_f32_bf16 v13, v184, v24, v13
    v_dot2_f32_bf16 v14, v185, v25, v14
    v_dot2_f32_bf16 v13, v186, v26, v13
    v_dot2_f32_bf16 v14, v187, v27, v14
    s_waitcnt vmcnt(16)
    v_dot2_f32_bf16 v13, v188, v28, v13
    v_dot2_f32_bf16 v14, v189, v29, v14
    v_dot2_f32_bf16 v13, v190, v30, v13
    v_dot2_f32_bf16 v14, v191, v31, v14
    s_waitcnt vmcnt(15)
    v_dot2_f32_bf16 v11, v192, v16, 0
    v_dot2_f32_bf16 v12, v193, v17, 0
    v_dot2_f32_bf16 v11, v194, v18, v11
    v_dot2_f32_bf16 v12, v195, v19, v12
    v_add_f32 v13, v13, v14
    s_waitcnt vmcnt(14)
    v_dot2_f32_bf16 v11, v196, v20, v11
    v_dot2_f32_bf16 v12, v197, v21, v12
    v_dot2_f32_bf16 v11, v198, v22, v11
    v_dot2_f32_bf16 v12, v199, v23, v12
    v_add_f32_dpp v9, v13, v13 row_half_mirror row_mask:0xf bank_mask:0xa
    s_waitcnt vmcnt(13)
    v_dot2_f32_bf16 v11, v200, v24, v11
    v_dot2_f32_bf16 v12, v201, v25, v12
    v_dot2_f32_bf16 v11, v202, v26, v11
    v_dot2_f32_bf16 v12, v203, v27, v12
    v_add_f32_dpp v9, v9, v9 quad_perm:[1,0,3,2] row_mask:0xf bank_mask:0xf
    s_waitcnt vmcnt(12)
    v_dot2_f32_bf16 v11, v204, v28, v11
    v_dot2_f32_bf16 v12, v205, v29, v12
    v_dot2_f32_bf16 v11, v206, v30, v11
    v_dot2_f32_bf16 v12, v207, v31, v12
    v_add_f32_dpp v9, v9, v9 quad_perm:[2,3,0,1] row_mask:0xf bank_mask:0xf
    s_waitcnt vmcnt(11)
    v_dot2_f32_bf16 v13, v208, v16, 0
    v_dot2_f32_bf16 v14, v209, v17, 0
    v_dot2_f32_bf16 v13, v210, v18, v13
    v_dot2_f32_bf16 v14, v211, v19, v14
    v_cvt_pk_bf16_f32 v10, 0, v9
    v_add_f32 v11, v11, v12
    s_waitcnt vmcnt(10)
    v_dot2_f32_bf16 v13, v212, v20, v13
    v_dot2_f32_bf16 v14, v213, v21, v14
    v_dot2_f32_bf16 v13, v214, v22, v13
    v_dot2_f32_bf16 v14, v215, v23, v14
    v_max_f32 v8, v8, v10
    ds_write_b32 v6, v10 offset:1376
    v_add_f32_dpp v9, v11, v11 row_half_mirror row_mask:0xf bank_mask:0x5
    s_waitcnt vmcnt(9)
    v_dot2_f32_bf16 v13, v216, v24, v13
    v_dot2_f32_bf16 v14, v217, v25, v14
    v_dot2_f32_bf16 v13, v218, v26, v13
    v_dot2_f32_bf16 v14, v219, v27, v14
    s_waitcnt vmcnt(8)
    v_dot2_f32_bf16 v13, v220, v28, v13
    v_dot2_f32_bf16 v14, v221, v29, v14
    v_dot2_f32_bf16 v13, v222, v30, v13
    v_dot2_f32_bf16 v14, v223, v31, v14
    s_waitcnt vmcnt(7)
    v_dot2_f32_bf16 v11, v224, v16, 0
    v_dot2_f32_bf16 v12, v225, v17, 0
    v_dot2_f32_bf16 v11, v226, v18, v11
    v_dot2_f32_bf16 v12, v227, v19, v12
    v_add_f32 v13, v13, v14
    s_waitcnt vmcnt(6)
    v_dot2_f32_bf16 v11, v228, v20, v11
    v_dot2_f32_bf16 v12, v229, v21, v12
    v_dot2_f32_bf16 v11, v230, v22, v11
    v_dot2_f32_bf16 v12, v231, v23, v12
    v_add_f32_dpp v9, v13, v13 row_half_mirror row_mask:0xf bank_mask:0xa
    s_waitcnt vmcnt(5)
    v_dot2_f32_bf16 v11, v232, v24, v11
    v_dot2_f32_bf16 v12, v233, v25, v12
    v_dot2_f32_bf16 v11, v234, v26, v11
    v_dot2_f32_bf16 v12, v235, v27, v12
    v_add_f32_dpp v9, v9, v9 quad_perm:[1,0,3,2] row_mask:0xf bank_mask:0xf
    s_waitcnt vmcnt(4)
    v_dot2_f32_bf16 v11, v236, v28, v11
    v_dot2_f32_bf16 v12, v237, v29, v12
    v_dot2_f32_bf16 v11, v238, v30, v11
    v_dot2_f32_bf16 v12, v239, v31, v12
    v_add_f32_dpp v9, v9, v9 quad_perm:[2,3,0,1] row_mask:0xf bank_mask:0xf
    s_waitcnt vmcnt(3)
    v_dot2_f32_bf16 v13, v240, v16, 0
    v_dot2_f32_bf16 v14, v241, v17, 0
    v_dot2_f32_bf16 v13, v242, v18, v13
    v_dot2_f32_bf16 v14, v243, v19, v14
    v_cvt_pk_bf16_f32 v10, 0, v9
    v_add_f32 v11, v11, v12
    s_waitcnt vmcnt(2)
    v_dot2_f32_bf16 v13, v244, v20, v13
    v_dot2_f32_bf16 v14, v245, v21, v14
    v_dot2_f32_bf16 v13, v246, v22, v13
    v_dot2_f32_bf16 v14, v247, v23, v14
    v_max_f32 v8, v8, v10
    ds_write_b32 v6, v10 offset:1408
    v_add_f32_dpp v9, v11, v11 row_half_mirror row_mask:0xf bank_mask:0x5
    s_waitcnt vmcnt(1)
    v_dot2_f32_bf16 v13, v248, v24, v13
    v_dot2_f32_bf16 v14, v249, v25, v14
    v_dot2_f32_bf16 v13, v250, v26, v13
    v_dot2_f32_bf16 v14, v251, v27, v14
    s_waitcnt vmcnt(0)
    v_dot2_f32_bf16 v13, v252, v28, v13
    v_dot2_f32_bf16 v14, v253, v29, v14
    v_dot2_f32_bf16 v13, v254, v30, v13
    v_dot2_f32_bf16 v14, v255, v31, v14
    s_nop 2
    v_add_f32 v13, v13, v14
    s_nop 1
    v_add_f32_dpp v9, v13, v13 row_half_mirror row_mask:0xf bank_mask:0xa
    s_nop 1
    v_add_f32_dpp v9, v9, v9 quad_perm:[1,0,3,2] row_mask:0xf bank_mask:0xf
    s_nop 1
    v_add_f32_dpp v9, v9, v9 quad_perm:[2,3,0,1] row_mask:0xf bank_mask:0xf
    v_cvt_pk_bf16_f32 v10, 0, v9
    v_max_f32 v8, v8, v10
    ds_write_b32 v6, v10 offset:1440
    s_sub_u32 s47, s3, 4
    s_lshl_b32 s47, s47, 4
    s_nop 1
    v_max_f32_dpp v8, v8, v8 row_ror:4 row_mask:0xf bank_mask:0xf
    s_nop 1
    v_max_f32_dpp v8, v8, v8 row_ror:8 row_mask:0xf bank_mask:0xf
    v_lshrrev_b32 v9, 4, v0
    v_lshlrev_b32 v9, 2, v9
    v_add_u32 v9, s47, v9
    ds_write_b32 v9, v8 offset:512
    s_cmp_eq_u32 s3, 7
    s_cbranch_scc1 L_mon
L_wo:
    s_mul_i32 s47, s31, 229376
    s_sub_u32 s48, s3, 1
    s_lshl_b32 s48, s48, 7
    s_add_u32 s47, s47, s48
    s_sub_u32 s48, 3670016, s47
    s_add_u32 s52, s12, s47
    s_addc_u32 s53, s13, 0
    s_mov_b32 s54, s48
    s_mov_b32 s55, 0x20000
    v_mul_u32_u24 v28, 896, v2
    v_lshl_add_u32 v28, v3, 4, v28
    s_mov_b32 s47, 0
    buffer_load_dwordx4 v[128:131], v28, s[52:55], s47 offen
    s_add_u32 s47, s47, 7168
    s_waitcnt vmcnt(0)
    buffer_load_dwordx4 v[132:135], v28, s[52:55], s47 offen
    s_add_u32 s47, s47, 7168
    s_waitcnt vmcnt(0)
    buffer_load_dwordx4 v[136:139], v28, s[52:55], s47 offen
    s_add_u32 s47, s47, 7168
    s_waitcnt vmcnt(0)
    buffer_load_dwordx4 v[140:143], v28, s[52:55], s47 offen
    s_mov_b32 s47, 28672
    s_waitcnt vmcnt(0)
    buffer_load_dwordx4 v[144:147], v28, s[52:55], s47 offen
    s_add_u32 s47, s47, 7168
    s_waitcnt vmcnt(0)
    buffer_load_dwordx4 v[148:151], v28, s[52:55], s47 offen
    s_add_u32 s47, s47, 7168
    s_waitcnt vmcnt(0)
    buffer_load_dwordx4 v[152:155], v28, s[52:55], s47 offen
    s_add_u32 s47, s47, 7168
    s_waitcnt vmcnt(0)
    buffer_load_dwordx4 v[156:159], v28, s[52:55], s47 offen
    s_mov_b32 s47, 57344
    s_waitcnt vmcnt(0)
    buffer_load_dwordx4 v[160:163], v28, s[52:55], s47 offen
    s_add_u32 s47, s47, 7168
    s_waitcnt vmcnt(0)
    buffer_load_dwordx4 v[164:167], v28, s[52:55], s47 offen
    s_add_u32 s47, s47, 7168
    s_waitcnt vmcnt(0)
    buffer_load_dwordx4 v[168:171], v28, s[52:55], s47 offen
    s_add_u32 s47, s47, 7168
    s_waitcnt vmcnt(0)
    buffer_load_dwordx4 v[172:175], v28, s[52:55], s47 offen
    s_mov_b32 s47, 86016
    s_waitcnt vmcnt(0)
    buffer_load_dwordx4 v[176:179], v28, s[52:55], s47 offen
    s_add_u32 s47, s47, 7168
    s_waitcnt vmcnt(0)
    buffer_load_dwordx4 v[180:183], v28, s[52:55], s47 offen
    s_add_u32 s47, s47, 7168
    s_waitcnt vmcnt(0)
    buffer_load_dwordx4 v[184:187], v28, s[52:55], s47 offen
    s_add_u32 s47, s47, 7168
    s_waitcnt vmcnt(0)
    buffer_load_dwordx4 v[188:191], v28, s[52:55], s47 offen
    s_sub_u32 s47, s3, 1
    s_mul_i32 s47, s47, 8448
    s_add_u32 s47, s47, 27776
    v_lshl_add_u32 v28, v0, 4, s47
    v_bfe_u32 v29, v0, 2, 2
    v_lshrrev_b32 v31, 1, v29
    v_and_b32 v29, 1, v29
    v_lshlrev_b32 v29, 1, v29
    v_lshlrev_b32 v31, 7, v31
    v_lshrrev_b32 v30, 5, v0
    v_add_u32 v29, v29, v30
    v_mul_u32_u24 v29, 1056, v29
    v_bfe_u32 v30, v0, 4, 1
    v_lshl_add_u32 v31, v30, 9, v31
    v_add3_u32 v29, v29, v31, s47
    v_and_b32 v31, 3, v0
    v_lshl_add_u32 v29, v31, 3, v29
    s_waitcnt vmcnt(0)
    ds_write_b128 v28, v[128:131] offset:0
    ds_write_b128 v28, v[132:135] offset:1056
    ds_write_b128 v28, v[136:139] offset:2112
    ds_write_b128 v28, v[140:143] offset:3168
    ds_write_b128 v28, v[144:147] offset:4224
    ds_write_b128 v28, v[148:151] offset:5280
    ds_write_b128 v28, v[152:155] offset:6336
    ds_write_b128 v28, v[156:159] offset:7392
    s_waitcnt lgkmcnt(0)
    ds_read_b64_tr_b16 v[128:129], v29 offset:0
    ds_read_b64_tr_b16 v[130:131], v29 offset:256
    ds_read_b64_tr_b16 v[132:133], v29 offset:32
    ds_read_b64_tr_b16 v[134:135], v29 offset:288
    ds_read_b64_tr_b16 v[136:137], v29 offset:64
    ds_read_b64_tr_b16 v[138:139], v29 offset:320
    ds_read_b64_tr_b16 v[140:141], v29 offset:96
    ds_read_b64_tr_b16 v[142:143], v29 offset:352
    ds_read_b64_tr_b16 v[144:145], v29 offset:4224
    ds_read_b64_tr_b16 v[146:147], v29 offset:4480
    ds_read_b64_tr_b16 v[148:149], v29 offset:4256
    ds_read_b64_tr_b16 v[150:151], v29 offset:4512
    ds_read_b64_tr_b16 v[152:153], v29 offset:4288
    ds_read_b64_tr_b16 v[154:155], v29 offset:4544
    ds_read_b64_tr_b16 v[156:157], v29 offset:4320
    ds_read_b64_tr_b16 v[158:159], v29 offset:4576
    s_waitcnt lgkmcnt(0)
    ds_write_b128 v28, v[160:163] offset:0
    ds_write_b128 v28, v[164:167] offset:1056
    ds_write_b128 v28, v[168:171] offset:2112
    ds_write_b128 v28, v[172:175] offset:3168
    ds_write_b128 v28, v[176:179] offset:4224
    ds_write_b128 v28, v[180:183] offset:5280
    ds_write_b128 v28, v[184:187] offset:6336
    ds_write_b128 v28, v[188:191] offset:7392
    s_waitcnt lgkmcnt(0)
    ds_read_b64_tr_b16 v[160:161], v29 offset:0
    ds_read_b64_tr_b16 v[162:163], v29 offset:256
    ds_read_b64_tr_b16 v[164:165], v29 offset:32
    ds_read_b64_tr_b16 v[166:167], v29 offset:288
    ds_read_b64_tr_b16 v[168:169], v29 offset:64
    ds_read_b64_tr_b16 v[170:171], v29 offset:320
    ds_read_b64_tr_b16 v[172:173], v29 offset:96
    ds_read_b64_tr_b16 v[174:175], v29 offset:352
    ds_read_b64_tr_b16 v[176:177], v29 offset:4224
    ds_read_b64_tr_b16 v[178:179], v29 offset:4480
    ds_read_b64_tr_b16 v[180:181], v29 offset:4256
    ds_read_b64_tr_b16 v[182:183], v29 offset:4512
    ds_read_b64_tr_b16 v[184:185], v29 offset:4288
    ds_read_b64_tr_b16 v[186:187], v29 offset:4544
    ds_read_b64_tr_b16 v[188:189], v29 offset:4320
    ds_read_b64_tr_b16 v[190:191], v29 offset:4576
    s_waitcnt lgkmcnt(0)
    s_barrier
    s_cmp_eq_u32 s3, 5
    s_cbranch_scc1 L_w5
    s_cmp_lg_u32 s3, 6
    s_cbranch_scc1 L_wo2
    v_mov_b32 v4, 0
    ds_read_b128 v[64:67], v4 offset:512
    ds_read_b128 v[68:71], v4 offset:528
    ds_read_b128 v[72:75], v4 offset:544
    ds_read_b128 v[76:79], v4 offset:560
    v_mul_u32_u24 v5, 1040, v2
    v_lshl_add_u32 v5, v3, 7, v5
    ds_read_b128 v[32:35], v5 offset:1280
    ds_read_b128 v[36:39], v5 offset:1296
    ds_read_b128 v[40:43], v5 offset:1312
    ds_read_b128 v[44:47], v5 offset:1328
    ds_read_b128 v[48:51], v5 offset:1344
    ds_read_b128 v[52:55], v5 offset:1360
    ds_read_b128 v[56:59], v5 offset:1376
    ds_read_b128 v[60:63], v5 offset:1392
    s_waitcnt lgkmcnt(8)
    v_max3_f32 v6, v64, v65, v66
    v_max3_f32 v6, v6, v67, v68
    v_max3_f32 v6, v6, v69, v70
    v_max3_f32 v6, v6, v71, v72
    v_max3_f32 v6, v6, v73, v74
    v_max3_f32 v6, v6, v75, v76
    v_max3_f32 v6, v6, v77, v78
    v_max_f32 v6, v6, v79
    v_mul_f32 v7, s34, v6
    v_sub_f32 v7, 0, v7
    s_waitcnt lgkmcnt(0)
    v_fma_f32 v32, v32, s34, v7
    v_fma_f32 v33, v33, s34, v7
    v_fma_f32 v34, v34, s34, v7
    v_fma_f32 v35, v35, s34, v7
    v_fma_f32 v36, v36, s34, v7
    v_fma_f32 v37, v37, s34, v7
    v_fma_f32 v38, v38, s34, v7
    v_fma_f32 v39, v39, s34, v7
    v_fma_f32 v40, v40, s34, v7
    v_fma_f32 v41, v41, s34, v7
    v_fma_f32 v42, v42, s34, v7
    v_fma_f32 v43, v43, s34, v7
    v_fma_f32 v44, v44, s34, v7
    v_fma_f32 v45, v45, s34, v7
    v_fma_f32 v46, v46, s34, v7
    v_fma_f32 v47, v47, s34, v7
    v_fma_f32 v48, v48, s34, v7
    v_fma_f32 v49, v49, s34, v7
    v_fma_f32 v50, v50, s34, v7
    v_fma_f32 v51, v51, s34, v7
    v_fma_f32 v52, v52, s34, v7
    v_fma_f32 v53, v53, s34, v7
    v_fma_f32 v54, v54, s34, v7
    v_fma_f32 v55, v55, s34, v7
    v_fma_f32 v56, v56, s34, v7
    v_fma_f32 v57, v57, s34, v7
    v_fma_f32 v58, v58, s34, v7
    v_fma_f32 v59, v59, s34, v7
    v_fma_f32 v60, v60, s34, v7
    v_fma_f32 v61, v61, s34, v7
    v_fma_f32 v62, v62, s34, v7
    v_fma_f32 v63, v63, s34, v7
    v_exp_f32 v32, v32
    v_exp_f32 v33, v33
    v_exp_f32 v34, v34
    v_exp_f32 v35, v35
    v_exp_f32 v36, v36
    v_exp_f32 v37, v37
    v_exp_f32 v38, v38
    v_exp_f32 v39, v39
    v_exp_f32 v40, v40
    v_exp_f32 v41, v41
    v_exp_f32 v42, v42
    v_exp_f32 v43, v43
    v_exp_f32 v44, v44
    v_exp_f32 v45, v45
    v_exp_f32 v46, v46
    v_exp_f32 v47, v47
    v_exp_f32 v48, v48
    v_exp_f32 v49, v49
    v_exp_f32 v50, v50
    v_exp_f32 v51, v51
    v_exp_f32 v52, v52
    v_exp_f32 v53, v53
    v_exp_f32 v54, v54
    v_exp_f32 v55, v55
    v_exp_f32 v56, v56
    v_exp_f32 v57, v57
    v_exp_f32 v58, v58
    v_exp_f32 v59, v59
    v_exp_f32 v60, v60
    v_exp_f32 v61, v61
    v_exp_f32 v62, v62
    v_exp_f32 v63, v63
    v_add_f32 v32, v32, v48
    v_add_f32 v33, v33, v49
    v_add_f32 v34, v34, v50
    v_add_f32 v35, v35, v51
    v_add_f32 v36, v36, v52
    v_add_f32 v37, v37, v53
    v_add_f32 v38, v38, v54
    v_add_f32 v39, v39, v55
    v_add_f32 v40, v40, v56
    v_add_f32 v41, v41, v57
    v_add_f32 v42, v42, v58
    v_add_f32 v43, v43, v59
    v_add_f32 v44, v44, v60
    v_add_f32 v45, v45, v61
    v_add_f32 v46, v46, v62
    v_add_f32 v47, v47, v63
    v_add_f32 v32, v32, v40
    v_add_f32 v33, v33, v41
    v_add_f32 v34, v34, v42
    v_add_f32 v35, v35, v43
    v_add_f32 v36, v36, v44
    v_add_f32 v37, v37, v45
    v_add_f32 v38, v38, v46
    v_add_f32 v39, v39, v47
    v_add_f32 v32, v32, v36
    v_add_f32 v33, v33, v37
    v_add_f32 v34, v34, v38
    v_add_f32 v35, v35, v39
    v_add_f32 v32, v32, v34
    v_add_f32 v33, v33, v35
    v_add_f32 v32, v32, v33
    s_nop 1
    v_add_f32_dpp v32, v32, v32 quad_perm:[1,0,3,2] row_mask:0xf bank_mask:0xf
    s_nop 1
    v_add_f32_dpp v32, v32, v32 quad_perm:[2,3,0,1] row_mask:0xf bank_mask:0xf
    s_nop 1
    v_add_f32_dpp v32, v32, v32 row_half_mirror row_mask:0xf bank_mask:0xf
    s_nop 1
    v_add_f32_dpp v32, v32, v32 row_mirror row_mask:0xf bank_mask:0xf
    v_mov_b32 v33, v32
    s_nop 1
    v_permlane16_swap_b32 v32, v33
    v_add_f32 v32, v32, v33
    v_mov_b32 v33, v32
    s_nop 1
    v_permlane32_swap_b32 v32, v33
    v_add_f32 v32, v32, v33
    ds_read_b32 v16, v4 offset:580
    s_waitcnt lgkmcnt(0)
    v_or_b32 v16, 0xa000, v16
    s_mov_b32 s47, 0xffff0000
    v_and_or_b32 v8, v6, s47, v16
    v_lshl_or_b32 v9, v6, 16, v16
    v_and_or_b32 v10, v32, s47, v16
    v_lshl_or_b32 v11, v32, 16, v16
    s_mov_b64 exec, 1
    buffer_store_dwordx4 v[8:11], off, s[36:39], 0 offset:3840 sc1
    s_mov_b64 exec, -1
    s_branch L_wo2
L_w6b:
    s_mov_b32 s47, 0xffff0000
    s_xor_b32 s48, s32, 1
    s_lshl_b32 s48, s48, 12
    s_mov_b32 s49, 400000
L_mlp:
    buffer_load_dwordx4 v[12:15], off, s[40:43], s48 offset:3840 sc1
    s_waitcnt vmcnt(0)
    v_xor_b32 v17, v12, v16
    v_bitop3_b32 v17, v13, v16, v17 bitop3:0xbe
    v_bitop3_b32 v17, v14, v16, v17 bitop3:0xbe
    v_bitop3_b32 v17, v15, v16, v17 bitop3:0xbe
    v_and_b32 v17, 0xffff, v17
    v_cmp_ne_u32 vcc, 0, v17
    s_sub_u32 s49, s49, 1
    s_cbranch_scc1 L_mlx
    s_cbranch_vccz L_mlx
    s_sleep 8
    s_branch L_mlp
L_mlx:
    v_lshrrev_b32 v13, 16, v13
    v_lshrrev_b32 v15, 16, v15
    v_and_or_b32 v10, v12, s47, v13
    v_and_or_b32 v11, v14, s47, v15
    v_max_f32 v12, v6, v10
    v_sub_f32 v13, v6, v12
    v_sub_f32 v14, v10, v12
    v_mul_f32 v13, s34, v13
    v_mul_f32 v14, s34, v14
    v_exp_f32 v13, v13
    v_exp_f32 v14, v14
    s_nop 0
    v_mul_f32 v15, v13, v32
    v_fma_f32 v15, v14, v11, v15
    v_rcp_f32 v15, v15
    s_nop 0
    v_mul_f32 v15, v15, v13
    ds_write_b32 v4, v15 offset:576
    s_branch L_tail
L_w5:
    s_cmp_ge_u32 s32, 28
    s_cbranch_scc1 L_wo2
    v_mov_b32 v4, 0
    ds_read_b32 v78, v4 offset:580
    s_waitcnt lgkmcnt(0)
    s_mul_i32 s47, s30, 896
    s_add_u32 s88, s4, s47
    s_addc_u32 s89, s5, 0
    s_mov_b32 s90, 896
    s_mov_b32 s91, 0x20000
    v_lshrrev_b32 v64, 2, v0
    v_and_b32 v4, 3, v0
    v_and_b32 v65, 3, v64
    v_lshlrev_b32 v64, 12, v64
    v_lshl_add_u32 v64, v4, 4, v64
    s_lshl_b32 s47, s32, 6
    v_add_u32 v64, s47, v64
    v_lshl_add_u32 v65, v4, 2, v65
    s_lshl_b32 s47, s32, 5
    v_lshl_add_u32 v65, v65, 1, s47
    buffer_load_ushort v66, v65, s[88:91], 0 offen
    s_mov_b32 s49, 400000
    s_mov_b32 s47, 65536
    v_mov_b32 v68, v78
    v_mov_b32 v69, v78
    v_mov_b32 v70, v78
    v_mov_b32 v71, v78
    v_mov_b32 v72, v78
    v_mov_b32 v73, v78
    v_mov_b32 v74, v78
    v_mov_b32 v75, v78
L_bp:
    s_mov_b64 exec, 0xffff
    buffer_load_dwordx4 v[68:71], v64, s[40:43], 0 offen offset:2048 sc1
    s_mov_b64 exec, -1
    s_waitcnt vmcnt(0)
    s_waitcnt vmcnt(1)
    v_xor_b32 v76, v68, v78
    v_bitop3_b32 v76, v69, v78, v76 bitop3:0xbe
    v_bitop3_b32 v76, v70, v78, v76 bitop3:0xbe
    v_bitop3_b32 v76, v71, v78, v76 bitop3:0xbe
    s_waitcnt vmcnt(0)
    v_bitop3_b32 v76, v72, v78, v76 bitop3:0xbe
    v_bitop3_b32 v76, v73, v78, v76 bitop3:0xbe
    v_bitop3_b32 v76, v74, v78, v76 bitop3:0xbe
    v_bitop3_b32 v76, v75, v78, v76 bitop3:0xbe
    v_and_b32 v76, 0xfff, v76
    v_cmp_ne_u32 vcc, 0, v76
    s_sub_u32 s49, s49, 1
    s_cbranch_scc1 L_bx
    s_cbranch_vccz L_bx
    s_sleep 16
    s_branch L_bp
L_bx:
    s_waitcnt vmcnt(0)
    v_xor_b32 v68, v68, v78
    v_xor_b32 v69, v69, v78
    v_xor_b32 v70, v70, v78
    v_xor_b32 v71, v71, v78
    v_xor_b32 v72, v72, v78
    v_xor_b32 v73, v73, v78
    v_xor_b32 v74, v74, v78
    v_xor_b32 v75, v75, v78
    v_add_f32 v68, v68, v72
    v_add_f32 v69, v69, v73
    v_add_f32 v70, v70, v74
    v_add_f32 v71, v71, v75
    v_add_f32_dpp v68, v68, v68 row_ror:4 row_mask:0xf bank_mask:0xf
    v_add_f32_dpp v69, v69, v69 row_ror:4 row_mask:0xf bank_mask:0xf
    v_add_f32_dpp v70, v70, v70 row_ror:4 row_mask:0xf bank_mask:0xf
    v_add_f32_dpp v71, v71, v71 row_ror:4 row_mask:0xf bank_mask:0xf
    v_add_f32_dpp v68, v68, v68 row_ror:8 row_mask:0xf bank_mask:0xf
    v_add_f32_dpp v69, v69, v69 row_ror:8 row_mask:0xf bank_mask:0xf
    v_add_f32_dpp v70, v70, v70 row_ror:8 row_mask:0xf bank_mask:0xf
    v_add_f32_dpp v71, v71, v71 row_ror:8 row_mask:0xf bank_mask:0xf
    v_mov_b32_dpp v68, v69 quad_perm:[0,1,2,3] row_mask:0xf bank_mask:0x2
    v_mov_b32_dpp v68, v70 quad_perm:[0,1,2,3] row_mask:0xf bank_mask:0x4
    v_mov_b32_dpp v68, v71 quad_perm:[0,1,2,3] row_mask:0xf bank_mask:0x8
    v_mov_b32 v69, v68
    s_nop 1
    v_permlane16_swap_b32 v68, v69
    v_add_f32 v68, v68, v69
    v_mov_b32 v69, v68
    s_nop 1
    v_permlane32_swap_b32 v68, v69
    v_add_f32 v68, v68, v69
    v_cvt_pk_bf16_f32 v67, 0, v68
    v_lshlrev_b32 v66, 16, v66
    v_and_b32 v4, 15, v0
    v_lshlrev_b32 v4, 3, v4
    ds_write_b64 v4, v[66:67] offset:640
L_wo2:
    s_mul_i32 s47, s31, 229376
    s_sub_u32 s48, s3, 1
    s_lshl_b32 s48, s48, 7
    s_add_u32 s47, s47, s48
    s_sub_u32 s48, 3670016, s47
    s_add_u32 s52, s12, s47
    s_addc_u32 s53, s13, 0
    s_mov_b32 s54, s48
    s_mov_b32 s55, 0x20000
    v_mul_u32_u24 v28, 896, v2
    v_lshl_add_u32 v28, v3, 4, v28
    s_mov_b32 s47, 114688
    buffer_load_dwordx4 v[192:195], v28, s[52:55], s47 offen
    s_add_u32 s47, s47, 7168
    s_waitcnt vmcnt(0)
    buffer_load_dwordx4 v[196:199], v28, s[52:55], s47 offen
    s_add_u32 s47, s47, 7168
    s_waitcnt vmcnt(0)
    buffer_load_dwordx4 v[200:203], v28, s[52:55], s47 offen
    s_add_u32 s47, s47, 7168
    s_waitcnt vmcnt(0)
    buffer_load_dwordx4 v[204:207], v28, s[52:55], s47 offen
    s_mov_b32 s47, 143360
    s_waitcnt vmcnt(0)
    buffer_load_dwordx4 v[208:211], v28, s[52:55], s47 offen
    s_add_u32 s47, s47, 7168
    s_waitcnt vmcnt(0)
    buffer_load_dwordx4 v[212:215], v28, s[52:55], s47 offen
    s_add_u32 s47, s47, 7168
    s_waitcnt vmcnt(0)
    buffer_load_dwordx4 v[216:219], v28, s[52:55], s47 offen
    s_add_u32 s47, s47, 7168
    s_waitcnt vmcnt(0)
    buffer_load_dwordx4 v[220:223], v28, s[52:55], s47 offen
    s_mov_b32 s47, 172032
    s_waitcnt vmcnt(0)
    buffer_load_dwordx4 v[224:227], v28, s[52:55], s47 offen
    s_add_u32 s47, s47, 7168
    s_waitcnt vmcnt(0)
    buffer_load_dwordx4 v[228:231], v28, s[52:55], s47 offen
    s_add_u32 s47, s47, 7168
    s_waitcnt vmcnt(0)
    buffer_load_dwordx4 v[232:235], v28, s[52:55], s47 offen
    s_add_u32 s47, s47, 7168
    s_waitcnt vmcnt(0)
    buffer_load_dwordx4 v[236:239], v28, s[52:55], s47 offen
    s_mov_b32 s47, 200704
    s_waitcnt vmcnt(0)
    buffer_load_dwordx4 v[240:243], v28, s[52:55], s47 offen
    s_add_u32 s47, s47, 7168
    s_waitcnt vmcnt(0)
    buffer_load_dwordx4 v[244:247], v28, s[52:55], s47 offen
    s_add_u32 s47, s47, 7168
    s_waitcnt vmcnt(0)
    buffer_load_dwordx4 v[248:251], v28, s[52:55], s47 offen
    s_add_u32 s47, s47, 7168
    s_waitcnt vmcnt(0)
    buffer_load_dwordx4 v[252:255], v28, s[52:55], s47 offen
    s_sub_u32 s47, s3, 1
    s_mul_i32 s47, s47, 8448
    s_add_u32 s47, s47, 27776
    v_lshl_add_u32 v28, v0, 4, s47
    v_bfe_u32 v29, v0, 2, 2
    v_lshrrev_b32 v31, 1, v29
    v_and_b32 v29, 1, v29
    v_lshlrev_b32 v29, 1, v29
    v_lshlrev_b32 v31, 7, v31
    v_lshrrev_b32 v30, 5, v0
    v_add_u32 v29, v29, v30
    v_mul_u32_u24 v29, 1056, v29
    v_bfe_u32 v30, v0, 4, 1
    v_lshl_add_u32 v31, v30, 9, v31
    v_add3_u32 v29, v29, v31, s47
    v_and_b32 v31, 3, v0
    v_lshl_add_u32 v29, v31, 3, v29
    s_waitcnt vmcnt(0)
    ds_write_b128 v28, v[192:195] offset:0
    ds_write_b128 v28, v[196:199] offset:1056
    ds_write_b128 v28, v[200:203] offset:2112
    ds_write_b128 v28, v[204:207] offset:3168
    ds_write_b128 v28, v[208:211] offset:4224
    ds_write_b128 v28, v[212:215] offset:5280
    ds_write_b128 v28, v[216:219] offset:6336
    ds_write_b128 v28, v[220:223] offset:7392
    s_waitcnt lgkmcnt(0)
    ds_read_b64_tr_b16 v[192:193], v29 offset:0
    ds_read_b64_tr_b16 v[194:195], v29 offset:256
    ds_read_b64_tr_b16 v[196:197], v29 offset:32
    ds_read_b64_tr_b16 v[198:199], v29 offset:288
    ds_read_b64_tr_b16 v[200:201], v29 offset:64
    ds_read_b64_tr_b16 v[202:203], v29 offset:320
    ds_read_b64_tr_b16 v[204:205], v29 offset:96
    ds_read_b64_tr_b16 v[206:207], v29 offset:352
    ds_read_b64_tr_b16 v[208:209], v29 offset:4224
    ds_read_b64_tr_b16 v[210:211], v29 offset:4480
    ds_read_b64_tr_b16 v[212:213], v29 offset:4256
    ds_read_b64_tr_b16 v[214:215], v29 offset:4512
    ds_read_b64_tr_b16 v[216:217], v29 offset:4288
    ds_read_b64_tr_b16 v[218:219], v29 offset:4544
    ds_read_b64_tr_b16 v[220:221], v29 offset:4320
    ds_read_b64_tr_b16 v[222:223], v29 offset:4576
    s_waitcnt lgkmcnt(0)
    ds_write_b128 v28, v[224:227] offset:0
    ds_write_b128 v28, v[228:231] offset:1056
    ds_write_b128 v28, v[232:235] offset:2112
    ds_write_b128 v28, v[236:239] offset:3168
    ds_write_b128 v28, v[240:243] offset:4224
    ds_write_b128 v28, v[244:247] offset:5280
    ds_write_b128 v28, v[248:251] offset:6336
    ds_write_b128 v28, v[252:255] offset:7392
    s_waitcnt lgkmcnt(0)
    ds_read_b64_tr_b16 v[224:225], v29 offset:0
    ds_read_b64_tr_b16 v[226:227], v29 offset:256
    ds_read_b64_tr_b16 v[228:229], v29 offset:32
    ds_read_b64_tr_b16 v[230:231], v29 offset:288
    ds_read_b64_tr_b16 v[232:233], v29 offset:64
    ds_read_b64_tr_b16 v[234:235], v29 offset:320
    ds_read_b64_tr_b16 v[236:237], v29 offset:96
    ds_read_b64_tr_b16 v[238:239], v29 offset:352
    ds_read_b64_tr_b16 v[240:241], v29 offset:4224
    ds_read_b64_tr_b16 v[242:243], v29 offset:4480
    ds_read_b64_tr_b16 v[244:245], v29 offset:4256
    ds_read_b64_tr_b16 v[246:247], v29 offset:4512
    ds_read_b64_tr_b16 v[248:249], v29 offset:4288
    ds_read_b64_tr_b16 v[250:251], v29 offset:4544
    ds_read_b64_tr_b16 v[252:253], v29 offset:4320
    ds_read_b64_tr_b16 v[254:255], v29 offset:4576
    s_waitcnt lgkmcnt(0)
    s_cmp_eq_u32 s3, 6
    s_cbranch_scc1 L_w6b
    s_branch L_tail
L_mon:
    s_mul_i32 s47, s31, 229376
    s_sub_u32 s48, s3, 1
    s_lshl_b32 s48, s48, 7
    s_add_u32 s47, s47, s48
    s_sub_u32 s48, 3670016, s47
    s_add_u32 s52, s12, s47
    s_addc_u32 s53, s13, 0
    s_mov_b32 s54, s48
    s_mov_b32 s55, 0x20000
    v_mul_u32_u24 v28, 896, v2
    v_lshl_add_u32 v28, v3, 4, v28
    s_mov_b32 s47, 0
    buffer_load_dwordx4 v[128:131], v28, s[52:55], s47 offen
    s_add_u32 s47, s47, 7168
    buffer_load_dwordx4 v[132:135], v28, s[52:55], s47 offen
    s_add_u32 s47, s47, 7168
    buffer_load_dwordx4 v[136:139], v28, s[52:55], s47 offen
    s_add_u32 s47, s47, 7168
    buffer_load_dwordx4 v[140:143], v28, s[52:55], s47 offen
    s_mov_b32 s47, 28672
    s_waitcnt vmcnt(3)
    buffer_load_dwordx4 v[144:147], v28, s[52:55], s47 offen
    s_add_u32 s47, s47, 7168
    s_waitcnt vmcnt(3)
    buffer_load_dwordx4 v[148:151], v28, s[52:55], s47 offen
    s_add_u32 s47, s47, 7168
    s_waitcnt vmcnt(3)
    buffer_load_dwordx4 v[152:155], v28, s[52:55], s47 offen
    s_add_u32 s47, s47, 7168
    s_waitcnt vmcnt(3)
    buffer_load_dwordx4 v[156:159], v28, s[52:55], s47 offen
    s_mov_b32 s47, 57344
    s_waitcnt vmcnt(3)
    buffer_load_dwordx4 v[160:163], v28, s[52:55], s47 offen
    s_add_u32 s47, s47, 7168
    s_waitcnt vmcnt(3)
    buffer_load_dwordx4 v[164:167], v28, s[52:55], s47 offen
    s_add_u32 s47, s47, 7168
    s_waitcnt vmcnt(3)
    buffer_load_dwordx4 v[168:171], v28, s[52:55], s47 offen
    s_add_u32 s47, s47, 7168
    s_waitcnt vmcnt(3)
    buffer_load_dwordx4 v[172:175], v28, s[52:55], s47 offen
    s_mov_b32 s47, 86016
    s_waitcnt vmcnt(3)
    buffer_load_dwordx4 v[176:179], v28, s[52:55], s47 offen
    s_add_u32 s47, s47, 7168
    s_waitcnt vmcnt(3)
    buffer_load_dwordx4 v[180:183], v28, s[52:55], s47 offen
    s_add_u32 s47, s47, 7168
    s_waitcnt vmcnt(3)
    buffer_load_dwordx4 v[184:187], v28, s[52:55], s47 offen
    s_add_u32 s47, s47, 7168
    s_waitcnt vmcnt(3)
    buffer_load_dwordx4 v[188:191], v28, s[52:55], s47 offen
    s_mov_b32 s47, 114688
    s_waitcnt vmcnt(3)
    buffer_load_dwordx4 v[192:195], v28, s[52:55], s47 offen
    s_add_u32 s47, s47, 7168
    s_waitcnt vmcnt(3)
    buffer_load_dwordx4 v[196:199], v28, s[52:55], s47 offen
    s_add_u32 s47, s47, 7168
    s_waitcnt vmcnt(3)
    buffer_load_dwordx4 v[200:203], v28, s[52:55], s47 offen
    s_add_u32 s47, s47, 7168
    s_waitcnt vmcnt(3)
    buffer_load_dwordx4 v[204:207], v28, s[52:55], s47 offen
    s_mov_b32 s47, 143360
    s_waitcnt vmcnt(3)
    buffer_load_dwordx4 v[208:211], v28, s[52:55], s47 offen
    s_add_u32 s47, s47, 7168
    s_waitcnt vmcnt(3)
    buffer_load_dwordx4 v[212:215], v28, s[52:55], s47 offen
    s_add_u32 s47, s47, 7168
    s_waitcnt vmcnt(3)
    buffer_load_dwordx4 v[216:219], v28, s[52:55], s47 offen
    s_add_u32 s47, s47, 7168
    s_waitcnt vmcnt(3)
    buffer_load_dwordx4 v[220:223], v28, s[52:55], s47 offen
    s_mov_b32 s47, 172032
    s_waitcnt vmcnt(3)
    buffer_load_dwordx4 v[224:227], v28, s[52:55], s47 offen
    s_add_u32 s47, s47, 7168
    s_waitcnt vmcnt(3)
    buffer_load_dwordx4 v[228:231], v28, s[52:55], s47 offen
    s_add_u32 s47, s47, 7168
    s_waitcnt vmcnt(3)
    buffer_load_dwordx4 v[232:235], v28, s[52:55], s47 offen
    s_add_u32 s47, s47, 7168
    s_waitcnt vmcnt(3)
    buffer_load_dwordx4 v[236:239], v28, s[52:55], s47 offen
    s_mov_b32 s47, 200704
    s_waitcnt vmcnt(3)
    buffer_load_dwordx4 v[240:243], v28, s[52:55], s47 offen
    s_add_u32 s47, s47, 7168
    s_waitcnt vmcnt(3)
    buffer_load_dwordx4 v[244:247], v28, s[52:55], s47 offen
    s_add_u32 s47, s47, 7168
    s_waitcnt vmcnt(3)
    buffer_load_dwordx4 v[248:251], v28, s[52:55], s47 offen
    s_add_u32 s47, s47, 7168
    s_waitcnt vmcnt(3)
    buffer_load_dwordx4 v[252:255], v28, s[52:55], s47 offen
    s_sub_u32 s47, s3, 1
    s_mul_i32 s47, s47, 8448
    s_add_u32 s47, s47, 27776
    v_lshl_add_u32 v28, v0, 4, s47
    v_bfe_u32 v29, v0, 2, 2
    v_lshrrev_b32 v31, 1, v29
    v_and_b32 v29, 1, v29
    v_lshlrev_b32 v29, 1, v29
    v_lshlrev_b32 v31, 7, v31
    v_lshrrev_b32 v30, 5, v0
    v_add_u32 v29, v29, v30
    v_mul_u32_u24 v29, 1056, v29
    v_bfe_u32 v30, v0, 4, 1
    v_lshl_add_u32 v31, v30, 9, v31
    v_add3_u32 v29, v29, v31, s47
    v_and_b32 v31, 3, v0
    v_lshl_add_u32 v29, v31, 3, v29
    s_waitcnt vmcnt(0)
    ds_write_b128 v28, v[128:131] offset:0
    ds_write_b128 v28, v[132:135] offset:1056
    ds_write_b128 v28, v[136:139] offset:2112
    ds_write_b128 v28, v[140:143] offset:3168
    ds_write_b128 v28, v[144:147] offset:4224
    ds_write_b128 v28, v[148:151] offset:5280
    ds_write_b128 v28, v[152:155] offset:6336
    ds_write_b128 v28, v[156:159] offset:7392
    s_waitcnt lgkmcnt(0)
    ds_read_b64_tr_b16 v[128:129], v29 offset:0
    ds_read_b64_tr_b16 v[130:131], v29 offset:256
    ds_read_b64_tr_b16 v[132:133], v29 offset:32
    ds_read_b64_tr_b16 v[134:135], v29 offset:288
    ds_read_b64_tr_b16 v[136:137], v29 offset:64
    ds_read_b64_tr_b16 v[138:139], v29 offset:320
    ds_read_b64_tr_b16 v[140:141], v29 offset:96
    ds_read_b64_tr_b16 v[142:143], v29 offset:352
    ds_read_b64_tr_b16 v[144:145], v29 offset:4224
    ds_read_b64_tr_b16 v[146:147], v29 offset:4480
    ds_read_b64_tr_b16 v[148:149], v29 offset:4256
    ds_read_b64_tr_b16 v[150:151], v29 offset:4512
    ds_read_b64_tr_b16 v[152:153], v29 offset:4288
    ds_read_b64_tr_b16 v[154:155], v29 offset:4544
    ds_read_b64_tr_b16 v[156:157], v29 offset:4320
    ds_read_b64_tr_b16 v[158:159], v29 offset:4576
    s_waitcnt lgkmcnt(0)
    ds_write_b128 v28, v[160:163] offset:0
    ds_write_b128 v28, v[164:167] offset:1056
    ds_write_b128 v28, v[168:171] offset:2112
    ds_write_b128 v28, v[172:175] offset:3168
    ds_write_b128 v28, v[176:179] offset:4224
    ds_write_b128 v28, v[180:183] offset:5280
    ds_write_b128 v28, v[184:187] offset:6336
    ds_write_b128 v28, v[188:191] offset:7392
    s_waitcnt lgkmcnt(0)
    ds_read_b64_tr_b16 v[160:161], v29 offset:0
    ds_read_b64_tr_b16 v[162:163], v29 offset:256
    ds_read_b64_tr_b16 v[164:165], v29 offset:32
    ds_read_b64_tr_b16 v[166:167], v29 offset:288
    ds_read_b64_tr_b16 v[168:169], v29 offset:64
    ds_read_b64_tr_b16 v[170:171], v29 offset:320
    ds_read_b64_tr_b16 v[172:173], v29 offset:96
    ds_read_b64_tr_b16 v[174:175], v29 offset:352
    ds_read_b64_tr_b16 v[176:177], v29 offset:4224
    ds_read_b64_tr_b16 v[178:179], v29 offset:4480
    ds_read_b64_tr_b16 v[180:181], v29 offset:4256
    ds_read_b64_tr_b16 v[182:183], v29 offset:4512
    ds_read_b64_tr_b16 v[184:185], v29 offset:4288
    ds_read_b64_tr_b16 v[186:187], v29 offset:4544
    ds_read_b64_tr_b16 v[188:189], v29 offset:4320
    ds_read_b64_tr_b16 v[190:191], v29 offset:4576
    s_waitcnt lgkmcnt(0)
    ds_write_b128 v28, v[192:195] offset:0
    ds_write_b128 v28, v[196:199] offset:1056
    ds_write_b128 v28, v[200:203] offset:2112
    ds_write_b128 v28, v[204:207] offset:3168
    ds_write_b128 v28, v[208:211] offset:4224
    ds_write_b128 v28, v[212:215] offset:5280
    ds_write_b128 v28, v[216:219] offset:6336
    ds_write_b128 v28, v[220:223] offset:7392
    s_waitcnt lgkmcnt(0)
    ds_read_b64_tr_b16 v[192:193], v29 offset:0
    ds_read_b64_tr_b16 v[194:195], v29 offset:256
    ds_read_b64_tr_b16 v[196:197], v29 offset:32
    ds_read_b64_tr_b16 v[198:199], v29 offset:288
    ds_read_b64_tr_b16 v[200:201], v29 offset:64
    ds_read_b64_tr_b16 v[202:203], v29 offset:320
    ds_read_b64_tr_b16 v[204:205], v29 offset:96
    ds_read_b64_tr_b16 v[206:207], v29 offset:352
    ds_read_b64_tr_b16 v[208:209], v29 offset:4224
    ds_read_b64_tr_b16 v[210:211], v29 offset:4480
    ds_read_b64_tr_b16 v[212:213], v29 offset:4256
    ds_read_b64_tr_b16 v[214:215], v29 offset:4512
    ds_read_b64_tr_b16 v[216:217], v29 offset:4288
    ds_read_b64_tr_b16 v[218:219], v29 offset:4544
    ds_read_b64_tr_b16 v[220:221], v29 offset:4320
    ds_read_b64_tr_b16 v[222:223], v29 offset:4576
    s_waitcnt lgkmcnt(0)
    ds_write_b128 v28, v[224:227] offset:0
    ds_write_b128 v28, v[228:231] offset:1056
    ds_write_b128 v28, v[232:235] offset:2112
    ds_write_b128 v28, v[236:239] offset:3168
    ds_write_b128 v28, v[240:243] offset:4224
    ds_write_b128 v28, v[244:247] offset:5280
    ds_write_b128 v28, v[248:251] offset:6336
    ds_write_b128 v28, v[252:255] offset:7392
    s_waitcnt lgkmcnt(0)
    ds_read_b64_tr_b16 v[224:225], v29 offset:0
    ds_read_b64_tr_b16 v[226:227], v29 offset:256
    ds_read_b64_tr_b16 v[228:229], v29 offset:32
    ds_read_b64_tr_b16 v[230:231], v29 offset:288
    ds_read_b64_tr_b16 v[232:233], v29 offset:64
    ds_read_b64_tr_b16 v[234:235], v29 offset:320
    ds_read_b64_tr_b16 v[236:237], v29 offset:96
    ds_read_b64_tr_b16 v[238:239], v29 offset:352
    ds_read_b64_tr_b16 v[240:241], v29 offset:4224
    ds_read_b64_tr_b16 v[242:243], v29 offset:4480
    ds_read_b64_tr_b16 v[244:245], v29 offset:4256
    ds_read_b64_tr_b16 v[246:247], v29 offset:4512
    ds_read_b64_tr_b16 v[248:249], v29 offset:4288
    ds_read_b64_tr_b16 v[250:251], v29 offset:4544
    ds_read_b64_tr_b16 v[252:253], v29 offset:4320
    ds_read_b64_tr_b16 v[254:255], v29 offset:4576
    s_waitcnt lgkmcnt(0)
    s_mov_b32 s40, s24
    s_mov_b32 s41, s25
    s_mov_b32 s42, 1048576
    s_mov_b32 s43, 0x20000
    s_add_u32 s47, s30, 0
    s_and_b32 s47, s47, 7
    s_lshl_b32 s47, s47, 17
    s_add_u32 s12, s47, 3968
    s_add_u32 s47, s30, 2
    s_and_b32 s47, s47, 7
    s_lshl_b32 s47, s47, 17
    s_add_u32 s13, s47, 28544
    s_add_u32 s47, s30, 5
    s_and_b32 s47, s47, 7
    s_lshl_b32 s47, s47, 17
    s_add_u32 s14, s47, 44928
    s_add_u32 s47, s30, 7
    s_and_b32 s47, s47, 7
    s_lshl_b32 s47, s47, 17
    s_add_u32 s15, s47, 53120
    s_mov_b32 s51, 0xffffebbe
    s_lshr_b32 s51, s51, s32
    s_and_b32 s51, s51, 1
    s_mov_b32 s49, 400000
L_cw5:
    buffer_load_dword v5, off, s[56:59], 0 sc1
    s_waitcnt vmcnt(0)
    v_cmp_eq_u32 vcc, 0, v5
    s_sub_u32 s49, s49, 1
    s_cbranch_scc1 L_cwx5
    s_cbranch_vccz L_cwx5
    s_sleep 8
    s_branch L_cw5
L_cwx5:
    v_and_b32 v5, 0xfff, v5
    s_nop 0
    v_readfirstlane_b32 s96, v5
    v_mov_b32 v4, 0
    ds_write_b32 v4, v5 offset:580
    v_lshlrev_b32 v5, 16, v5
    s_lshl_b32 s96, s96, 16
    v_mov_b32 v4, 0
    s_mov_b32 s50, 0
    s_mov_b32 s100, 0
L_monk:
    ds_read_b32 v6, v4 offset:584
    s_waitcnt lgkmcnt(0)
    v_readfirstlane_b32 s47, v6
    s_cmp_ge_u32 s47, 17
    s_cbranch_scc1 L_monkx
    s_cmp_lg_u32 s47, s50
    s_cbranch_scc1 L_monkn
    s_sleep 4
    s_branch L_monk
L_monkn:
    s_mov_b32 s50, s47
    s_cmp_le_u32 s47, 24
    s_cselect_b32 s17, 3, 1
    s_cselect_b32 s18, 64, 32
    s_cselect_b32 s19, 6, 6
    s_and_b32 s48, s47, s17
    s_cbranch_scc1 L_monk
    s_or_b32 s48, s48, s51
    s_cbranch_scc1 L_monkp
    v_or_b32 v6, v5, v6
    s_mov_b64 exec, 1
    buffer_store_dword v6, off, s[36:39], 0 offset:3968 sc1
    s_mov_b64 exec, -1
L_monkp:
    s_buffer_load_dword s4, s[40:43], s12 glc
    s_buffer_load_dword s5, s[40:43], s13 glc
    s_buffer_load_dword s6, s[40:43], s14 glc
    s_buffer_load_dword s7, s[40:43], s15 glc
    s_waitcnt lgkmcnt(0)
    s_sub_u32 s4, s4, s96
    s_sub_u32 s5, s5, s96
    s_sub_u32 s6, s6, s96
    s_sub_u32 s7, s7, s96
    s_mov_b32 s48, s4
    s_mov_b32 s49, s4
    s_add_u32 s48, s48, s5
    s_max_u32 s49, s49, s5
    s_add_u32 s48, s48, s6
    s_max_u32 s49, s49, s6
    s_add_u32 s48, s48, s7
    s_max_u32 s49, s49, s7
    s_cmp_gt_u32 s49, 63
    s_cbranch_scc1 L_monk
    s_lshl_b32 s48, s48, 3
    s_lshl_b32 s49, s47, 5
    s_sub_i32 s49, s49, s18
    s_sub_i32 s49, s49, s48
    s_cmp_gt_i32 s49, s19
    s_cselect_b32 s48, 0, 1
    s_add_i32 s49, s49, s19
    s_cmp_lt_i32 s49, 0
    s_cselect_b32 s48, 2, s48
    v_mov_b32 v7, s48
    ds_write_b32 v4, v7 offset:588
    s_branch L_monk
L_monkx:
    s_waitcnt lgkmcnt(0)
    s_barrier
L_monv:
    ds_read_b32 v6, v4 offset:584
    s_waitcnt lgkmcnt(0)
    v_readfirstlane_b32 s47, v6
    s_cmp_ge_u32 s47, 38
    s_cbranch_scc1 L_monvx
    s_cmp_lg_u32 s47, s50
    s_cbranch_scc1 L_monvn
    s_sleep 4
    s_branch L_monv
L_monvn:
    s_mov_b32 s50, s47
    s_cmp_le_u32 s47, 24
    s_cselect_b32 s17, 3, 1
    s_cselect_b32 s18, 64, 32
    s_cselect_b32 s19, 6, 6
    s_and_b32 s48, s47, s17
    s_cbranch_scc1 L_monv
    s_or_b32 s48, s48, s51
    s_cbranch_scc1 L_monvp
    v_or_b32 v6, v5, v6
    s_mov_b64 exec, 1
    buffer_store_dword v6, off, s[36:39], 0 offset:3968 sc1
    s_mov_b64 exec, -1
L_monvp:
    s_buffer_load_dword s4, s[40:43], s12 glc
    s_buffer_load_dword s5, s[40:43], s13 glc
    s_buffer_load_dword s6, s[40:43], s14 glc
    s_buffer_load_dword s7, s[40:43], s15 glc
    s_waitcnt lgkmcnt(0)
    s_sub_u32 s4, s4, s96
    s_sub_u32 s5, s5, s96
    s_sub_u32 s6, s6, s96
    s_sub_u32 s7, s7, s96
    s_mov_b32 s48, s4
    s_mov_b32 s49, s4
    s_add_u32 s48, s48, s5
    s_max_u32 s49, s49, s5
    s_add_u32 s48, s48, s6
    s_max_u32 s49, s49, s6
    s_add_u32 s48, s48, s7
    s_max_u32 s49, s49, s7
    s_cmp_gt_u32 s49, 63
    s_cbranch_scc1 L_monv
    s_lshl_b32 s48, s48, 3
    s_lshl_b32 s49, s47, 5
    s_sub_i32 s49, s49, s18
    s_sub_i32 s49, s49, s48
    s_cmp_gt_i32 s49, s19
    s_cselect_b32 s48, 0, 1
    s_add_i32 s49, s49, s19
    s_cmp_lt_i32 s49, 0
    s_cselect_b32 s48, 2, s48
    v_mov_b32 v7, s48
    ds_write_b32 v4, v7 offset:588
    s_branch L_monv
L_monvx:
L_tail:
    v_lshrrev_b32 v29, 4, v0
    v_lshlrev_b32 v29, 4, v29
    v_mov_b32 v30, 0
    v_lshlrev_b32 v28, 2, v0
    s_sub_u32 s48, s3, 1
    s_lshl_b32 s48, s48, 8
    s_waitcnt vmcnt(0) lgkmcnt(0)
    s_barrier
    ds_read_b128 v[32:35], v29 offset:768
    ds_read_b128 v[36:39], v29 offset:832
    ds_read_b64 v[10:11], v30 offset:576
    s_waitcnt lgkmcnt(2)
    v_mfma_f32_16x16x32_bf16 v[12:15], v[32:35], v[128:131], 0
    v_mfma_f32_16x16x32_bf16 v[16:19], v[32:35], v[132:135], 0
    v_mfma_f32_16x16x32_bf16 v[20:23], v[32:35], v[136:139], 0
    v_mfma_f32_16x16x32_bf16 v[24:27], v[32:35], v[140:143], 0
    s_waitcnt lgkmcnt(1)
    v_mfma_f32_16x16x32_bf16 v[12:15], v[36:39], v[144:147], v[12:15]
    v_mfma_f32_16x16x32_bf16 v[16:19], v[36:39], v[148:151], v[16:19]
    v_mfma_f32_16x16x32_bf16 v[20:23], v[36:39], v[152:155], v[20:23]
    v_mfma_f32_16x16x32_bf16 v[24:27], v[36:39], v[156:159], v[24:27]
    s_barrier
    ds_read_b128 v[40:43], v29 offset:896
    ds_read_b128 v[44:47], v29 offset:960
    s_waitcnt lgkmcnt(1)
    v_mfma_f32_16x16x32_bf16 v[12:15], v[40:43], v[160:163], v[12:15]
    v_mfma_f32_16x16x32_bf16 v[16:19], v[40:43], v[164:167], v[16:19]
    v_mfma_f32_16x16x32_bf16 v[20:23], v[40:43], v[168:171], v[20:23]
    v_mfma_f32_16x16x32_bf16 v[24:27], v[40:43], v[172:175], v[24:27]
    s_waitcnt lgkmcnt(0)
    v_mfma_f32_16x16x32_bf16 v[12:15], v[44:47], v[176:179], v[12:15]
    v_mfma_f32_16x16x32_bf16 v[16:19], v[44:47], v[180:183], v[16:19]
    v_mfma_f32_16x16x32_bf16 v[20:23], v[44:47], v[184:187], v[20:23]
    v_mfma_f32_16x16x32_bf16 v[24:27], v[44:47], v[188:191], v[24:27]
    s_barrier
    ds_read_b128 v[48:51], v29 offset:1024
    ds_read_b128 v[52:55], v29 offset:1088
    s_waitcnt lgkmcnt(1)
    v_mfma_f32_16x16x32_bf16 v[12:15], v[48:51], v[192:195], v[12:15]
    v_mfma_f32_16x16x32_bf16 v[16:19], v[48:51], v[196:199], v[16:19]
    v_mfma_f32_16x16x32_bf16 v[20:23], v[48:51], v[200:203], v[20:23]
    v_mfma_f32_16x16x32_bf16 v[24:27], v[48:51], v[204:207], v[24:27]
    s_waitcnt lgkmcnt(0)
    v_mfma_f32_16x16x32_bf16 v[12:15], v[52:55], v[208:211], v[12:15]
    v_mfma_f32_16x16x32_bf16 v[16:19], v[52:55], v[212:215], v[16:19]
    v_mfma_f32_16x16x32_bf16 v[20:23], v[52:55], v[216:219], v[20:23]
    v_mfma_f32_16x16x32_bf16 v[24:27], v[52:55], v[220:223], v[24:27]
    s_barrier
    ds_read_b128 v[56:59], v29 offset:1152
    ds_read_b128 v[60:63], v29 offset:1216
    s_waitcnt lgkmcnt(1)
    v_mfma_f32_16x16x32_bf16 v[12:15], v[56:59], v[224:227], v[12:15]
    v_mfma_f32_16x16x32_bf16 v[16:19], v[56:59], v[228:231], v[16:19]
    v_mfma_f32_16x16x32_bf16 v[20:23], v[56:59], v[232:235], v[20:23]
    v_mfma_f32_16x16x32_bf16 v[24:27], v[56:59], v[236:239], v[24:27]
    s_waitcnt lgkmcnt(0)
    v_mfma_f32_16x16x32_bf16 v[12:15], v[60:63], v[240:243], v[12:15]
    v_mfma_f32_16x16x32_bf16 v[16:19], v[60:63], v[244:247], v[16:19]
    v_mfma_f32_16x16x32_bf16 v[20:23], v[60:63], v[248:251], v[20:23]
    v_mfma_f32_16x16x32_bf16 v[24:27], v[60:63], v[252:255], v[24:27]
    s_nop 5
    v_mov_b32_dpp v12, v16 quad_perm:[0,1,2,3] row_mask:0x2 bank_mask:0xf
    v_mov_b32_dpp v12, v20 quad_perm:[0,1,2,3] row_mask:0x4 bank_mask:0xf
    v_mov_b32_dpp v12, v24 quad_perm:[0,1,2,3] row_mask:0x8 bank_mask:0xf
    v_mul_f32 v12, v10, v12
    v_add_u32 v12, 0x800, v12
    v_and_or_b32 v12, v12, s97, v11
    buffer_store_dword v12, v28, s[36:39], s48 offen sc1
    s_cmp_ge_u32 s32, 28
    s_cbranch_scc1 L_tend
    s_barrier
L_tend:
    s_endpgm
L_help:
    v_lshlrev_b32 v1, 4, v0
    v_lshlrev_b32 v28, 13, v2
    v_lshl_add_u32 v28, v3, 4, v28
    s_mul_i32 s47, s30, 896
    s_lshl_b32 s48, s31, 9
    s_sub_u32 s49, s3, 1
    s_lshl_b32 s49, s49, 7
    s_add_u32 s48, s48, s49
    s_sub_u32 s49, 3670016, s48
    s_mul_i32 s51, s30, 7
    s_lshr_b32 s51, s51, 2
    s_waitcnt lgkmcnt(0)
    s_add_u32 s88, s4, s47
    s_addc_u32 s89, s5, 0
    s_mov_b32 s90, 896
    s_mov_b32 s91, 0x20000
    s_add_u32 s52, s10, s48
    s_addc_u32 s53, s11, 0
    s_mov_b32 s54, s49
    s_mov_b32 s55, 0x20000
    buffer_load_dwordx4 v[4:7], v1, s[88:91], 0 offen
    s_lshl_b32 s48, s51, 18
    s_cmp_eq_u32 s28, 1
    s_cbranch_scc1 L_q1
    buffer_load_dwordx4 v[32:35], v28, s[52:55], s48 offen
    s_add_u32 s48, s48, 65536
    buffer_load_dwordx4 v[36:39], v28, s[52:55], s48 offen
    s_add_u32 s48, s48, 65536
    buffer_load_dwordx4 v[40:43], v28, s[52:55], s48 offen
    s_add_u32 s48, s48, 65536
    buffer_load_dwordx4 v[44:47], v28, s[52:55], s48 offen
    s_add_u32 s48, s48, 65536
    s_cmp_ge_u32 s48, 3670016
    s_cselect_b32 s48, 0, s48
    buffer_load_dwordx4 v[48:51], v28, s[52:55], s48 offen
    s_add_u32 s48, s48, 65536
    buffer_load_dwordx4 v[52:55], v28, s[52:55], s48 offen
    s_add_u32 s48, s48, 65536
    buffer_load_dwordx4 v[56:59], v28, s[52:55], s48 offen
    s_add_u32 s48, s48, 65536
    buffer_load_dwordx4 v[60:63], v28, s[52:55], s48 offen
    s_add_u32 s48, s48, 65536
    s_cmp_ge_u32 s48, 3670016
    s_cselect_b32 s48, 0, s48
    buffer_load_dwordx4 v[64:67], v28, s[52:55], s48 offen
    s_add_u32 s48, s48, 65536
    buffer_load_dwordx4 v[68:71], v28, s[52:55], s48 offen
    s_add_u32 s48, s48, 65536
    buffer_load_dwordx4 v[72:75], v28, s[52:55], s48 offen
    s_add_u32 s48, s48, 65536
    buffer_load_dwordx4 v[76:79], v28, s[52:55], s48 offen
    s_add_u32 s48, s48, 65536
    s_cmp_ge_u32 s48, 3670016
    s_cselect_b32 s48, 0, s48
    v_and_b32 v12, 1, v3
    v_lshlrev_b32 v12, 4, v12
    v_mov_b32 v13, 0xffff
    v_lshlrev_b32 v12, v12, v13
    v_lshrrev_b32 v13, 1, v3
    v_cmp_eq_u32 vcc, 0, v13
    s_nop 1
    v_cndmask_b32 v20, 0, v12, vcc
    v_cmp_eq_u32 vcc, 1, v13
    s_nop 1
    v_cndmask_b32 v21, 0, v12, vcc
    v_cmp_eq_u32 vcc, 2, v13
    s_nop 1
    v_cndmask_b32 v22, 0, v12, vcc
    v_cmp_eq_u32 vcc, 3, v13
    s_nop 1
    v_cndmask_b32 v23, 0, v12, vcc
    s_waitcnt vmcnt(12)
    v_lshlrev_b32 v8, 16, v4
    v_and_b32 v9, 0xffff0000, v4
    v_lshlrev_b32 v10, 16, v5
    v_and_b32 v11, 0xffff0000, v5
    v_lshlrev_b32 v12, 16, v6
    v_and_b32 v13, 0xffff0000, v6
    v_lshlrev_b32 v14, 16, v7
    v_and_b32 v15, 0xffff0000, v7
    v_add_f32 v16, v8, v9
    v_add_f32 v17, v10, v11
    v_add_f32 v18, v12, v13
    v_add_f32 v19, v14, v15
    v_add_f32 v16, v16, v17
    v_add_f32 v18, v18, v19
    v_add_f32 v16, v16, v18
    s_nop 1
    v_add_f32_dpp v16, v16, v16 quad_perm:[1,0,3,2] row_mask:0xf bank_mask:0xf
    s_nop 1
    v_add_f32_dpp v16, v16, v16 quad_perm:[2,3,0,1] row_mask:0xf bank_mask:0xf
    s_nop 1
    v_add_f32_dpp v16, v16, v16 row_half_mirror row_mask:0xf bank_mask:0xf
    s_nop 1
    v_add_f32_dpp v16, v16, v16 row_mirror row_mask:0xf bank_mask:0xf
    v_mov_b32 v17, v16
    s_nop 1
    v_permlane16_swap_b32 v16, v17
    v_add_f32 v16, v16, v17
    v_mov_b32 v17, v16
    s_nop 1
    v_permlane32_swap_b32 v16, v17
    v_add_f32 v16, v16, v17
    v_mul_f32 v16, 0x3b124925, v16
    v_cmp_gt_u32 vcc, 56, v0
    v_cvt_pk_bf16_f32 v17, 0, v16
    s_nop 0
    v_cndmask_b32 v16, 0, v16, vcc
    v_sub_f32 v4, v8, v16
    v_mul_f32 v18, v4, v4
    v_sub_f32 v4, v9, v16
    v_fmac_f32 v18, v4, v4
    v_sub_f32 v4, v10, v16
    v_fmac_f32 v18, v4, v4
    v_sub_f32 v4, v11, v16
    v_fmac_f32 v18, v4, v4
    v_sub_f32 v4, v12, v16
    v_fmac_f32 v18, v4, v4
    v_sub_f32 v4, v13, v16
    v_fmac_f32 v18, v4, v4
    v_sub_f32 v4, v14, v16
    v_fmac_f32 v18, v4, v4
    v_sub_f32 v4, v15, v16
    v_fmac_f32 v18, v4, v4
    s_nop 1
    v_add_f32_dpp v18, v18, v18 quad_perm:[1,0,3,2] row_mask:0xf bank_mask:0xf
    s_nop 1
    v_add_f32_dpp v18, v18, v18 quad_perm:[2,3,0,1] row_mask:0xf bank_mask:0xf
    s_nop 1
    v_add_f32_dpp v18, v18, v18 row_half_mirror row_mask:0xf bank_mask:0xf
    s_nop 1
    v_add_f32_dpp v18, v18, v18 row_mirror row_mask:0xf bank_mask:0xf
    v_mov_b32 v19, v18
    s_nop 1
    v_permlane16_swap_b32 v18, v19
    v_add_f32 v18, v18, v19
    v_mov_b32 v19, v18
    s_nop 1
    v_permlane32_swap_b32 v18, v19
    v_add_f32 v18, v18, v19
    v_mul_f32 v18, 0x3b124925, v18
    v_cvt_pk_bf16_f32 v18, 0, v18
    v_add_f32 v18, 0x3727c5ac, v18
    v_cvt_pk_bf16_f32 v18, 0, v18
    v_sqrt_f32 v18, v18
    s_nop 0
    v_cvt_pk_bf16_f32 v18, 0, v18
    v_rcp_f32 v19, v18
    v_sub_f32 v8, v8, v17
    v_cvt_pk_bf16_f32 v8, 0, v8
    v_mul_f32 v4, v8, v19
    v_fma_f32 v6, -v4, v18, v8
    v_fma_f32 v4, v6, v19, v4
    v_cvt_pk_bf16_f32 v8, v4, v4
    v_sub_f32 v9, v9, v17
    v_cvt_pk_bf16_f32 v9, 0, v9
    v_mul_f32 v4, v9, v19
    v_fma_f32 v6, -v4, v18, v9
    v_fma_f32 v4, v6, v19, v4
    v_cvt_pk_bf16_f32 v9, v4, v4
    v_sub_f32 v10, v10, v17
    v_cvt_pk_bf16_f32 v10, 0, v10
    v_mul_f32 v4, v10, v19
    v_fma_f32 v6, -v4, v18, v10
    v_fma_f32 v4, v6, v19, v4
    v_cvt_pk_bf16_f32 v10, v4, v4
    v_sub_f32 v11, v11, v17
    v_cvt_pk_bf16_f32 v11, 0, v11
    v_mul_f32 v4, v11, v19
    v_fma_f32 v6, -v4, v18, v11
    v_fma_f32 v4, v6, v19, v4
    v_cvt_pk_bf16_f32 v11, v4, v4
    v_sub_f32 v12, v12, v17
    v_cvt_pk_bf16_f32 v12, 0, v12
    v_mul_f32 v4, v12, v19
    v_fma_f32 v6, -v4, v18, v12
    v_fma_f32 v4, v6, v19, v4
    v_cvt_pk_bf16_f32 v12, v4, v4
    v_sub_f32 v13, v13, v17
    v_cvt_pk_bf16_f32 v13, 0, v13
    v_mul_f32 v4, v13, v19
    v_fma_f32 v6, -v4, v18, v13
    v_fma_f32 v4, v6, v19, v4
    v_cvt_pk_bf16_f32 v13, v4, v4
    v_sub_f32 v14, v14, v17
    v_cvt_pk_bf16_f32 v14, 0, v14
    v_mul_f32 v4, v14, v19
    v_fma_f32 v6, -v4, v18, v14
    v_fma_f32 v4, v6, v19, v4
    v_cvt_pk_bf16_f32 v14, v4, v4
    v_sub_f32 v15, v15, v17
    v_cvt_pk_bf16_f32 v15, 0, v15
    v_mul_f32 v4, v15, v19
    v_fma_f32 v6, -v4, v18, v15
    v_fma_f32 v4, v6, v19, v4
    v_cvt_pk_bf16_f32 v15, v4, v4
    s_sub_u32 s47, s3, 1
    s_mul_i32 s47, s47, 2176
    s_add_u32 s47, s47, 9600
    s_lshl_b32 s50, s51, 2
    v_subrev_u32 v5, s50, v0
    v_add_u32 v6, 56, v5
    v_min_u32 v5, v5, v6
    v_cmp_lt_u32 vcc, 55, v0
    s_nop 1
    v_cndmask_b32 v5, v5, v0, vcc
    v_lshl_add_u32 v5, v5, 2, s47
    ds_write_b32 v5, v8 offset:0
    ds_write_b32 v5, v9 offset:272
    ds_write_b32 v5, v10 offset:544
    ds_write_b32 v5, v11 offset:816
    ds_write_b32 v5, v12 offset:1088
    ds_write_b32 v5, v13 offset:1360
    ds_write_b32 v5, v14 offset:1632
    ds_write_b32 v5, v15 offset:1904
    v_mul_u32_u24 v29, 272, v2
    v_add_u32 v29, s47, v29
    s_waitcnt lgkmcnt(0)
    ds_read_b128 v[4:7], v29
    ds_read_b128 v[8:11], v29 offset:16
    s_waitcnt lgkmcnt(1)
    v_and_b32 v12, v4, v20
    v_and_b32 v13, v4, v21
    v_and_b32 v14, v4, v22
    v_and_b32 v15, v4, v23
    v_and_b32 v16, v5, v20
    v_and_b32 v17, v5, v21
    v_and_b32 v18, v5, v22
    v_and_b32 v19, v5, v23
    buffer_load_dwordx4 v[80:83], v28, s[52:55], s48 offen
    s_add_u32 s48, s48, 65536
    s_waitcnt vmcnt(12)
    v_mfma_f32_16x16x32_bf16 v[24:27], v[32:35], v[12:15], 0
    v_and_b32 v12, v6, v20
    v_and_b32 v13, v6, v21
    v_and_b32 v14, v6, v22
    v_and_b32 v15, v6, v23
    buffer_load_dwordx4 v[84:87], v28, s[52:55], s48 offen
    s_add_u32 s48, s48, 65536
    s_waitcnt vmcnt(12)
    v_mfma_f32_16x16x32_bf16 v[24:27], v[36:39], v[16:19], v[24:27]
    v_and_b32 v16, v7, v20
    v_and_b32 v17, v7, v21
    v_and_b32 v18, v7, v22
    v_and_b32 v19, v7, v23
    ds_read_b128 v[4:7], v29 offset:32
    buffer_load_dwordx4 v[88:91], v28, s[52:55], s48 offen
    s_add_u32 s48, s48, 65536
    s_waitcnt vmcnt(12)
    v_mfma_f32_16x16x32_bf16 v[24:27], v[40:43], v[12:15], v[24:27]
    s_waitcnt lgkmcnt(1)
    v_and_b32 v12, v8, v20
    v_and_b32 v13, v8, v21
    v_and_b32 v14, v8, v22
    v_and_b32 v15, v8, v23
    buffer_load_dwordx4 v[92:95], v28, s[52:55], s48 offen
    s_add_u32 s48, s48, 65536
    s_cmp_ge_u32 s48, 3670016
    s_cselect_b32 s48, 0, s48
    s_waitcnt vmcnt(12)
    v_mfma_f32_16x16x32_bf16 v[24:27], v[44:47], v[16:19], v[24:27]
    v_and_b32 v16, v9, v20
    v_and_b32 v17, v9, v21
    v_and_b32 v18, v9, v22
    v_and_b32 v19, v9, v23
    buffer_load_dwordx4 v[96:99], v28, s[52:55], s48 offen
    s_add_u32 s48, s48, 65536
    s_waitcnt vmcnt(12)
    v_mfma_f32_16x16x32_bf16 v[24:27], v[48:51], v[12:15], v[24:27]
    v_and_b32 v12, v10, v20
    v_and_b32 v13, v10, v21
    v_and_b32 v14, v10, v22
    v_and_b32 v15, v10, v23
    buffer_load_dwordx4 v[100:103], v28, s[52:55], s48 offen
    s_add_u32 s48, s48, 65536
    s_waitcnt vmcnt(12)
    v_mfma_f32_16x16x32_bf16 v[24:27], v[52:55], v[16:19], v[24:27]
    v_and_b32 v16, v11, v20
    v_and_b32 v17, v11, v21
    v_and_b32 v18, v11, v22
    v_and_b32 v19, v11, v23
    ds_read_b128 v[8:11], v29 offset:48
    buffer_load_dwordx4 v[104:107], v28, s[52:55], s48 offen
    s_add_u32 s48, s48, 65536
    s_waitcnt vmcnt(12)
    v_mfma_f32_16x16x32_bf16 v[24:27], v[56:59], v[12:15], v[24:27]
    s_waitcnt lgkmcnt(1)
    v_and_b32 v12, v4, v20
    v_and_b32 v13, v4, v21
    v_and_b32 v14, v4, v22
    v_and_b32 v15, v4, v23
    buffer_load_dwordx4 v[108:111], v28, s[52:55], s48 offen
    s_add_u32 s48, s48, 65536
    s_cmp_ge_u32 s48, 3670016
    s_cselect_b32 s48, 0, s48
    s_waitcnt vmcnt(12)
    v_mfma_f32_16x16x32_bf16 v[24:27], v[60:63], v[16:19], v[24:27]
    v_and_b32 v16, v5, v20
    v_and_b32 v17, v5, v21
    v_and_b32 v18, v5, v22
    v_and_b32 v19, v5, v23
    buffer_load_dwordx4 v[112:115], v28, s[52:55], s48 offen
    s_add_u32 s48, s48, 65536
    s_waitcnt vmcnt(12)
    v_mfma_f32_16x16x32_bf16 v[24:27], v[64:67], v[12:15], v[24:27]
    v_and_b32 v12, v6, v20
    v_and_b32 v13, v6, v21
    v_and_b32 v14, v6, v22
    v_and_b32 v15, v6, v23
    buffer_load_dwordx4 v[116:119], v28, s[52:55], s48 offen
    s_add_u32 s48, s48, 65536
    s_waitcnt vmcnt(12)
    v_mfma_f32_16x16x32_bf16 v[24:27], v[68:71], v[16:19], v[24:27]
    v_and_b32 v16, v7, v20
    v_and_b32 v17, v7, v21
    v_and_b32 v18, v7, v22
    v_and_b32 v19, v7, v23
    ds_read_b128 v[4:7], v29 offset:64
    buffer_load_dwordx4 v[120:123], v28, s[52:55], s48 offen
    s_add_u32 s48, s48, 65536
    s_waitcnt vmcnt(12)
    v_mfma_f32_16x16x32_bf16 v[24:27], v[72:75], v[12:15], v[24:27]
    s_waitcnt lgkmcnt(1)
    v_and_b32 v12, v8, v20
    v_and_b32 v13, v8, v21
    v_and_b32 v14, v8, v22
    v_and_b32 v15, v8, v23
    buffer_load_dwordx4 v[124:127], v28, s[52:55], s48 offen
    s_add_u32 s48, s48, 65536
    s_cmp_ge_u32 s48, 3670016
    s_cselect_b32 s48, 0, s48
    s_waitcnt vmcnt(12)
    v_mfma_f32_16x16x32_bf16 v[24:27], v[76:79], v[16:19], v[24:27]
    v_and_b32 v16, v9, v20
    v_and_b32 v17, v9, v21
    v_and_b32 v18, v9, v22
    v_and_b32 v19, v9, v23
    buffer_load_dwordx4 v[128:131], v28, s[52:55], s48 offen
    s_add_u32 s48, s48, 65536
    s_waitcnt vmcnt(12)
    v_mfma_f32_16x16x32_bf16 v[24:27], v[80:83], v[12:15], v[24:27]
    v_and_b32 v12, v10, v20
    v_and_b32 v13, v10, v21
    v_and_b32 v14, v10, v22
    v_and_b32 v15, v10, v23
    buffer_load_dwordx4 v[132:135], v28, s[52:55], s48 offen
    s_add_u32 s48, s48, 65536
    s_waitcnt vmcnt(12)
    v_mfma_f32_16x16x32_bf16 v[24:27], v[84:87], v[16:19], v[24:27]
    v_and_b32 v16, v11, v20
    v_and_b32 v17, v11, v21
    v_and_b32 v18, v11, v22
    v_and_b32 v19, v11, v23
    ds_read_b128 v[8:11], v29 offset:80
    buffer_load_dwordx4 v[136:139], v28, s[52:55], s48 offen
    s_add_u32 s48, s48, 65536
    s_waitcnt vmcnt(12)
    v_mfma_f32_16x16x32_bf16 v[24:27], v[88:91], v[12:15], v[24:27]
    s_waitcnt lgkmcnt(1)
    v_and_b32 v12, v4, v20
    v_and_b32 v13, v4, v21
    v_and_b32 v14, v4, v22
    v_and_b32 v15, v4, v23
    buffer_load_dwordx4 v[140:143], v28, s[52:55], s48 offen
    s_add_u32 s48, s48, 65536
    s_cmp_ge_u32 s48, 3670016
    s_cselect_b32 s48, 0, s48
    s_waitcnt vmcnt(12)
    v_mfma_f32_16x16x32_bf16 v[24:27], v[92:95], v[16:19], v[24:27]
    v_and_b32 v16, v5, v20
    v_and_b32 v17, v5, v21
    v_and_b32 v18, v5, v22
    v_and_b32 v19, v5, v23
    buffer_load_dwordx4 v[144:147], v28, s[52:55], s48 offen
    s_add_u32 s48, s48, 65536
    s_waitcnt vmcnt(12)
    v_mfma_f32_16x16x32_bf16 v[24:27], v[96:99], v[12:15], v[24:27]
    v_and_b32 v12, v6, v20
    v_and_b32 v13, v6, v21
    v_and_b32 v14, v6, v22
    v_and_b32 v15, v6, v23
    buffer_load_dwordx4 v[148:151], v28, s[52:55], s48 offen
    s_add_u32 s48, s48, 65536
    s_waitcnt vmcnt(12)
    v_mfma_f32_16x16x32_bf16 v[24:27], v[100:103], v[16:19], v[24:27]
    v_and_b32 v16, v7, v20
    v_and_b32 v17, v7, v21
    v_and_b32 v18, v7, v22
    v_and_b32 v19, v7, v23
    ds_read_b128 v[4:7], v29 offset:96
    buffer_load_dwordx4 v[152:155], v28, s[52:55], s48 offen
    s_add_u32 s48, s48, 65536
    s_waitcnt vmcnt(12)
    v_mfma_f32_16x16x32_bf16 v[24:27], v[104:107], v[12:15], v[24:27]
    s_waitcnt lgkmcnt(1)
    v_and_b32 v12, v8, v20
    v_and_b32 v13, v8, v21
    v_and_b32 v14, v8, v22
    v_and_b32 v15, v8, v23
    buffer_load_dwordx4 v[156:159], v28, s[52:55], s48 offen
    s_add_u32 s48, s48, 65536
    s_cmp_ge_u32 s48, 3670016
    s_cselect_b32 s48, 0, s48
    s_waitcnt vmcnt(12)
    v_mfma_f32_16x16x32_bf16 v[24:27], v[108:111], v[16:19], v[24:27]
    v_and_b32 v16, v9, v20
    v_and_b32 v17, v9, v21
    v_and_b32 v18, v9, v22
    v_and_b32 v19, v9, v23
    buffer_load_dwordx4 v[160:163], v28, s[52:55], s48 offen
    s_add_u32 s48, s48, 65536
    s_waitcnt vmcnt(12)
    v_mfma_f32_16x16x32_bf16 v[24:27], v[112:115], v[12:15], v[24:27]
    v_and_b32 v12, v10, v20
    v_and_b32 v13, v10, v21
    v_and_b32 v14, v10, v22
    v_and_b32 v15, v10, v23
    buffer_load_dwordx4 v[164:167], v28, s[52:55], s48 offen
    s_add_u32 s48, s48, 65536
    s_waitcnt vmcnt(12)
    v_mfma_f32_16x16x32_bf16 v[24:27], v[116:119], v[16:19], v[24:27]
    v_and_b32 v16, v11, v20
    v_and_b32 v17, v11, v21
    v_and_b32 v18, v11, v22
    v_and_b32 v19, v11, v23
    ds_read_b128 v[8:11], v29 offset:112
    buffer_load_dwordx4 v[168:171], v28, s[52:55], s48 offen
    s_add_u32 s48, s48, 65536
    s_waitcnt vmcnt(12)
    v_mfma_f32_16x16x32_bf16 v[24:27], v[120:123], v[12:15], v[24:27]
    s_waitcnt lgkmcnt(1)
    v_and_b32 v12, v4, v20
    v_and_b32 v13, v4, v21
    v_and_b32 v14, v4, v22
    v_and_b32 v15, v4, v23
    buffer_load_dwordx4 v[172:175], v28, s[52:55], s48 offen
    s_add_u32 s48, s48, 65536
    s_cmp_ge_u32 s48, 3670016
    s_cselect_b32 s48, 0, s48
    s_waitcnt vmcnt(12)
    v_mfma_f32_16x16x32_bf16 v[24:27], v[124:127], v[16:19], v[24:27]
    v_and_b32 v16, v5, v20
    v_and_b32 v17, v5, v21
    v_and_b32 v18, v5, v22
    v_and_b32 v19, v5, v23
    buffer_load_dwordx4 v[176:179], v28, s[52:55], s48 offen
    s_add_u32 s48, s48, 65536
    s_waitcnt vmcnt(12)
    v_mfma_f32_16x16x32_bf16 v[24:27], v[128:131], v[12:15], v[24:27]
    v_and_b32 v12, v6, v20
    v_and_b32 v13, v6, v21
    v_and_b32 v14, v6, v22
    v_and_b32 v15, v6, v23
    buffer_load_dwordx4 v[180:183], v28, s[52:55], s48 offen
    s_add_u32 s48, s48, 65536
    s_waitcnt vmcnt(12)
    v_mfma_f32_16x16x32_bf16 v[24:27], v[132:135], v[16:19], v[24:27]
    v_and_b32 v16, v7, v20
    v_and_b32 v17, v7, v21
    v_and_b32 v18, v7, v22
    v_and_b32 v19, v7, v23
    ds_read_b128 v[4:7], v29 offset:128
    buffer_load_dwordx4 v[184:187], v28, s[52:55], s48 offen
    s_add_u32 s48, s48, 65536
    s_waitcnt vmcnt(12)
    v_mfma_f32_16x16x32_bf16 v[24:27], v[136:139], v[12:15], v[24:27]
    s_waitcnt lgkmcnt(1)
    v_and_b32 v12, v8, v20
    v_and_b32 v13, v8, v21
    v_and_b32 v14, v8, v22
    v_and_b32 v15, v8, v23
    buffer_load_dwordx4 v[188:191], v28, s[52:55], s48 offen
    s_add_u32 s48, s48, 65536
    s_cmp_ge_u32 s48, 3670016
    s_cselect_b32 s48, 0, s48
    s_waitcnt vmcnt(12)
    v_mfma_f32_16x16x32_bf16 v[24:27], v[140:143], v[16:19], v[24:27]
    v_and_b32 v16, v9, v20
    v_and_b32 v17, v9, v21
    v_and_b32 v18, v9, v22
    v_and_b32 v19, v9, v23
    buffer_load_dwordx4 v[192:195], v28, s[52:55], s48 offen
    s_add_u32 s48, s48, 65536
    s_waitcnt vmcnt(12)
    v_mfma_f32_16x16x32_bf16 v[24:27], v[144:147], v[12:15], v[24:27]
    v_and_b32 v12, v10, v20
    v_and_b32 v13, v10, v21
    v_and_b32 v14, v10, v22
    v_and_b32 v15, v10, v23
    buffer_load_dwordx4 v[196:199], v28, s[52:55], s48 offen
    s_add_u32 s48, s48, 65536
    s_waitcnt vmcnt(12)
    v_mfma_f32_16x16x32_bf16 v[24:27], v[148:151], v[16:19], v[24:27]
    v_and_b32 v16, v11, v20
    v_and_b32 v17, v11, v21
    v_and_b32 v18, v11, v22
    v_and_b32 v19, v11, v23
    ds_read_b128 v[8:11], v29 offset:144
    buffer_load_dwordx4 v[200:203], v28, s[52:55], s48 offen
    s_add_u32 s48, s48, 65536
    s_waitcnt vmcnt(12)
    v_mfma_f32_16x16x32_bf16 v[24:27], v[152:155], v[12:15], v[24:27]
    s_waitcnt lgkmcnt(1)
    v_and_b32 v12, v4, v20
    v_and_b32 v13, v4, v21
    v_and_b32 v14, v4, v22
    v_and_b32 v15, v4, v23
    buffer_load_dwordx4 v[204:207], v28, s[52:55], s48 offen
    s_add_u32 s48, s48, 65536
    s_cmp_ge_u32 s48, 3670016
    s_cselect_b32 s48, 0, s48
    s_waitcnt vmcnt(12)
    v_mfma_f32_16x16x32_bf16 v[24:27], v[156:159], v[16:19], v[24:27]
    v_and_b32 v16, v5, v20
    v_and_b32 v17, v5, v21
    v_and_b32 v18, v5, v22
    v_and_b32 v19, v5, v23
    buffer_load_dwordx4 v[208:211], v28, s[52:55], s48 offen
    s_add_u32 s48, s48, 65536
    s_waitcnt vmcnt(12)
    v_mfma_f32_16x16x32_bf16 v[24:27], v[160:163], v[12:15], v[24:27]
    v_and_b32 v12, v6, v20
    v_and_b32 v13, v6, v21
    v_and_b32 v14, v6, v22
    v_and_b32 v15, v6, v23
    buffer_load_dwordx4 v[212:215], v28, s[52:55], s48 offen
    s_add_u32 s48, s48, 65536
    s_waitcnt vmcnt(12)
    v_mfma_f32_16x16x32_bf16 v[24:27], v[164:167], v[16:19], v[24:27]
    v_and_b32 v16, v7, v20
    v_and_b32 v17, v7, v21
    v_and_b32 v18, v7, v22
    v_and_b32 v19, v7, v23
    ds_read_b128 v[4:7], v29 offset:160
    buffer_load_dwordx4 v[216:219], v28, s[52:55], s48 offen
    s_add_u32 s48, s48, 65536
    s_waitcnt vmcnt(12)
    v_mfma_f32_16x16x32_bf16 v[24:27], v[168:171], v[12:15], v[24:27]
    s_waitcnt lgkmcnt(1)
    v_and_b32 v12, v8, v20
    v_and_b32 v13, v8, v21
    v_and_b32 v14, v8, v22
    v_and_b32 v15, v8, v23
    buffer_load_dwordx4 v[220:223], v28, s[52:55], s48 offen
    s_add_u32 s48, s48, 65536
    s_cmp_ge_u32 s48, 3670016
    s_cselect_b32 s48, 0, s48
    s_waitcnt vmcnt(12)
    v_mfma_f32_16x16x32_bf16 v[24:27], v[172:175], v[16:19], v[24:27]
    v_and_b32 v16, v9, v20
    v_and_b32 v17, v9, v21
    v_and_b32 v18, v9, v22
    v_and_b32 v19, v9, v23
    buffer_load_dwordx4 v[224:227], v28, s[52:55], s48 offen
    s_add_u32 s48, s48, 65536
    s_waitcnt vmcnt(12)
    v_mfma_f32_16x16x32_bf16 v[24:27], v[176:179], v[12:15], v[24:27]
    v_and_b32 v12, v10, v20
    v_and_b32 v13, v10, v21
    v_and_b32 v14, v10, v22
    v_and_b32 v15, v10, v23
    buffer_load_dwordx4 v[228:231], v28, s[52:55], s48 offen
    s_add_u32 s48, s48, 65536
    s_waitcnt vmcnt(12)
    v_mfma_f32_16x16x32_bf16 v[24:27], v[180:183], v[16:19], v[24:27]
    v_and_b32 v16, v11, v20
    v_and_b32 v17, v11, v21
    v_and_b32 v18, v11, v22
    v_and_b32 v19, v11, v23
    ds_read_b128 v[8:11], v29 offset:176
    buffer_load_dwordx4 v[232:235], v28, s[52:55], s48 offen
    s_add_u32 s48, s48, 65536
    s_waitcnt vmcnt(12)
    v_mfma_f32_16x16x32_bf16 v[24:27], v[184:187], v[12:15], v[24:27]
    s_waitcnt lgkmcnt(1)
    v_and_b32 v12, v4, v20
    v_and_b32 v13, v4, v21
    v_and_b32 v14, v4, v22
    v_and_b32 v15, v4, v23
    buffer_load_dwordx4 v[236:239], v28, s[52:55], s48 offen
    s_add_u32 s48, s48, 65536
    s_cmp_ge_u32 s48, 3670016
    s_cselect_b32 s48, 0, s48
    s_waitcnt vmcnt(12)
    v_mfma_f32_16x16x32_bf16 v[24:27], v[188:191], v[16:19], v[24:27]
    v_and_b32 v16, v5, v20
    v_and_b32 v17, v5, v21
    v_and_b32 v18, v5, v22
    v_and_b32 v19, v5, v23
    buffer_load_dwordx4 v[240:243], v28, s[52:55], s48 offen
    s_add_u32 s48, s48, 65536
    s_waitcnt vmcnt(12)
    v_mfma_f32_16x16x32_bf16 v[24:27], v[192:195], v[12:15], v[24:27]
    v_and_b32 v12, v6, v20
    v_and_b32 v13, v6, v21
    v_and_b32 v14, v6, v22
    v_and_b32 v15, v6, v23
    buffer_load_dwordx4 v[244:247], v28, s[52:55], s48 offen
    s_add_u32 s48, s48, 65536
    s_waitcnt vmcnt(12)
    v_mfma_f32_16x16x32_bf16 v[24:27], v[196:199], v[16:19], v[24:27]
    v_and_b32 v16, v7, v20
    v_and_b32 v17, v7, v21
    v_and_b32 v18, v7, v22
    v_and_b32 v19, v7, v23
    ds_read_b128 v[4:7], v29 offset:192
    buffer_load_dwordx4 v[248:251], v28, s[52:55], s48 offen
    s_add_u32 s48, s48, 65536
    s_waitcnt vmcnt(12)
    v_mfma_f32_16x16x32_bf16 v[24:27], v[200:203], v[12:15], v[24:27]
    s_waitcnt lgkmcnt(1)
    v_and_b32 v12, v8, v20
    v_and_b32 v13, v8, v21
    v_and_b32 v14, v8, v22
    v_and_b32 v15, v8, v23
    buffer_load_dwordx4 v[252:255], v28, s[52:55], s48 offen
    s_add_u32 s48, s48, 65536
    s_barrier
    s_waitcnt vmcnt(12)
    v_mfma_f32_16x16x32_bf16 v[24:27], v[204:207], v[16:19], v[24:27]
    v_and_b32 v16, v9, v20
    v_and_b32 v17, v9, v21
    v_and_b32 v18, v9, v22
    v_and_b32 v19, v9, v23
    s_waitcnt vmcnt(11)
    v_mfma_f32_16x16x32_bf16 v[24:27], v[208:211], v[12:15], v[24:27]
    v_and_b32 v12, v10, v20
    v_and_b32 v13, v10, v21
    v_and_b32 v14, v10, v22
    v_and_b32 v15, v10, v23
    s_waitcnt vmcnt(10)
    v_mfma_f32_16x16x32_bf16 v[24:27], v[212:215], v[16:19], v[24:27]
    v_and_b32 v16, v11, v20
    v_and_b32 v17, v11, v21
    v_and_b32 v18, v11, v22
    v_and_b32 v19, v11, v23
    ds_read_b128 v[8:11], v29 offset:208
    s_waitcnt vmcnt(9)
    v_mfma_f32_16x16x32_bf16 v[24:27], v[216:219], v[12:15], v[24:27]
    s_waitcnt lgkmcnt(1)
    v_and_b32 v12, v4, v20
    v_and_b32 v13, v4, v21
    v_and_b32 v14, v4, v22
    v_and_b32 v15, v4, v23
    s_waitcnt vmcnt(8)
    v_mfma_f32_16x16x32_bf16 v[24:27], v[220:223], v[16:19], v[24:27]
    v_and_b32 v16, v5, v20
    v_and_b32 v17, v5, v21
    v_and_b32 v18, v5, v22
    v_and_b32 v19, v5, v23
    s_waitcnt vmcnt(7)
    v_mfma_f32_16x16x32_bf16 v[24:27], v[224:227], v[12:15], v[24:27]
    v_and_b32 v12, v6, v20
    v_and_b32 v13, v6, v21
    v_and_b32 v14, v6, v22
    v_and_b32 v15, v6, v23
    s_waitcnt vmcnt(6)
    v_mfma_f32_16x16x32_bf16 v[24:27], v[228:231], v[16:19], v[24:27]
    v_and_b32 v16, v7, v20
    v_and_b32 v17, v7, v21
    v_and_b32 v18, v7, v22
    v_and_b32 v19, v7, v23
    s_waitcnt vmcnt(5)
    v_mfma_f32_16x16x32_bf16 v[24:27], v[232:235], v[12:15], v[24:27]
    s_waitcnt lgkmcnt(0)
    v_and_b32 v12, v8, v20
    v_and_b32 v13, v8, v21
    v_and_b32 v14, v8, v22
    v_and_b32 v15, v8, v23
    s_waitcnt vmcnt(4)
    v_mfma_f32_16x16x32_bf16 v[24:27], v[236:239], v[16:19], v[24:27]
    v_and_b32 v16, v9, v20
    v_and_b32 v17, v9, v21
    v_and_b32 v18, v9, v22
    v_and_b32 v19, v9, v23
    s_waitcnt vmcnt(3)
    v_mfma_f32_16x16x32_bf16 v[24:27], v[240:243], v[12:15], v[24:27]
    v_and_b32 v12, v10, v20
    v_and_b32 v13, v10, v21
    v_and_b32 v14, v10, v22
    v_and_b32 v15, v10, v23
    s_waitcnt vmcnt(2)
    v_mfma_f32_16x16x32_bf16 v[24:27], v[244:247], v[16:19], v[24:27]
    v_and_b32 v16, v11, v20
    v_and_b32 v17, v11, v21
    v_and_b32 v18, v11, v22
    v_and_b32 v19, v11, v23
    s_waitcnt vmcnt(1)
    v_mfma_f32_16x16x32_bf16 v[24:27], v[248:251], v[12:15], v[24:27]
    s_nop 0
    s_waitcnt vmcnt(0)
    v_mfma_f32_16x16x32_bf16 v[24:27], v[252:255], v[16:19], v[24:27]
    s_nop 7
    v_permlane32_swap_b32 v24, v25
    v_permlane32_swap_b32 v26, v27
    s_nop 1
    v_add_f32_dpp v12, v25, v24 row_ror:8 row_mask:0xf bank_mask:0xf
    v_add_f32_dpp v13, v27, v26 row_ror:8 row_mask:0xf bank_mask:0xf
    s_branch L_q2
L_q1:
    v_and_b32 v12, 1, v3
    v_lshlrev_b32 v12, 4, v12
    v_mov_b32 v13, 0xffff
    v_lshlrev_b32 v12, v12, v13
    v_lshrrev_b32 v13, 1, v3
    v_cmp_eq_u32 vcc, 0, v13
    s_nop 1
    v_cndmask_b32 v20, 0, v12, vcc
    v_cmp_eq_u32 vcc, 1, v13
    s_nop 1
    v_cndmask_b32 v21, 0, v12, vcc
    v_cmp_eq_u32 vcc, 2, v13
    s_nop 1
    v_cndmask_b32 v22, 0, v12, vcc
    v_cmp_eq_u32 vcc, 3, v13
    s_nop 1
    v_cndmask_b32 v23, 0, v12, vcc
    s_waitcnt vmcnt(0)
    v_lshlrev_b32 v8, 16, v4
    v_and_b32 v9, 0xffff0000, v4
    v_lshlrev_b32 v10, 16, v5
    v_and_b32 v11, 0xffff0000, v5
    v_lshlrev_b32 v12, 16, v6
    v_and_b32 v13, 0xffff0000, v6
    v_lshlrev_b32 v14, 16, v7
    v_and_b32 v15, 0xffff0000, v7
    v_add_f32 v16, v8, v9
    v_add_f32 v17, v10, v11
    v_add_f32 v18, v12, v13
    v_add_f32 v19, v14, v15
    v_add_f32 v16, v16, v17
    v_add_f32 v18, v18, v19
    v_add_f32 v16, v16, v18
    s_nop 1
    v_add_f32_dpp v16, v16, v16 quad_perm:[1,0,3,2] row_mask:0xf bank_mask:0xf
    s_nop 1
    v_add_f32_dpp v16, v16, v16 quad_perm:[2,3,0,1] row_mask:0xf bank_mask:0xf
    s_nop 1
    v_add_f32_dpp v16, v16, v16 row_half_mirror row_mask:0xf bank_mask:0xf
    s_nop 1
    v_add_f32_dpp v16, v16, v16 row_mirror row_mask:0xf bank_mask:0xf
    v_mov_b32 v17, v16
    s_nop 1
    v_permlane16_swap_b32 v16, v17
    v_add_f32 v16, v16, v17
    v_mov_b32 v17, v16
    s_nop 1
    v_permlane32_swap_b32 v16, v17
    v_add_f32 v16, v16, v17
    v_mul_f32 v16, 0x3b124925, v16
    v_cmp_gt_u32 vcc, 56, v0
    v_cvt_pk_bf16_f32 v17, 0, v16
    s_nop 0
    v_cndmask_b32 v16, 0, v16, vcc
    v_sub_f32 v4, v8, v16
    v_mul_f32 v18, v4, v4
    v_sub_f32 v4, v9, v16
    v_fmac_f32 v18, v4, v4
    v_sub_f32 v4, v10, v16
    v_fmac_f32 v18, v4, v4
    v_sub_f32 v4, v11, v16
    v_fmac_f32 v18, v4, v4
    v_sub_f32 v4, v12, v16
    v_fmac_f32 v18, v4, v4
    v_sub_f32 v4, v13, v16
    v_fmac_f32 v18, v4, v4
    v_sub_f32 v4, v14, v16
    v_fmac_f32 v18, v4, v4
    v_sub_f32 v4, v15, v16
    v_fmac_f32 v18, v4, v4
    s_nop 1
    v_add_f32_dpp v18, v18, v18 quad_perm:[1,0,3,2] row_mask:0xf bank_mask:0xf
    s_nop 1
    v_add_f32_dpp v18, v18, v18 quad_perm:[2,3,0,1] row_mask:0xf bank_mask:0xf
    s_nop 1
    v_add_f32_dpp v18, v18, v18 row_half_mirror row_mask:0xf bank_mask:0xf
    s_nop 1
    v_add_f32_dpp v18, v18, v18 row_mirror row_mask:0xf bank_mask:0xf
    v_mov_b32 v19, v18
    s_nop 1
    v_permlane16_swap_b32 v18, v19
    v_add_f32 v18, v18, v19
    v_mov_b32 v19, v18
    s_nop 1
    v_permlane32_swap_b32 v18, v19
    v_add_f32 v18, v18, v19
    v_mul_f32 v18, 0x3b124925, v18
    v_cvt_pk_bf16_f32 v18, 0, v18
    v_add_f32 v18, 0x3727c5ac, v18
    v_cvt_pk_bf16_f32 v18, 0, v18
    v_sqrt_f32 v18, v18
    s_nop 0
    v_cvt_pk_bf16_f32 v18, 0, v18
    v_rcp_f32 v19, v18
    v_sub_f32 v8, v8, v17
    v_cvt_pk_bf16_f32 v8, 0, v8
    v_mul_f32 v4, v8, v19
    v_fma_f32 v6, -v4, v18, v8
    v_fma_f32 v4, v6, v19, v4
    v_cvt_pk_bf16_f32 v8, v4, v4
    v_sub_f32 v9, v9, v17
    v_cvt_pk_bf16_f32 v9, 0, v9
    v_mul_f32 v4, v9, v19
    v_fma_f32 v6, -v4, v18, v9
    v_fma_f32 v4, v6, v19, v4
    v_cvt_pk_bf16_f32 v9, v4, v4
    v_sub_f32 v10, v10, v17
    v_cvt_pk_bf16_f32 v10, 0, v10
    v_mul_f32 v4, v10, v19
    v_fma_f32 v6, -v4, v18, v10
    v_fma_f32 v4, v6, v19, v4
    v_cvt_pk_bf16_f32 v10, v4, v4
    v_sub_f32 v11, v11, v17
    v_cvt_pk_bf16_f32 v11, 0, v11
    v_mul_f32 v4, v11, v19
    v_fma_f32 v6, -v4, v18, v11
    v_fma_f32 v4, v6, v19, v4
    v_cvt_pk_bf16_f32 v11, v4, v4
    v_sub_f32 v12, v12, v17
    v_cvt_pk_bf16_f32 v12, 0, v12
    v_mul_f32 v4, v12, v19
    v_fma_f32 v6, -v4, v18, v12
    v_fma_f32 v4, v6, v19, v4
    v_cvt_pk_bf16_f32 v12, v4, v4
    v_sub_f32 v13, v13, v17
    v_cvt_pk_bf16_f32 v13, 0, v13
    v_mul_f32 v4, v13, v19
    v_fma_f32 v6, -v4, v18, v13
    v_fma_f32 v4, v6, v19, v4
    v_cvt_pk_bf16_f32 v13, v4, v4
    v_sub_f32 v14, v14, v17
    v_cvt_pk_bf16_f32 v14, 0, v14
    v_mul_f32 v4, v14, v19
    v_fma_f32 v6, -v4, v18, v14
    v_fma_f32 v4, v6, v19, v4
    v_cvt_pk_bf16_f32 v14, v4, v4
    v_sub_f32 v15, v15, v17
    v_cvt_pk_bf16_f32 v15, 0, v15
    v_mul_f32 v4, v15, v19
    v_fma_f32 v6, -v4, v18, v15
    v_fma_f32 v4, v6, v19, v4
    v_cvt_pk_bf16_f32 v15, v4, v4
    s_sub_u32 s47, s3, 1
    s_mul_i32 s47, s47, 2176
    s_add_u32 s47, s47, 9600
    s_lshl_b32 s50, s51, 2
    v_subrev_u32 v5, s50, v0
    v_add_u32 v6, 56, v5
    v_min_u32 v5, v5, v6
    v_cmp_lt_u32 vcc, 55, v0
    s_nop 1
    v_cndmask_b32 v5, v5, v0, vcc
    v_lshl_add_u32 v5, v5, 2, s47
    ds_write_b32 v5, v8 offset:0
    ds_write_b32 v5, v9 offset:272
    ds_write_b32 v5, v10 offset:544
    ds_write_b32 v5, v11 offset:816
    ds_write_b32 v5, v12 offset:1088
    ds_write_b32 v5, v13 offset:1360
    ds_write_b32 v5, v14 offset:1632
    ds_write_b32 v5, v15 offset:1904
    v_mul_u32_u24 v29, 272, v2
    v_add_u32 v29, s47, v29
    s_barrier
    buffer_load_dwordx4 v[32:35], v28, s[52:55], s48 offen
    s_add_u32 s48, s48, 65536
    buffer_load_dwordx4 v[36:39], v28, s[52:55], s48 offen
    s_add_u32 s48, s48, 65536
    buffer_load_dwordx4 v[40:43], v28, s[52:55], s48 offen
    s_add_u32 s48, s48, 65536
    buffer_load_dwordx4 v[44:47], v28, s[52:55], s48 offen
    s_add_u32 s48, s48, 65536
    s_cmp_ge_u32 s48, 3670016
    s_cselect_b32 s48, 0, s48
    buffer_load_dwordx4 v[48:51], v28, s[52:55], s48 offen
    s_add_u32 s48, s48, 65536
    buffer_load_dwordx4 v[52:55], v28, s[52:55], s48 offen
    s_add_u32 s48, s48, 65536
    buffer_load_dwordx4 v[56:59], v28, s[52:55], s48 offen
    s_add_u32 s48, s48, 65536
    buffer_load_dwordx4 v[60:63], v28, s[52:55], s48 offen
    s_add_u32 s48, s48, 65536
    s_cmp_ge_u32 s48, 3670016
    s_cselect_b32 s48, 0, s48
    buffer_load_dwordx4 v[64:67], v28, s[52:55], s48 offen
    s_add_u32 s48, s48, 65536
    buffer_load_dwordx4 v[68:71], v28, s[52:55], s48 offen
    s_add_u32 s48, s48, 65536
    buffer_load_dwordx4 v[72:75], v28, s[52:55], s48 offen
    s_add_u32 s48, s48, 65536
    buffer_load_dwordx4 v[76:79], v28, s[52:55], s48 offen
    s_add_u32 s48, s48, 65536
    s_cmp_ge_u32 s48, 3670016
    s_cselect_b32 s48, 0, s48
    s_waitcnt lgkmcnt(0)
    ds_read_b128 v[4:7], v29
    ds_read_b128 v[8:11], v29 offset:16
    s_waitcnt lgkmcnt(1)
    v_and_b32 v12, v4, v20
    v_and_b32 v13, v4, v21
    v_and_b32 v14, v4, v22
    v_and_b32 v15, v4, v23
    v_and_b32 v16, v5, v20
    v_and_b32 v17, v5, v21
    v_and_b32 v18, v5, v22
    v_and_b32 v19, v5, v23
    buffer_load_dwordx4 v[80:83], v28, s[52:55], s48 offen
    s_add_u32 s48, s48, 65536
    s_waitcnt vmcnt(12)
    v_mfma_f32_16x16x32_bf16 v[24:27], v[32:35], v[12:15], 0
    v_and_b32 v12, v6, v20
    v_and_b32 v13, v6, v21
    v_and_b32 v14, v6, v22
    v_and_b32 v15, v6, v23
    buffer_load_dwordx4 v[84:87], v28, s[52:55], s48 offen
    s_add_u32 s48, s48, 65536
    s_waitcnt vmcnt(12)
    v_mfma_f32_16x16x32_bf16 v[24:27], v[36:39], v[16:19], v[24:27]
    v_and_b32 v16, v7, v20
    v_and_b32 v17, v7, v21
    v_and_b32 v18, v7, v22
    v_and_b32 v19, v7, v23
    ds_read_b128 v[4:7], v29 offset:32
    buffer_load_dwordx4 v[88:91], v28, s[52:55], s48 offen
    s_add_u32 s48, s48, 65536
    s_waitcnt vmcnt(12)
    v_mfma_f32_16x16x32_bf16 v[24:27], v[40:43], v[12:15], v[24:27]
    s_waitcnt lgkmcnt(1)
    v_and_b32 v12, v8, v20
    v_and_b32 v13, v8, v21
    v_and_b32 v14, v8, v22
    v_and_b32 v15, v8, v23
    buffer_load_dwordx4 v[92:95], v28, s[52:55], s48 offen
    s_add_u32 s48, s48, 65536
    s_cmp_ge_u32 s48, 3670016
    s_cselect_b32 s48, 0, s48
    s_waitcnt vmcnt(12)
    v_mfma_f32_16x16x32_bf16 v[24:27], v[44:47], v[16:19], v[24:27]
    v_and_b32 v16, v9, v20
    v_and_b32 v17, v9, v21
    v_and_b32 v18, v9, v22
    v_and_b32 v19, v9, v23
    buffer_load_dwordx4 v[96:99], v28, s[52:55], s48 offen
    s_add_u32 s48, s48, 65536
    s_waitcnt vmcnt(12)
    v_mfma_f32_16x16x32_bf16 v[24:27], v[48:51], v[12:15], v[24:27]
    v_and_b32 v12, v10, v20
    v_and_b32 v13, v10, v21
    v_and_b32 v14, v10, v22
    v_and_b32 v15, v10, v23
    buffer_load_dwordx4 v[100:103], v28, s[52:55], s48 offen
    s_add_u32 s48, s48, 65536
    s_waitcnt vmcnt(12)
    v_mfma_f32_16x16x32_bf16 v[24:27], v[52:55], v[16:19], v[24:27]
    v_and_b32 v16, v11, v20
    v_and_b32 v17, v11, v21
    v_and_b32 v18, v11, v22
    v_and_b32 v19, v11, v23
    ds_read_b128 v[8:11], v29 offset:48
    buffer_load_dwordx4 v[104:107], v28, s[52:55], s48 offen
    s_add_u32 s48, s48, 65536
    s_waitcnt vmcnt(12)
    v_mfma_f32_16x16x32_bf16 v[24:27], v[56:59], v[12:15], v[24:27]
    s_waitcnt lgkmcnt(1)
    v_and_b32 v12, v4, v20
    v_and_b32 v13, v4, v21
    v_and_b32 v14, v4, v22
    v_and_b32 v15, v4, v23
    buffer_load_dwordx4 v[108:111], v28, s[52:55], s48 offen
    s_add_u32 s48, s48, 65536
    s_cmp_ge_u32 s48, 3670016
    s_cselect_b32 s48, 0, s48
    s_waitcnt vmcnt(12)
    v_mfma_f32_16x16x32_bf16 v[24:27], v[60:63], v[16:19], v[24:27]
    v_and_b32 v16, v5, v20
    v_and_b32 v17, v5, v21
    v_and_b32 v18, v5, v22
    v_and_b32 v19, v5, v23
    buffer_load_dwordx4 v[112:115], v28, s[52:55], s48 offen
    s_add_u32 s48, s48, 65536
    s_waitcnt vmcnt(12)
    v_mfma_f32_16x16x32_bf16 v[24:27], v[64:67], v[12:15], v[24:27]
    v_and_b32 v12, v6, v20
    v_and_b32 v13, v6, v21
    v_and_b32 v14, v6, v22
    v_and_b32 v15, v6, v23
    buffer_load_dwordx4 v[116:119], v28, s[52:55], s48 offen
    s_add_u32 s48, s48, 65536
    s_waitcnt vmcnt(12)
    v_mfma_f32_16x16x32_bf16 v[24:27], v[68:71], v[16:19], v[24:27]
    v_and_b32 v16, v7, v20
    v_and_b32 v17, v7, v21
    v_and_b32 v18, v7, v22
    v_and_b32 v19, v7, v23
    ds_read_b128 v[4:7], v29 offset:64
    buffer_load_dwordx4 v[120:123], v28, s[52:55], s48 offen
    s_add_u32 s48, s48, 65536
    s_waitcnt vmcnt(12)
    v_mfma_f32_16x16x32_bf16 v[24:27], v[72:75], v[12:15], v[24:27]
    s_waitcnt lgkmcnt(1)
    v_and_b32 v12, v8, v20
    v_and_b32 v13, v8, v21
    v_and_b32 v14, v8, v22
    v_and_b32 v15, v8, v23
    buffer_load_dwordx4 v[124:127], v28, s[52:55], s48 offen
    s_add_u32 s48, s48, 65536
    s_cmp_ge_u32 s48, 3670016
    s_cselect_b32 s48, 0, s48
    s_waitcnt vmcnt(12)
    v_mfma_f32_16x16x32_bf16 v[24:27], v[76:79], v[16:19], v[24:27]
    v_and_b32 v16, v9, v20
    v_and_b32 v17, v9, v21
    v_and_b32 v18, v9, v22
    v_and_b32 v19, v9, v23
    buffer_load_dwordx4 v[128:131], v28, s[52:55], s48 offen
    s_add_u32 s48, s48, 65536
    s_waitcnt vmcnt(12)
    v_mfma_f32_16x16x32_bf16 v[24:27], v[80:83], v[12:15], v[24:27]
    v_and_b32 v12, v10, v20
    v_and_b32 v13, v10, v21
    v_and_b32 v14, v10, v22
    v_and_b32 v15, v10, v23
    buffer_load_dwordx4 v[132:135], v28, s[52:55], s48 offen
    s_add_u32 s48, s48, 65536
    s_waitcnt vmcnt(12)
    v_mfma_f32_16x16x32_bf16 v[24:27], v[84:87], v[16:19], v[24:27]
    v_and_b32 v16, v11, v20
    v_and_b32 v17, v11, v21
    v_and_b32 v18, v11, v22
    v_and_b32 v19, v11, v23
    ds_read_b128 v[8:11], v29 offset:80
    buffer_load_dwordx4 v[136:139], v28, s[52:55], s48 offen
    s_add_u32 s48, s48, 65536
    s_waitcnt vmcnt(12)
    v_mfma_f32_16x16x32_bf16 v[24:27], v[88:91], v[12:15], v[24:27]
    s_waitcnt lgkmcnt(1)
    v_and_b32 v12, v4, v20
    v_and_b32 v13, v4, v21
    v_and_b32 v14, v4, v22
    v_and_b32 v15, v4, v23
    buffer_load_dwordx4 v[140:143], v28, s[52:55], s48 offen
    s_add_u32 s48, s48, 65536
    s_cmp_ge_u32 s48, 3670016
    s_cselect_b32 s48, 0, s48
    s_waitcnt vmcnt(12)
    v_mfma_f32_16x16x32_bf16 v[24:27], v[92:95], v[16:19], v[24:27]
    v_and_b32 v16, v5, v20
    v_and_b32 v17, v5, v21
    v_and_b32 v18, v5, v22
    v_and_b32 v19, v5, v23
    buffer_load_dwordx4 v[144:147], v28, s[52:55], s48 offen
    s_add_u32 s48, s48, 65536
    s_waitcnt vmcnt(12)
    v_mfma_f32_16x16x32_bf16 v[24:27], v[96:99], v[12:15], v[24:27]
    v_and_b32 v12, v6, v20
    v_and_b32 v13, v6, v21
    v_and_b32 v14, v6, v22
    v_and_b32 v15, v6, v23
    buffer_load_dwordx4 v[148:151], v28, s[52:55], s48 offen
    s_add_u32 s48, s48, 65536
    s_waitcnt vmcnt(12)
    v_mfma_f32_16x16x32_bf16 v[24:27], v[100:103], v[16:19], v[24:27]
    v_and_b32 v16, v7, v20
    v_and_b32 v17, v7, v21
    v_and_b32 v18, v7, v22
    v_and_b32 v19, v7, v23
    ds_read_b128 v[4:7], v29 offset:96
    buffer_load_dwordx4 v[152:155], v28, s[52:55], s48 offen
    s_add_u32 s48, s48, 65536
    s_waitcnt vmcnt(12)
    v_mfma_f32_16x16x32_bf16 v[24:27], v[104:107], v[12:15], v[24:27]
    s_waitcnt lgkmcnt(1)
    v_and_b32 v12, v8, v20
    v_and_b32 v13, v8, v21
    v_and_b32 v14, v8, v22
    v_and_b32 v15, v8, v23
    buffer_load_dwordx4 v[156:159], v28, s[52:55], s48 offen
    s_add_u32 s48, s48, 65536
    s_cmp_ge_u32 s48, 3670016
    s_cselect_b32 s48, 0, s48
    s_waitcnt vmcnt(12)
    v_mfma_f32_16x16x32_bf16 v[24:27], v[108:111], v[16:19], v[24:27]
    v_and_b32 v16, v9, v20
    v_and_b32 v17, v9, v21
    v_and_b32 v18, v9, v22
    v_and_b32 v19, v9, v23
    buffer_load_dwordx4 v[160:163], v28, s[52:55], s48 offen
    s_add_u32 s48, s48, 65536
    s_waitcnt vmcnt(12)
    v_mfma_f32_16x16x32_bf16 v[24:27], v[112:115], v[12:15], v[24:27]
    v_and_b32 v12, v10, v20
    v_and_b32 v13, v10, v21
    v_and_b32 v14, v10, v22
    v_and_b32 v15, v10, v23
    buffer_load_dwordx4 v[164:167], v28, s[52:55], s48 offen
    s_add_u32 s48, s48, 65536
    s_waitcnt vmcnt(12)
    v_mfma_f32_16x16x32_bf16 v[24:27], v[116:119], v[16:19], v[24:27]
    v_and_b32 v16, v11, v20
    v_and_b32 v17, v11, v21
    v_and_b32 v18, v11, v22
    v_and_b32 v19, v11, v23
    ds_read_b128 v[8:11], v29 offset:112
    buffer_load_dwordx4 v[168:171], v28, s[52:55], s48 offen
    s_add_u32 s48, s48, 65536
    s_waitcnt vmcnt(12)
    v_mfma_f32_16x16x32_bf16 v[24:27], v[120:123], v[12:15], v[24:27]
    s_waitcnt lgkmcnt(1)
    v_and_b32 v12, v4, v20
    v_and_b32 v13, v4, v21
    v_and_b32 v14, v4, v22
    v_and_b32 v15, v4, v23
    buffer_load_dwordx4 v[172:175], v28, s[52:55], s48 offen
    s_add_u32 s48, s48, 65536
    s_cmp_ge_u32 s48, 3670016
    s_cselect_b32 s48, 0, s48
    s_waitcnt vmcnt(12)
    v_mfma_f32_16x16x32_bf16 v[24:27], v[124:127], v[16:19], v[24:27]
    v_and_b32 v16, v5, v20
    v_and_b32 v17, v5, v21
    v_and_b32 v18, v5, v22
    v_and_b32 v19, v5, v23
    buffer_load_dwordx4 v[176:179], v28, s[52:55], s48 offen
    s_add_u32 s48, s48, 65536
    s_waitcnt vmcnt(12)
    v_mfma_f32_16x16x32_bf16 v[24:27], v[128:131], v[12:15], v[24:27]
    v_and_b32 v12, v6, v20
    v_and_b32 v13, v6, v21
    v_and_b32 v14, v6, v22
    v_and_b32 v15, v6, v23
    buffer_load_dwordx4 v[180:183], v28, s[52:55], s48 offen
    s_add_u32 s48, s48, 65536
    s_waitcnt vmcnt(12)
    v_mfma_f32_16x16x32_bf16 v[24:27], v[132:135], v[16:19], v[24:27]
    v_and_b32 v16, v7, v20
    v_and_b32 v17, v7, v21
    v_and_b32 v18, v7, v22
    v_and_b32 v19, v7, v23
    ds_read_b128 v[4:7], v29 offset:128
    buffer_load_dwordx4 v[184:187], v28, s[52:55], s48 offen
    s_add_u32 s48, s48, 65536
    s_waitcnt vmcnt(12)
    v_mfma_f32_16x16x32_bf16 v[24:27], v[136:139], v[12:15], v[24:27]
    s_waitcnt lgkmcnt(1)
    v_and_b32 v12, v8, v20
    v_and_b32 v13, v8, v21
    v_and_b32 v14, v8, v22
    v_and_b32 v15, v8, v23
    buffer_load_dwordx4 v[188:191], v28, s[52:55], s48 offen
    s_add_u32 s48, s48, 65536
    s_cmp_ge_u32 s48, 3670016
    s_cselect_b32 s48, 0, s48
    s_waitcnt vmcnt(12)
    v_mfma_f32_16x16x32_bf16 v[24:27], v[140:143], v[16:19], v[24:27]
    v_and_b32 v16, v9, v20
    v_and_b32 v17, v9, v21
    v_and_b32 v18, v9, v22
    v_and_b32 v19, v9, v23
    buffer_load_dwordx4 v[192:195], v28, s[52:55], s48 offen
    s_add_u32 s48, s48, 65536
    s_waitcnt vmcnt(12)
    v_mfma_f32_16x16x32_bf16 v[24:27], v[144:147], v[12:15], v[24:27]
    v_and_b32 v12, v10, v20
    v_and_b32 v13, v10, v21
    v_and_b32 v14, v10, v22
    v_and_b32 v15, v10, v23
    buffer_load_dwordx4 v[196:199], v28, s[52:55], s48 offen
    s_add_u32 s48, s48, 65536
    s_waitcnt vmcnt(12)
    v_mfma_f32_16x16x32_bf16 v[24:27], v[148:151], v[16:19], v[24:27]
    v_and_b32 v16, v11, v20
    v_and_b32 v17, v11, v21
    v_and_b32 v18, v11, v22
    v_and_b32 v19, v11, v23
    ds_read_b128 v[8:11], v29 offset:144
    buffer_load_dwordx4 v[200:203], v28, s[52:55], s48 offen
    s_add_u32 s48, s48, 65536
    s_waitcnt vmcnt(12)
    v_mfma_f32_16x16x32_bf16 v[24:27], v[152:155], v[12:15], v[24:27]
    s_waitcnt lgkmcnt(1)
    v_and_b32 v12, v4, v20
    v_and_b32 v13, v4, v21
    v_and_b32 v14, v4, v22
    v_and_b32 v15, v4, v23
    buffer_load_dwordx4 v[204:207], v28, s[52:55], s48 offen
    s_add_u32 s48, s48, 65536
    s_cmp_ge_u32 s48, 3670016
    s_cselect_b32 s48, 0, s48
    s_waitcnt vmcnt(12)
    v_mfma_f32_16x16x32_bf16 v[24:27], v[156:159], v[16:19], v[24:27]
    v_and_b32 v16, v5, v20
    v_and_b32 v17, v5, v21
    v_and_b32 v18, v5, v22
    v_and_b32 v19, v5, v23
    buffer_load_dwordx4 v[208:211], v28, s[52:55], s48 offen
    s_add_u32 s48, s48, 65536
    s_waitcnt vmcnt(12)
    v_mfma_f32_16x16x32_bf16 v[24:27], v[160:163], v[12:15], v[24:27]
    v_and_b32 v12, v6, v20
    v_and_b32 v13, v6, v21
    v_and_b32 v14, v6, v22
    v_and_b32 v15, v6, v23
    buffer_load_dwordx4 v[212:215], v28, s[52:55], s48 offen
    s_add_u32 s48, s48, 65536
    s_waitcnt vmcnt(12)
    v_mfma_f32_16x16x32_bf16 v[24:27], v[164:167], v[16:19], v[24:27]
    v_and_b32 v16, v7, v20
    v_and_b32 v17, v7, v21
    v_and_b32 v18, v7, v22
    v_and_b32 v19, v7, v23
    ds_read_b128 v[4:7], v29 offset:160
    buffer_load_dwordx4 v[216:219], v28, s[52:55], s48 offen
    s_add_u32 s48, s48, 65536
    s_waitcnt vmcnt(12)
    v_mfma_f32_16x16x32_bf16 v[24:27], v[168:171], v[12:15], v[24:27]
    s_waitcnt lgkmcnt(1)
    v_and_b32 v12, v8, v20
    v_and_b32 v13, v8, v21
    v_and_b32 v14, v8, v22
    v_and_b32 v15, v8, v23
    buffer_load_dwordx4 v[220:223], v28, s[52:55], s48 offen
    s_add_u32 s48, s48, 65536
    s_cmp_ge_u32 s48, 3670016
    s_cselect_b32 s48, 0, s48
    s_waitcnt vmcnt(12)
    v_mfma_f32_16x16x32_bf16 v[24:27], v[172:175], v[16:19], v[24:27]
    v_and_b32 v16, v9, v20
    v_and_b32 v17, v9, v21
    v_and_b32 v18, v9, v22
    v_and_b32 v19, v9, v23
    buffer_load_dwordx4 v[224:227], v28, s[52:55], s48 offen
    s_add_u32 s48, s48, 65536
    s_waitcnt vmcnt(12)
    v_mfma_f32_16x16x32_bf16 v[24:27], v[176:179], v[12:15], v[24:27]
    v_and_b32 v12, v10, v20
    v_and_b32 v13, v10, v21
    v_and_b32 v14, v10, v22
    v_and_b32 v15, v10, v23
    buffer_load_dwordx4 v[228:231], v28, s[52:55], s48 offen
    s_add_u32 s48, s48, 65536
    s_waitcnt vmcnt(12)
    v_mfma_f32_16x16x32_bf16 v[24:27], v[180:183], v[16:19], v[24:27]
    v_and_b32 v16, v11, v20
    v_and_b32 v17, v11, v21
    v_and_b32 v18, v11, v22
    v_and_b32 v19, v11, v23
    ds_read_b128 v[8:11], v29 offset:176
    buffer_load_dwordx4 v[232:235], v28, s[52:55], s48 offen
    s_add_u32 s48, s48, 65536
    s_waitcnt vmcnt(12)
    v_mfma_f32_16x16x32_bf16 v[24:27], v[184:187], v[12:15], v[24:27]
    s_waitcnt lgkmcnt(1)
    v_and_b32 v12, v4, v20
    v_and_b32 v13, v4, v21
    v_and_b32 v14, v4, v22
    v_and_b32 v15, v4, v23
    buffer_load_dwordx4 v[236:239], v28, s[52:55], s48 offen
    s_add_u32 s48, s48, 65536
    s_cmp_ge_u32 s48, 3670016
    s_cselect_b32 s48, 0, s48
    s_waitcnt vmcnt(12)
    v_mfma_f32_16x16x32_bf16 v[24:27], v[188:191], v[16:19], v[24:27]
    v_and_b32 v16, v5, v20
    v_and_b32 v17, v5, v21
    v_and_b32 v18, v5, v22
    v_and_b32 v19, v5, v23
    buffer_load_dwordx4 v[240:243], v28, s[52:55], s48 offen
    s_add_u32 s48, s48, 65536
    s_waitcnt vmcnt(12)
    v_mfma_f32_16x16x32_bf16 v[24:27], v[192:195], v[12:15], v[24:27]
    v_and_b32 v12, v6, v20
    v_and_b32 v13, v6, v21
    v_and_b32 v14, v6, v22
    v_and_b32 v15, v6, v23
    buffer_load_dwordx4 v[244:247], v28, s[52:55], s48 offen
    s_add_u32 s48, s48, 65536
    s_waitcnt vmcnt(12)
    v_mfma_f32_16x16x32_bf16 v[24:27], v[196:199], v[16:19], v[24:27]
    v_and_b32 v16, v7, v20
    v_and_b32 v17, v7, v21
    v_and_b32 v18, v7, v22
    v_and_b32 v19, v7, v23
    ds_read_b128 v[4:7], v29 offset:192
    buffer_load_dwordx4 v[248:251], v28, s[52:55], s48 offen
    s_add_u32 s48, s48, 65536
    s_waitcnt vmcnt(12)
    v_mfma_f32_16x16x32_bf16 v[24:27], v[200:203], v[12:15], v[24:27]
    s_waitcnt lgkmcnt(1)
    v_and_b32 v12, v8, v20
    v_and_b32 v13, v8, v21
    v_and_b32 v14, v8, v22
    v_and_b32 v15, v8, v23
    buffer_load_dwordx4 v[252:255], v28, s[52:55], s48 offen
    s_add_u32 s48, s48, 65536
    s_waitcnt vmcnt(12)
    v_mfma_f32_16x16x32_bf16 v[24:27], v[204:207], v[16:19], v[24:27]
    v_and_b32 v16, v9, v20
    v_and_b32 v17, v9, v21
    v_and_b32 v18, v9, v22
    v_and_b32 v19, v9, v23
    s_waitcnt vmcnt(11)
    v_mfma_f32_16x16x32_bf16 v[24:27], v[208:211], v[12:15], v[24:27]
    v_and_b32 v12, v10, v20
    v_and_b32 v13, v10, v21
    v_and_b32 v14, v10, v22
    v_and_b32 v15, v10, v23
    s_waitcnt vmcnt(10)
    v_mfma_f32_16x16x32_bf16 v[24:27], v[212:215], v[16:19], v[24:27]
    v_and_b32 v16, v11, v20
    v_and_b32 v17, v11, v21
    v_and_b32 v18, v11, v22
    v_and_b32 v19, v11, v23
    ds_read_b128 v[8:11], v29 offset:208
    s_waitcnt vmcnt(9)
    v_mfma_f32_16x16x32_bf16 v[24:27], v[216:219], v[12:15], v[24:27]
    s_waitcnt lgkmcnt(1)
    v_and_b32 v12, v4, v20
    v_and_b32 v13, v4, v21
    v_and_b32 v14, v4, v22
    v_and_b32 v15, v4, v23
    s_waitcnt vmcnt(8)
    v_mfma_f32_16x16x32_bf16 v[24:27], v[220:223], v[16:19], v[24:27]
    v_and_b32 v16, v5, v20
    v_and_b32 v17, v5, v21
    v_and_b32 v18, v5, v22
    v_and_b32 v19, v5, v23
    s_waitcnt vmcnt(7)
    v_mfma_f32_16x16x32_bf16 v[24:27], v[224:227], v[12:15], v[24:27]
    v_and_b32 v12, v6, v20
    v_and_b32 v13, v6, v21
    v_and_b32 v14, v6, v22
    v_and_b32 v15, v6, v23
    s_waitcnt vmcnt(6)
    v_mfma_f32_16x16x32_bf16 v[24:27], v[228:231], v[16:19], v[24:27]
    v_and_b32 v16, v7, v20
    v_and_b32 v17, v7, v21
    v_and_b32 v18, v7, v22
    v_and_b32 v19, v7, v23
    s_waitcnt vmcnt(5)
    v_mfma_f32_16x16x32_bf16 v[24:27], v[232:235], v[12:15], v[24:27]
    s_waitcnt lgkmcnt(0)
    v_and_b32 v12, v8, v20
    v_and_b32 v13, v8, v21
    v_and_b32 v14, v8, v22
    v_and_b32 v15, v8, v23
    s_waitcnt vmcnt(4)
    v_mfma_f32_16x16x32_bf16 v[24:27], v[236:239], v[16:19], v[24:27]
    v_and_b32 v16, v9, v20
    v_and_b32 v17, v9, v21
    v_and_b32 v18, v9, v22
    v_and_b32 v19, v9, v23
    s_waitcnt vmcnt(3)
    v_mfma_f32_16x16x32_bf16 v[24:27], v[240:243], v[12:15], v[24:27]
    v_and_b32 v12, v10, v20
    v_and_b32 v13, v10, v21
    v_and_b32 v14, v10, v22
    v_and_b32 v15, v10, v23
    s_waitcnt vmcnt(2)
    v_mfma_f32_16x16x32_bf16 v[24:27], v[244:247], v[16:19], v[24:27]
    v_and_b32 v16, v11, v20
    v_and_b32 v17, v11, v21
    v_and_b32 v18, v11, v22
    v_and_b32 v19, v11, v23
    s_waitcnt vmcnt(1)
    v_mfma_f32_16x16x32_bf16 v[24:27], v[248:251], v[12:15], v[24:27]
    s_nop 0
    s_waitcnt vmcnt(0)
    v_mfma_f32_16x16x32_bf16 v[24:27], v[252:255], v[16:19], v[24:27]
    s_nop 7
    v_permlane32_swap_b32 v24, v25
    v_permlane32_swap_b32 v26, v27
    s_nop 1
    v_add_f32_dpp v12, v25, v24 row_ror:8 row_mask:0xf bank_mask:0xf
    v_add_f32_dpp v13, v27, v26 row_ror:8 row_mask:0xf bank_mask:0xf
L_q2:
    v_cvt_pk_bf16_f32 v12, v12, v13
    v_bfe_u32 v4, v0, 4, 1
    v_lshrrev_b32 v5, 5, v0
    v_lshl_add_u32 v4, v4, 2, v5
    v_lshlrev_b32 v4, 4, v4
    v_lshl_add_u32 v4, v3, 1, v4
    s_sub_u32 s47, s3, 1
    s_lshl_b32 s47, s47, 7
    v_add_u32 v4, s47, v4
    s_mov_b64 exec, s[60:61]
    ds_write_b16 v4, v12 offset:0
    ds_write_b16_d16_hi v4, v12 offset:32
    s_mov_b64 exec, -1
    s_waitcnt lgkmcnt(0)
    s_barrier
    s_lshl_b32 s47, s33, 12
    s_add_u32 s36, s24, s47
    s_addc_u32 s37, s25, 0
    s_mov_b32 s38, 4096
    s_mov_b32 s39, 0x20000
    s_lshl_b32 s47, s30, 17
    s_add_u32 s40, s24, s47
    s_addc_u32 s41, s25, 0
    s_mov_b32 s42, 131072
    s_mov_b32 s43, 0x20000
    s_mov_b32 s56, s22
    s_mov_b32 s57, s23
    s_mov_b32 s58, 256
    s_mov_b32 s59, 0x20000
    s_cmp_lg_u32 s3, 1
    s_cbranch_scc1 L_wo
    s_cmp_lg_u32 s28, 1
    s_cbranch_scc1 L_wo
    s_xor_b32 s47, s30, s26
    s_and_b32 s48, s47, 1
    s_cbranch_scc1 L_wo
    s_bfe_u32 s50, s47, 0x10001
    s_lshr_b32 s47, s47, 2
    s_lshl_b32 s47, s47, 4
    s_add_u32 s51, s31, s47
    s_cmp_ge_u32 s51, 28
    s_cbranch_scc1 L_wo
    s_mul_i32 s62, s51, 37
    s_lshr_b32 s62, s62, 8
    s_mul_i32 s63, s62, 7
    s_sub_u32 s63, s51, s63
    s_cmp_eq_u32 s50, 1
    s_cbranch_scc1 L_f1a
    s_lshl_b32 s48, s51, 7
    s_sub_u32 s49, 1605632, s48
    s_add_u32 s52, s16, s48
    s_addc_u32 s53, s17, 0
    s_mov_b32 s54, s49
    s_mov_b32 s55, 0x20000
    s_mov_b32 s46, 3584
    s_mov_b32 s88, s4
    s_mov_b32 s89, s5
    s_mov_b32 s90, 7168
    s_mov_b32 s91, 0x20000
    v_add_u32 v5, 18304, v1
    v_cmp_gt_u32 vcc, 56, v0
    v_mov_b32 v6, 0x10000
    s_nop 0
    v_cndmask_b32 v6, v6, v1, vcc
    buffer_load_dwordx4 v[224:227], v6, s[88:91], 0 offen offset:0
    buffer_load_dwordx4 v[228:231], v6, s[88:91], 0 offen offset:896
    buffer_load_dwordx4 v[232:235], v6, s[88:91], 0 offen offset:1792
    buffer_load_dwordx4 v[236:239], v6, s[88:91], 0 offen offset:2688
    buffer_load_dwordx4 v[240:243], v6, s[88:91], 0 offen offset:3584
    buffer_load_dwordx4 v[244:247], v6, s[88:91], s46 offen offset:896
    buffer_load_dwordx4 v[248:251], v6, s[88:91], s46 offen offset:1792
    buffer_load_dwordx4 v[252:255], v6, s[88:91], s46 offen offset:2688
    s_branch L_f1b
L_f1a:
    s_mul_i32 s48, s62, 401408
    s_lshl_b32 s49, s63, 7
    s_add_u32 s48, s48, s49
    s_sub_u32 s49, 1605632, s48
    s_add_u32 s52, s18, s48
    s_addc_u32 s53, s19, 0
    s_mov_b32 s54, s49
    s_mov_b32 s55, 0x20000
    s_mov_b32 s46, 896
L_f1b:
    v_mul_u32_u24 v28, s46, v2
    v_lshl_add_u32 v28, v3, 4, v28
    s_lshl_b32 s46, s46, 3
    s_mov_b32 s48, 0
    buffer_load_dwordx4 v[32:35], v28, s[52:55], s48 offen nt
    s_add_u32 s48, s48, s46
    buffer_load_dwordx4 v[36:39], v28, s[52:55], s48 offen nt
    s_add_u32 s48, s48, s46
    buffer_load_dwordx4 v[40:43], v28, s[52:55], s48 offen nt
    s_add_u32 s48, s48, s46
    buffer_load_dwordx4 v[44:47], v28, s[52:55], s48 offen nt
    s_add_u32 s48, s48, s46
    buffer_load_dwordx4 v[48:51], v28, s[52:55], s48 offen nt
    s_add_u32 s48, s48, s46
    buffer_load_dwordx4 v[52:55], v28, s[52:55], s48 offen nt
    s_add_u32 s48, s48, s46
    buffer_load_dwordx4 v[56:59], v28, s[52:55], s48 offen nt
    s_add_u32 s48, s48, s46
    buffer_load_dwordx4 v[60:63], v28, s[52:55], s48 offen nt
    s_add_u32 s48, s48, s46
    s_cmp_eq_u32 s50, 1
    s_cbranch_scc1 L_f2
    s_waitcnt vmcnt(8)
    ds_write_b128 v5, v[224:227] offset:0
    ds_write_b128 v5, v[228:231] offset:1040
    ds_write_b128 v5, v[232:235] offset:2080
    ds_write_b128 v5, v[236:239] offset:3120
    ds_write_b128 v5, v[240:243] offset:4160
    ds_write_b128 v5, v[244:247] offset:5200
    ds_write_b128 v5, v[248:251] offset:6240
    ds_write_b128 v5, v[252:255] offset:7280
    s_mov_b32 s49, 8
L_ln8:
    s_waitcnt lgkmcnt(0)
    ds_read_b128 v[20:23], v5
    s_waitcnt lgkmcnt(0)
    v_lshlrev_b32 v8, 16, v20
    v_and_b32 v9, 0xffff0000, v20
    v_lshlrev_b32 v10, 16, v21
    v_and_b32 v11, 0xffff0000, v21
    v_lshlrev_b32 v12, 16, v22
    v_and_b32 v13, 0xffff0000, v22
    v_lshlrev_b32 v14, 16, v23
    v_and_b32 v15, 0xffff0000, v23
    v_add_f32 v16, v8, v9
    v_add_f32 v17, v10, v11
    v_add_f32 v18, v12, v13
    v_add_f32 v19, v14, v15
    v_add_f32 v16, v16, v17
    v_add_f32 v18, v18, v19
    v_add_f32 v16, v16, v18
    s_nop 1
    v_add_f32_dpp v16, v16, v16 quad_perm:[1,0,3,2] row_mask:0xf bank_mask:0xf
    s_nop 1
    v_add_f32_dpp v16, v16, v16 quad_perm:[2,3,0,1] row_mask:0xf bank_mask:0xf
    s_nop 1
    v_add_f32_dpp v16, v16, v16 row_half_mirror row_mask:0xf bank_mask:0xf
    s_nop 1
    v_add_f32_dpp v16, v16, v16 row_mirror row_mask:0xf bank_mask:0xf
    v_mov_b32 v17, v16
    s_nop 1
    v_permlane16_swap_b32 v16, v17
    v_add_f32 v16, v16, v17
    v_mov_b32 v17, v16
    s_nop 1
    v_permlane32_swap_b32 v16, v17
    v_add_f32 v16, v16, v17
    v_mul_f32 v16, 0x3b124925, v16
    v_cmp_gt_u32 vcc, 56, v0
    v_cvt_pk_bf16_f32 v17, 0, v16
    s_nop 0
    v_cndmask_b32 v16, 0, v16, vcc
    v_sub_f32 v4, v8, v16
    v_mul_f32 v18, v4, v4
    v_sub_f32 v4, v9, v16
    v_fmac_f32 v18, v4, v4
    v_sub_f32 v4, v10, v16
    v_fmac_f32 v18, v4, v4
    v_sub_f32 v4, v11, v16
    v_fmac_f32 v18, v4, v4
    v_sub_f32 v4, v12, v16
    v_fmac_f32 v18, v4, v4
    v_sub_f32 v4, v13, v16
    v_fmac_f32 v18, v4, v4
    v_sub_f32 v4, v14, v16
    v_fmac_f32 v18, v4, v4
    v_sub_f32 v4, v15, v16
    v_fmac_f32 v18, v4, v4
    s_nop 1
    v_add_f32_dpp v18, v18, v18 quad_perm:[1,0,3,2] row_mask:0xf bank_mask:0xf
    s_nop 1
    v_add_f32_dpp v18, v18, v18 quad_perm:[2,3,0,1] row_mask:0xf bank_mask:0xf
    s_nop 1
    v_add_f32_dpp v18, v18, v18 row_half_mirror row_mask:0xf bank_mask:0xf
    s_nop 1
    v_add_f32_dpp v18, v18, v18 row_mirror row_mask:0xf bank_mask:0xf
    v_mov_b32 v19, v18
    s_nop 1
    v_permlane16_swap_b32 v18, v19
    v_add_f32 v18, v18, v19
    v_mov_b32 v19, v18
    s_nop 1
    v_permlane32_swap_b32 v18, v19
    v_add_f32 v18, v18, v19
    v_mul_f32 v18, 0x3b124925, v18
    v_cvt_pk_bf16_f32 v18, 0, v18
    v_add_f32 v18, 0x3727c5ac, v18
    v_cvt_pk_bf16_f32 v18, 0, v18
    v_sqrt_f32 v18, v18
    s_nop 0
    v_cvt_pk_bf16_f32 v18, 0, v18
    v_rcp_f32 v19, v18
    v_sub_f32 v8, v8, v17
    v_cvt_pk_bf16_f32 v8, 0, v8
    v_mul_f32 v4, v8, v19
    v_fma_f32 v6, -v4, v18, v8
    v_fma_f32 v8, v6, v19, v4
    v_sub_f32 v9, v9, v17
    v_cvt_pk_bf16_f32 v9, 0, v9
    v_mul_f32 v4, v9, v19
    v_fma_f32 v6, -v4, v18, v9
    v_fma_f32 v9, v6, v19, v4
    v_sub_f32 v10, v10, v17
    v_cvt_pk_bf16_f32 v10, 0, v10
    v_mul_f32 v4, v10, v19
    v_fma_f32 v6, -v4, v18, v10
    v_fma_f32 v10, v6, v19, v4
    v_sub_f32 v11, v11, v17
    v_cvt_pk_bf16_f32 v11, 0, v11
    v_mul_f32 v4, v11, v19
    v_fma_f32 v6, -v4, v18, v11
    v_fma_f32 v11, v6, v19, v4
    v_sub_f32 v12, v12, v17
    v_cvt_pk_bf16_f32 v12, 0, v12
    v_mul_f32 v4, v12, v19
    v_fma_f32 v6, -v4, v18, v12
    v_fma_f32 v12, v6, v19, v4
    v_sub_f32 v13, v13, v17
    v_cvt_pk_bf16_f32 v13, 0, v13
    v_mul_f32 v4, v13, v19
    v_fma_f32 v6, -v4, v18, v13
    v_fma_f32 v13, v6, v19, v4
    v_sub_f32 v14, v14, v17
    v_cvt_pk_bf16_f32 v14, 0, v14
    v_mul_f32 v4, v14, v19
    v_fma_f32 v6, -v4, v18, v14
    v_fma_f32 v14, v6, v19, v4
    v_sub_f32 v15, v15, v17
    v_cvt_pk_bf16_f32 v15, 0, v15
    v_mul_f32 v4, v15, v19
    v_fma_f32 v6, -v4, v18, v15
    v_fma_f32 v15, v6, v19, v4
    v_cvt_pk_bf16_f32 v8, v8, v9
    v_cvt_pk_bf16_f32 v9, v10, v11
    v_cvt_pk_bf16_f32 v10, v12, v13
    v_cvt_pk_bf16_f32 v11, v14, v15
    ds_write_b128 v5, v[8:11]
    v_add_u32 v5, 1040, v5
    s_sub_u32 s49, s49, 1
    s_cmp_lg_u32 s49, 0
    s_cbranch_scc1 L_ln8
L_f2:
    s_waitcnt vmcnt(7)
    buffer_load_dwordx4 v[64:67], v28, s[52:55], s48 offen nt
    s_add_u32 s48, s48, s46
    s_waitcnt vmcnt(7)
    buffer_load_dwordx4 v[68:71], v28, s[52:55], s48 offen nt
    s_add_u32 s48, s48, s46
    s_waitcnt vmcnt(7)
    buffer_load_dwordx4 v[72:75], v28, s[52:55], s48 offen nt
    s_add_u32 s48, s48, s46
    s_waitcnt vmcnt(7)
    buffer_load_dwordx4 v[76:79], v28, s[52:55], s48 offen nt
    s_add_u32 s48, s48, s46
    s_waitcnt vmcnt(7)
    buffer_load_dwordx4 v[80:83], v28, s[52:55], s48 offen nt
    s_add_u32 s48, s48, s46
    s_waitcnt vmcnt(7)
    buffer_load_dwordx4 v[84:87], v28, s[52:55], s48 offen nt
    s_add_u32 s48, s48, s46
    s_waitcnt vmcnt(7)
    buffer_load_dwordx4 v[88:91], v28, s[52:55], s48 offen nt
    s_add_u32 s48, s48, s46
    s_waitcnt vmcnt(7)
    buffer_load_dwordx4 v[92:95], v28, s[52:55], s48 offen nt
    s_add_u32 s48, s48, s46
    s_waitcnt vmcnt(7)
    buffer_load_dwordx4 v[96:99], v28, s[52:55], s48 offen nt
    s_add_u32 s48, s48, s46
    s_waitcnt vmcnt(7)
    buffer_load_dwordx4 v[100:103], v28, s[52:55], s48 offen nt
    s_add_u32 s48, s48, s46
    s_waitcnt vmcnt(7)
    buffer_load_dwordx4 v[104:107], v28, s[52:55], s48 offen nt
    s_add_u32 s48, s48, s46
    s_waitcnt vmcnt(7)
    buffer_load_dwordx4 v[108:111], v28, s[52:55], s48 offen nt
    s_add_u32 s48, s48, s46
    s_waitcnt vmcnt(7)
    buffer_load_dwordx4 v[112:115], v28, s[52:55], s48 offen nt
    s_add_u32 s48, s48, s46
    s_waitcnt vmcnt(7)
    buffer_load_dwordx4 v[116:119], v28, s[52:55], s48 offen nt
    s_add_u32 s48, s48, s46
    s_waitcnt vmcnt(7)
    buffer_load_dwordx4 v[120:123], v28, s[52:55], s48 offen nt
    s_add_u32 s48, s48, s46
    s_waitcnt vmcnt(7)
    buffer_load_dwordx4 v[124:127], v28, s[52:55], s48 offen nt
    s_add_u32 s48, s48, s46
    s_waitcnt vmcnt(7)
    buffer_load_dwordx4 v[128:131], v28, s[52:55], s48 offen nt
    s_add_u32 s48, s48, s46
    s_waitcnt vmcnt(7)
    buffer_load_dwordx4 v[132:135], v28, s[52:55], s48 offen nt
    s_add_u32 s48, s48, s46
    s_waitcnt vmcnt(7)
    buffer_load_dwordx4 v[136:139], v28, s[52:55], s48 offen nt
    s_add_u32 s48, s48, s46
    s_waitcnt vmcnt(7)
    buffer_load_dwordx4 v[140:143], v28, s[52:55], s48 offen nt
    s_add_u32 s48, s48, s46
    s_waitcnt vmcnt(7)
    buffer_load_dwordx4 v[144:147], v28, s[52:55], s48 offen nt
    s_add_u32 s48, s48, s46
    s_waitcnt vmcnt(7)
    buffer_load_dwordx4 v[148:151], v28, s[52:55], s48 offen nt
    s_add_u32 s48, s48, s46
    s_waitcnt vmcnt(7)
    buffer_load_dwordx4 v[152:155], v28, s[52:55], s48 offen nt
    s_add_u32 s48, s48, s46
    s_waitcnt vmcnt(7)
    buffer_load_dwordx4 v[156:159], v28, s[52:55], s48 offen nt
    s_add_u32 s48, s48, s46
    s_waitcnt vmcnt(7)
    buffer_load_dwordx4 v[160:163], v28, s[52:55], s48 offen nt
    s_add_u32 s48, s48, s46
    s_waitcnt vmcnt(7)
    buffer_load_dwordx4 v[164:167], v28, s[52:55], s48 offen nt
    s_add_u32 s48, s48, s46
    s_waitcnt vmcnt(7)
    buffer_load_dwordx4 v[168:171], v28, s[52:55], s48 offen nt
    s_add_u32 s48, s48, s46
    s_waitcnt vmcnt(7)
    buffer_load_dwordx4 v[172:175], v28, s[52:55], s48 offen nt
    s_add_u32 s48, s48, s46
    s_waitcnt vmcnt(7)
    buffer_load_dwordx4 v[176:179], v28, s[52:55], s48 offen nt
    s_add_u32 s48, s48, s46
    s_waitcnt vmcnt(7)
    buffer_load_dwordx4 v[180:183], v28, s[52:55], s48 offen nt
    s_add_u32 s48, s48, s46
    s_waitcnt vmcnt(7)
    buffer_load_dwordx4 v[184:187], v28, s[52:55], s48 offen nt
    s_add_u32 s48, s48, s46
    s_waitcnt vmcnt(7)
    buffer_load_dwordx4 v[188:191], v28, s[52:55], s48 offen nt
    s_add_u32 s48, s48, s46
    s_waitcnt vmcnt(7)
    buffer_load_dwordx4 v[192:195], v28, s[52:55], s48 offen nt
    s_add_u32 s48, s48, s46
    s_waitcnt vmcnt(7)
    buffer_load_dwordx4 v[196:199], v28, s[52:55], s48 offen nt
    s_add_u32 s48, s48, s46
    s_waitcnt vmcnt(7)
    buffer_load_dwordx4 v[200:203], v28, s[52:55], s48 offen nt
    s_add_u32 s48, s48, s46
    s_waitcnt vmcnt(7)
    buffer_load_dwordx4 v[204:207], v28, s[52:55], s48 offen nt
    s_add_u32 s48, s48, s46
    s_waitcnt vmcnt(7)
    buffer_load_dwordx4 v[208:211], v28, s[52:55], s48 offen nt
    s_add_u32 s48, s48, s46
    s_waitcnt vmcnt(7)
    buffer_load_dwordx4 v[212:215], v28, s[52:55], s48 offen nt
    s_add_u32 s48, s48, s46
    s_waitcnt vmcnt(7)
    buffer_load_dwordx4 v[216:219], v28, s[52:55], s48 offen nt
    s_add_u32 s48, s48, s46
    s_waitcnt vmcnt(7)
    buffer_load_dwordx4 v[220:223], v28, s[52:55], s48 offen nt
    s_add_u32 s48, s48, s46
    s_waitcnt vmcnt(7)
    buffer_load_dwordx4 v[224:227], v28, s[52:55], s48 offen nt
    s_add_u32 s48, s48, s46
    s_waitcnt vmcnt(7)
    buffer_load_dwordx4 v[228:231], v28, s[52:55], s48 offen nt
    s_add_u32 s48, s48, s46
    s_waitcnt vmcnt(7)
    buffer_load_dwordx4 v[232:235], v28, s[52:55], s48 offen nt
    s_add_u32 s48, s48, s46
    s_waitcnt vmcnt(7)
    buffer_load_dwordx4 v[236:239], v28, s[52:55], s48 offen nt
    s_add_u32 s48, s48, s46
    s_waitcnt vmcnt(7)
    buffer_load_dwordx4 v[240:243], v28, s[52:55], s48 offen nt
    s_add_u32 s48, s48, s46
    s_waitcnt vmcnt(7)
    buffer_load_dwordx4 v[244:247], v28, s[52:55], s48 offen nt
    s_add_u32 s48, s48, s46
    s_waitcnt vmcnt(7)
    buffer_load_dwordx4 v[248:251], v28, s[52:55], s48 offen nt
    s_add_u32 s48, s48, s46
    s_waitcnt vmcnt(7)
    buffer_load_dwordx4 v[252:255], v28, s[52:55], s48 offen nt
    s_add_u32 s48, s48, s46
    s_waitcnt vmcnt(0)
    s_sub_u32 s47, s3, 1
    s_mul_i32 s47, s47, 8448
    s_add_u32 s47, s47, 27776
    v_lshl_add_u32 v28, v0, 4, s47
    v_bfe_u32 v29, v0, 2, 2
    v_lshlrev_b32 v29, 7, v29
    v_lshrrev_b32 v31, 4, v0
    v_mul_u32_u24 v31, 1056, v31
    v_add3_u32 v29, v29, v31, s47
    v_and_b32 v31, 3, v0
    v_lshl_add_u32 v29, v31, 3, v29
    ds_write_b128 v28, v[32:35] offset:0
    ds_write_b128 v28, v[36:39] offset:1056
    ds_write_b128 v28, v[40:43] offset:2112
    ds_write_b128 v28, v[44:47] offset:3168
    s_waitcnt lgkmcnt(0)
    ds_read_b64_tr_b16 v[32:33], v29 offset:0
    ds_read_b64_tr_b16 v[34:35], v29 offset:512
    ds_read_b64_tr_b16 v[36:37], v29 offset:32
    ds_read_b64_tr_b16 v[38:39], v29 offset:544
    ds_read_b64_tr_b16 v[40:41], v29 offset:64
    ds_read_b64_tr_b16 v[42:43], v29 offset:576
    ds_read_b64_tr_b16 v[44:45], v29 offset:96
    ds_read_b64_tr_b16 v[46:47], v29 offset:608
    s_waitcnt lgkmcnt(0)
    ds_write_b128 v28, v[48:51] offset:0
    ds_write_b128 v28, v[52:55] offset:1056
    ds_write_b128 v28, v[56:59] offset:2112
    ds_write_b128 v28, v[60:63] offset:3168
    s_waitcnt lgkmcnt(0)
    ds_read_b64_tr_b16 v[48:49], v29 offset:0
    ds_read_b64_tr_b16 v[50:51], v29 offset:512
    ds_read_b64_tr_b16 v[52:53], v29 offset:32
    ds_read_b64_tr_b16 v[54:55], v29 offset:544
    ds_read_b64_tr_b16 v[56:57], v29 offset:64
    ds_read_b64_tr_b16 v[58:59], v29 offset:576
    ds_read_b64_tr_b16 v[60:61], v29 offset:96
    ds_read_b64_tr_b16 v[62:63], v29 offset:608
    s_waitcnt lgkmcnt(0)
    ds_write_b128 v28, v[64:67] offset:0
    ds_write_b128 v28, v[68:71] offset:1056
    ds_write_b128 v28, v[72:75] offset:2112
    ds_write_b128 v28, v[76:79] offset:3168
    s_waitcnt lgkmcnt(0)
    ds_read_b64_tr_b16 v[64:65], v29 offset:0
    ds_read_b64_tr_b16 v[66:67], v29 offset:512
    ds_read_b64_tr_b16 v[68:69], v29 offset:32
    ds_read_b64_tr_b16 v[70:71], v29 offset:544
    ds_read_b64_tr_b16 v[72:73], v29 offset:64
    ds_read_b64_tr_b16 v[74:75], v29 offset:576
    ds_read_b64_tr_b16 v[76:77], v29 offset:96
    ds_read_b64_tr_b16 v[78:79], v29 offset:608
    s_waitcnt lgkmcnt(0)
    ds_write_b128 v28, v[80:83] offset:0
    ds_write_b128 v28, v[84:87] offset:1056
    ds_write_b128 v28, v[88:91] offset:2112
    ds_write_b128 v28, v[92:95] offset:3168
    s_waitcnt lgkmcnt(0)
    ds_read_b64_tr_b16 v[80:81], v29 offset:0
    ds_read_b64_tr_b16 v[82:83], v29 offset:512
    ds_read_b64_tr_b16 v[84:85], v29 offset:32
    ds_read_b64_tr_b16 v[86:87], v29 offset:544
    ds_read_b64_tr_b16 v[88:89], v29 offset:64
    ds_read_b64_tr_b16 v[90:91], v29 offset:576
    ds_read_b64_tr_b16 v[92:93], v29 offset:96
    ds_read_b64_tr_b16 v[94:95], v29 offset:608
    s_waitcnt lgkmcnt(0)
    ds_write_b128 v28, v[96:99] offset:0
    ds_write_b128 v28, v[100:103] offset:1056
    ds_write_b128 v28, v[104:107] offset:2112
    ds_write_b128 v28, v[108:111] offset:3168
    s_waitcnt lgkmcnt(0)
    ds_read_b64_tr_b16 v[96:97], v29 offset:0
    ds_read_b64_tr_b16 v[98:99], v29 offset:512
    ds_read_b64_tr_b16 v[100:101], v29 offset:32
    ds_read_b64_tr_b16 v[102:103], v29 offset:544
    ds_read_b64_tr_b16 v[104:105], v29 offset:64
    ds_read_b64_tr_b16 v[106:107], v29 offset:576
    ds_read_b64_tr_b16 v[108:109], v29 offset:96
    ds_read_b64_tr_b16 v[110:111], v29 offset:608
    s_waitcnt lgkmcnt(0)
    ds_write_b128 v28, v[112:115] offset:0
    ds_write_b128 v28, v[116:119] offset:1056
    ds_write_b128 v28, v[120:123] offset:2112
    ds_write_b128 v28, v[124:127] offset:3168
    s_waitcnt lgkmcnt(0)
    ds_read_b64_tr_b16 v[112:113], v29 offset:0
    ds_read_b64_tr_b16 v[114:115], v29 offset:512
    ds_read_b64_tr_b16 v[116:117], v29 offset:32
    ds_read_b64_tr_b16 v[118:119], v29 offset:544
    ds_read_b64_tr_b16 v[120:121], v29 offset:64
    ds_read_b64_tr_b16 v[122:123], v29 offset:576
    ds_read_b64_tr_b16 v[124:125], v29 offset:96
    ds_read_b64_tr_b16 v[126:127], v29 offset:608
    s_waitcnt lgkmcnt(0)
    ds_write_b128 v28, v[128:131] offset:0
    ds_write_b128 v28, v[132:135] offset:1056
    ds_write_b128 v28, v[136:139] offset:2112
    ds_write_b128 v28, v[140:143] offset:3168
    s_waitcnt lgkmcnt(0)
    ds_read_b64_tr_b16 v[128:129], v29 offset:0
    ds_read_b64_tr_b16 v[130:131], v29 offset:512
    ds_read_b64_tr_b16 v[132:133], v29 offset:32
    ds_read_b64_tr_b16 v[134:135], v29 offset:544
    ds_read_b64_tr_b16 v[136:137], v29 offset:64
    ds_read_b64_tr_b16 v[138:139], v29 offset:576
    ds_read_b64_tr_b16 v[140:141], v29 offset:96
    ds_read_b64_tr_b16 v[142:143], v29 offset:608
    s_waitcnt lgkmcnt(0)
    ds_write_b128 v28, v[144:147] offset:0
    ds_write_b128 v28, v[148:151] offset:1056
    ds_write_b128 v28, v[152:155] offset:2112
    ds_write_b128 v28, v[156:159] offset:3168
    s_waitcnt lgkmcnt(0)
    ds_read_b64_tr_b16 v[144:145], v29 offset:0
    ds_read_b64_tr_b16 v[146:147], v29 offset:512
    ds_read_b64_tr_b16 v[148:149], v29 offset:32
    ds_read_b64_tr_b16 v[150:151], v29 offset:544
    ds_read_b64_tr_b16 v[152:153], v29 offset:64
    ds_read_b64_tr_b16 v[154:155], v29 offset:576
    ds_read_b64_tr_b16 v[156:157], v29 offset:96
    ds_read_b64_tr_b16 v[158:159], v29 offset:608
    s_waitcnt lgkmcnt(0)
    ds_write_b128 v28, v[160:163] offset:0
    ds_write_b128 v28, v[164:167] offset:1056
    ds_write_b128 v28, v[168:171] offset:2112
    ds_write_b128 v28, v[172:175] offset:3168
    s_waitcnt lgkmcnt(0)
    ds_read_b64_tr_b16 v[160:161], v29 offset:0
    ds_read_b64_tr_b16 v[162:163], v29 offset:512
    ds_read_b64_tr_b16 v[164:165], v29 offset:32
    ds_read_b64_tr_b16 v[166:167], v29 offset:544
    ds_read_b64_tr_b16 v[168:169], v29 offset:64
    ds_read_b64_tr_b16 v[170:171], v29 offset:576
    ds_read_b64_tr_b16 v[172:173], v29 offset:96
    ds_read_b64_tr_b16 v[174:175], v29 offset:608
    s_waitcnt lgkmcnt(0)
    ds_write_b128 v28, v[176:179] offset:0
    ds_write_b128 v28, v[180:183] offset:1056
    ds_write_b128 v28, v[184:187] offset:2112
    ds_write_b128 v28, v[188:191] offset:3168
    s_waitcnt lgkmcnt(0)
    ds_read_b64_tr_b16 v[176:177], v29 offset:0
    ds_read_b64_tr_b16 v[178:179], v29 offset:512
    ds_read_b64_tr_b16 v[180:181], v29 offset:32
    ds_read_b64_tr_b16 v[182:183], v29 offset:544
    ds_read_b64_tr_b16 v[184:185], v29 offset:64
    ds_read_b64_tr_b16 v[186:187], v29 offset:576
    ds_read_b64_tr_b16 v[188:189], v29 offset:96
    ds_read_b64_tr_b16 v[190:191], v29 offset:608
    s_waitcnt lgkmcnt(0)
    ds_write_b128 v28, v[192:195] offset:0
    ds_write_b128 v28, v[196:199] offset:1056
    ds_write_b128 v28, v[200:203] offset:2112
    ds_write_b128 v28, v[204:207] offset:3168
    s_waitcnt lgkmcnt(0)
    ds_read_b64_tr_b16 v[192:193], v29 offset:0
    ds_read_b64_tr_b16 v[194:195], v29 offset:512
    ds_read_b64_tr_b16 v[196:197], v29 offset:32
    ds_read_b64_tr_b16 v[198:199], v29 offset:544
    ds_read_b64_tr_b16 v[200:201], v29 offset:64
    ds_read_b64_tr_b16 v[202:203], v29 offset:576
    ds_read_b64_tr_b16 v[204:205], v29 offset:96
    ds_read_b64_tr_b16 v[206:207], v29 offset:608
    s_waitcnt lgkmcnt(0)
    ds_write_b128 v28, v[208:211] offset:0
    ds_write_b128 v28, v[212:215] offset:1056
    ds_write_b128 v28, v[216:219] offset:2112
    ds_write_b128 v28, v[220:223] offset:3168
    s_waitcnt lgkmcnt(0)
    ds_read_b64_tr_b16 v[208:209], v29 offset:0
    ds_read_b64_tr_b16 v[210:211], v29 offset:512
    ds_read_b64_tr_b16 v[212:213], v29 offset:32
    ds_read_b64_tr_b16 v[214:215], v29 offset:544
    ds_read_b64_tr_b16 v[216:217], v29 offset:64
    ds_read_b64_tr_b16 v[218:219], v29 offset:576
    ds_read_b64_tr_b16 v[220:221], v29 offset:96
    ds_read_b64_tr_b16 v[222:223], v29 offset:608
    s_waitcnt lgkmcnt(0)
    ds_write_b128 v28, v[224:227] offset:0
    ds_write_b128 v28, v[228:231] offset:1056
    ds_write_b128 v28, v[232:235] offset:2112
    ds_write_b128 v28, v[236:239] offset:3168
    s_waitcnt lgkmcnt(0)
    ds_read_b64_tr_b16 v[224:225], v29 offset:0
    ds_read_b64_tr_b16 v[226:227], v29 offset:512
    ds_read_b64_tr_b16 v[228:229], v29 offset:32
    ds_read_b64_tr_b16 v[230:231], v29 offset:544
    ds_read_b64_tr_b16 v[232:233], v29 offset:64
    ds_read_b64_tr_b16 v[234:235], v29 offset:576
    ds_read_b64_tr_b16 v[236:237], v29 offset:96
    ds_read_b64_tr_b16 v[238:239], v29 offset:608
    s_waitcnt lgkmcnt(0)
    ds_write_b128 v28, v[240:243] offset:0
    ds_write_b128 v28, v[244:247] offset:1056
    ds_write_b128 v28, v[248:251] offset:2112
    ds_write_b128 v28, v[252:255] offset:3168
    s_waitcnt lgkmcnt(0)
    ds_read_b64_tr_b16 v[240:241], v29 offset:0
    ds_read_b64_tr_b16 v[242:243], v29 offset:512
    ds_read_b64_tr_b16 v[244:245], v29 offset:32
    ds_read_b64_tr_b16 v[246:247], v29 offset:544
    ds_read_b64_tr_b16 v[248:249], v29 offset:64
    ds_read_b64_tr_b16 v[250:251], v29 offset:576
    ds_read_b64_tr_b16 v[252:253], v29 offset:96
    ds_read_b64_tr_b16 v[254:255], v29 offset:608
    s_waitcnt lgkmcnt(0)
    s_mov_b32 s49, 400000
L_cw6:
    buffer_load_dword v1, off, s[56:59], 0 sc1
    s_waitcnt vmcnt(0)
    v_cmp_eq_u32 vcc, 0, v1
    s_sub_u32 s49, s49, 1
    s_cbranch_scc1 L_cwx6
    s_cbranch_vccz L_cwx6
    s_sleep 8
    s_branch L_cw6
L_cwx6:
    v_and_b32 v1, 0xfff, v1
    s_nop 0
    v_readfirstlane_b32 s96, v1
    v_or_b32 v7, 0xa000, v1
    s_mov_b32 s52, s24
    s_mov_b32 s53, s25
    s_mov_b32 s54, 1048576
    s_mov_b32 s55, 0x20000
    s_lshl_b32 s47, s51, 12
    s_add_u32 s47, s47, 1792
    s_cmp_eq_u32 s50, 0
    s_cbranch_scc1 L_f3
    v_lshrrev_b32 v5, 4, v0
    v_and_b32 v6, 15, v0
    v_lshlrev_b32 v4, 17, v5
    v_lshl_add_u32 v4, v6, 4, v4
    s_mul_i32 s47, s62, 28672
    s_add_u32 s47, s47, 1792
    v_add_u32 v4, s47, v4
    v_mul_u32_u24 v5, 1040, v5
    v_lshl_add_u32 v5, v6, 3, v5
    s_mov_b32 s63, 0x07060302
    s_mov_b32 s49, 400000
L_hg0:
    s_mov_b32 s47, 0
    buffer_load_dwordx4 v[8:11], v4, s[52:55], s47 offen sc1
    s_mov_b32 s47, 4096
    buffer_load_dwordx4 v[12:15], v4, s[52:55], s47 offen sc1
    s_mov_b32 s47, 8192
    buffer_load_dwordx4 v[16:19], v4, s[52:55], s47 offen sc1
    s_mov_b32 s47, 12288
    buffer_load_dwordx4 v[20:23], v4, s[52:55], s47 offen sc1
    s_mov_b32 s47, 16384
    buffer_load_dwordx4 v[24:27], v4, s[52:55], s47 offen sc1
    s_waitcnt vmcnt(0)
    v_xor_b32 v6, v8, v7
    v_bitop3_b32 v6, v9, v7, v6 bitop3:0xbe
    v_bitop3_b32 v6, v10, v7, v6 bitop3:0xbe
    v_bitop3_b32 v6, v11, v7, v6 bitop3:0xbe
    v_bitop3_b32 v6, v12, v7, v6 bitop3:0xbe
    v_bitop3_b32 v6, v13, v7, v6 bitop3:0xbe
    v_bitop3_b32 v6, v14, v7, v6 bitop3:0xbe
    v_bitop3_b32 v6, v15, v7, v6 bitop3:0xbe
    v_bitop3_b32 v6, v16, v7, v6 bitop3:0xbe
    v_bitop3_b32 v6, v17, v7, v6 bitop3:0xbe
    v_bitop3_b32 v6, v18, v7, v6 bitop3:0xbe
    v_bitop3_b32 v6, v19, v7, v6 bitop3:0xbe
    v_bitop3_b32 v6, v20, v7, v6 bitop3:0xbe
    v_bitop3_b32 v6, v21, v7, v6 bitop3:0xbe
    v_bitop3_b32 v6, v22, v7, v6 bitop3:0xbe
    v_bitop3_b32 v6, v23, v7, v6 bitop3:0xbe
    v_bitop3_b32 v6, v24, v7, v6 bitop3:0xbe
    v_bitop3_b32 v6, v25, v7, v6 bitop3:0xbe
    v_bitop3_b32 v6, v26, v7, v6 bitop3:0xbe
    v_bitop3_b32 v6, v27, v7, v6 bitop3:0xbe
    v_and_b32 v6, 0xffff, v6
    v_cmp_ne_u32 vcc, 0, v6
    s_sub_u32 s49, s49, 1
    s_cbranch_scc1 L_hx0
    s_cbranch_vccz L_hx0
    s_sleep 32
    s_branch L_hg0
L_hx0:
    v_perm_b32 v8, v9, v8, s63
    v_perm_b32 v9, v11, v10, s63
    ds_write_b64 v5, v[8:9] offset:18304
    v_perm_b32 v12, v13, v12, s63
    v_perm_b32 v13, v15, v14, s63
    ds_write_b64 v5, v[12:13] offset:18432
    v_perm_b32 v16, v17, v16, s63
    v_perm_b32 v17, v19, v18, s63
    ds_write_b64 v5, v[16:17] offset:18560
    v_perm_b32 v20, v21, v20, s63
    v_perm_b32 v21, v23, v22, s63
    ds_write_b64 v5, v[20:21] offset:18688
    v_perm_b32 v24, v25, v24, s63
    v_perm_b32 v25, v27, v26, s63
    ds_write_b64 v5, v[24:25] offset:18816
    s_waitcnt lgkmcnt(0)
    s_mov_b32 s49, 400000
L_hg1:
    s_mov_b32 s47, 20480
    buffer_load_dwordx4 v[8:11], v4, s[52:55], s47 offen sc1
    s_mov_b32 s47, 24576
    buffer_load_dwordx4 v[12:15], v4, s[52:55], s47 offen sc1
    s_mov_b32 s47, 524288
    buffer_load_dwordx4 v[16:19], v4, s[52:55], s47 offen sc1
    s_mov_b32 s47, 528384
    buffer_load_dwordx4 v[20:23], v4, s[52:55], s47 offen sc1
    s_mov_b32 s47, 532480
    buffer_load_dwordx4 v[24:27], v4, s[52:55], s47 offen sc1
    s_waitcnt vmcnt(0)
    v_xor_b32 v6, v8, v7
    v_bitop3_b32 v6, v9, v7, v6 bitop3:0xbe
    v_bitop3_b32 v6, v10, v7, v6 bitop3:0xbe
    v_bitop3_b32 v6, v11, v7, v6 bitop3:0xbe
    v_bitop3_b32 v6, v12, v7, v6 bitop3:0xbe
    v_bitop3_b32 v6, v13, v7, v6 bitop3:0xbe
    v_bitop3_b32 v6, v14, v7, v6 bitop3:0xbe
    v_bitop3_b32 v6, v15, v7, v6 bitop3:0xbe
    v_bitop3_b32 v6, v16, v7, v6 bitop3:0xbe
    v_bitop3_b32 v6, v17, v7, v6 bitop3:0xbe
    v_bitop3_b32 v6, v18, v7, v6 bitop3:0xbe
    v_bitop3_b32 v6, v19, v7, v6 bitop3:0xbe
    v_bitop3_b32 v6, v20, v7, v6 bitop3:0xbe
    v_bitop3_b32 v6, v21, v7, v6 bitop3:0xbe
    v_bitop3_b32 v6, v22, v7, v6 bitop3:0xbe
    v_bitop3_b32 v6, v23, v7, v6 bitop3:0xbe
    v_bitop3_b32 v6, v24, v7, v6 bitop3:0xbe
    v_bitop3_b32 v6, v25, v7, v6 bitop3:0xbe
    v_bitop3_b32 v6, v26, v7, v6 bitop3:0xbe
    v_bitop3_b32 v6, v27, v7, v6 bitop3:0xbe
    v_and_b32 v6, 0xffff, v6
    v_cmp_ne_u32 vcc, 0, v6
    s_sub_u32 s49, s49, 1
    s_cbranch_scc1 L_hx1
    s_cbranch_vccz L_hx1
    s_sleep 32
    s_branch L_hg1
L_hx1:
    v_perm_b32 v8, v9, v8, s63
    v_perm_b32 v9, v11, v10, s63
    ds_write_b64 v5, v[8:9] offset:18944
    v_perm_b32 v12, v13, v12, s63
    v_perm_b32 v13, v15, v14, s63
    ds_write_b64 v5, v[12:13] offset:19072
    v_perm_b32 v16, v17, v16, s63
    v_perm_b32 v17, v19, v18, s63
    ds_write_b64 v5, v[16:17] offset:22464
    v_perm_b32 v20, v21, v20, s63
    v_perm_b32 v21, v23, v22, s63
    ds_write_b64 v5, v[20:21] offset:22592
    v_perm_b32 v24, v25, v24, s63
    v_perm_b32 v25, v27, v26, s63
    ds_write_b64 v5, v[24:25] offset:22720
    s_waitcnt lgkmcnt(0)
    s_mov_b32 s49, 400000
L_hg2:
    s_mov_b32 s47, 536576
    buffer_load_dwordx4 v[8:11], v4, s[52:55], s47 offen sc1
    s_mov_b32 s47, 540672
    buffer_load_dwordx4 v[12:15], v4, s[52:55], s47 offen sc1
    s_mov_b32 s47, 544768
    buffer_load_dwordx4 v[16:19], v4, s[52:55], s47 offen sc1
    s_mov_b32 s47, 548864
    buffer_load_dwordx4 v[20:23], v4, s[52:55], s47 offen sc1
    s_waitcnt vmcnt(0)
    v_xor_b32 v6, v8, v7
    v_bitop3_b32 v6, v9, v7, v6 bitop3:0xbe
    v_bitop3_b32 v6, v10, v7, v6 bitop3:0xbe
    v_bitop3_b32 v6, v11, v7, v6 bitop3:0xbe
    v_bitop3_b32 v6, v12, v7, v6 bitop3:0xbe
    v_bitop3_b32 v6, v13, v7, v6 bitop3:0xbe
    v_bitop3_b32 v6, v14, v7, v6 bitop3:0xbe
    v_bitop3_b32 v6, v15, v7, v6 bitop3:0xbe
    v_bitop3_b32 v6, v16, v7, v6 bitop3:0xbe
    v_bitop3_b32 v6, v17, v7, v6 bitop3:0xbe
    v_bitop3_b32 v6, v18, v7, v6 bitop3:0xbe
    v_bitop3_b32 v6, v19, v7, v6 bitop3:0xbe
    v_bitop3_b32 v6, v20, v7, v6 bitop3:0xbe
    v_bitop3_b32 v6, v21, v7, v6 bitop3:0xbe
    v_bitop3_b32 v6, v22, v7, v6 bitop3:0xbe
    v_bitop3_b32 v6, v23, v7, v6 bitop3:0xbe
    v_and_b32 v6, 0xffff, v6
    v_cmp_ne_u32 vcc, 0, v6
    s_sub_u32 s49, s49, 1
    s_cbranch_scc1 L_hx2
    s_cbranch_vccz L_hx2
    s_sleep 32
    s_branch L_hg2
L_hx2:
    v_perm_b32 v8, v9, v8, s63
    v_perm_b32 v9, v11, v10, s63
    ds_write_b64 v5, v[8:9] offset:22848
    v_perm_b32 v12, v13, v12, s63
    v_perm_b32 v13, v15, v14, s63
    ds_write_b64 v5, v[12:13] offset:22976
    v_perm_b32 v16, v17, v16, s63
    v_perm_b32 v17, v19, v18, s63
    ds_write_b64 v5, v[16:17] offset:23104
    v_perm_b32 v20, v21, v20, s63
    v_perm_b32 v21, v23, v22, s63
    ds_write_b64 v5, v[20:21] offset:23232
    s_waitcnt lgkmcnt(0)
    s_mul_i32 s63, s62, 7
    s_sub_u32 s63, s51, s63
    s_lshl_b32 s47, s62, 12
    s_lshl_b32 s48, s63, 8
    s_add_u32 s47, s47, s48
    s_add_u32 s47, s47, 2048
L_f3:
    v_and_b32 v30, 3, v0
    v_mul_u32_u24 v30, 1040, v30
    v_lshrrev_b32 v31, 4, v0
    v_lshl_add_u32 v30, v31, 4, v30
    v_lshl_add_u32 v31, v0, 2, s47
    ds_read_b128 v[20:23], v30 offset:18304
    s_waitcnt lgkmcnt(0)
    v_mfma_f32_16x16x32_bf16 v[4:7], v[20:23], v[32:35], 0
    v_mfma_f32_16x16x32_bf16 v[8:11], v[20:23], v[36:39], 0
    v_mfma_f32_16x16x32_bf16 v[12:15], v[20:23], v[40:43], 0
    v_mfma_f32_16x16x32_bf16 v[16:19], v[20:23], v[44:47], 0
    ds_read_b128 v[24:27], v30 offset:18368
    s_waitcnt lgkmcnt(0)
    v_mfma_f32_16x16x32_bf16 v[4:7], v[24:27], v[48:51], v[4:7]
    v_mfma_f32_16x16x32_bf16 v[8:11], v[24:27], v[52:55], v[8:11]
    v_mfma_f32_16x16x32_bf16 v[12:15], v[24:27], v[56:59], v[12:15]
    v_mfma_f32_16x16x32_bf16 v[16:19], v[24:27], v[60:63], v[16:19]
    ds_read_b128 v[20:23], v30 offset:18432
    s_waitcnt lgkmcnt(0)
    v_mfma_f32_16x16x32_bf16 v[4:7], v[20:23], v[64:67], v[4:7]
    v_mfma_f32_16x16x32_bf16 v[8:11], v[20:23], v[68:71], v[8:11]
    v_mfma_f32_16x16x32_bf16 v[12:15], v[20:23], v[72:75], v[12:15]
    v_mfma_f32_16x16x32_bf16 v[16:19], v[20:23], v[76:79], v[16:19]
    ds_read_b128 v[24:27], v30 offset:18496
    s_waitcnt lgkmcnt(0)
    v_mfma_f32_16x16x32_bf16 v[4:7], v[24:27], v[80:83], v[4:7]
    v_mfma_f32_16x16x32_bf16 v[8:11], v[24:27], v[84:87], v[8:11]
    v_mfma_f32_16x16x32_bf16 v[12:15], v[24:27], v[88:91], v[12:15]
    v_mfma_f32_16x16x32_bf16 v[16:19], v[24:27], v[92:95], v[16:19]
    ds_read_b128 v[20:23], v30 offset:18560
    s_waitcnt lgkmcnt(0)
    v_mfma_f32_16x16x32_bf16 v[4:7], v[20:23], v[96:99], v[4:7]
    v_mfma_f32_16x16x32_bf16 v[8:11], v[20:23], v[100:103], v[8:11]
    v_mfma_f32_16x16x32_bf16 v[12:15], v[20:23], v[104:107], v[12:15]
    v_mfma_f32_16x16x32_bf16 v[16:19], v[20:23], v[108:111], v[16:19]
    ds_read_b128 v[24:27], v30 offset:18624
    s_waitcnt lgkmcnt(0)
    v_mfma_f32_16x16x32_bf16 v[4:7], v[24:27], v[112:115], v[4:7]
    v_mfma_f32_16x16x32_bf16 v[8:11], v[24:27], v[116:119], v[8:11]
    v_mfma_f32_16x16x32_bf16 v[12:15], v[24:27], v[120:123], v[12:15]
    v_mfma_f32_16x16x32_bf16 v[16:19], v[24:27], v[124:127], v[16:19]
    ds_read_b128 v[20:23], v30 offset:18688
    s_waitcnt lgkmcnt(0)
    v_mfma_f32_16x16x32_bf16 v[4:7], v[20:23], v[128:131], v[4:7]
    v_mfma_f32_16x16x32_bf16 v[8:11], v[20:23], v[132:135], v[8:11]
    v_mfma_f32_16x16x32_bf16 v[12:15], v[20:23], v[136:139], v[12:15]
    v_mfma_f32_16x16x32_bf16 v[16:19], v[20:23], v[140:143], v[16:19]
    ds_read_b128 v[24:27], v30 offset:18752
    s_waitcnt lgkmcnt(0)
    v_mfma_f32_16x16x32_bf16 v[4:7], v[24:27], v[144:147], v[4:7]
    v_mfma_f32_16x16x32_bf16 v[8:11], v[24:27], v[148:151], v[8:11]
    v_mfma_f32_16x16x32_bf16 v[12:15], v[24:27], v[152:155], v[12:15]
    v_mfma_f32_16x16x32_bf16 v[16:19], v[24:27], v[156:159], v[16:19]
    ds_read_b128 v[20:23], v30 offset:18816
    s_waitcnt lgkmcnt(0)
    v_mfma_f32_16x16x32_bf16 v[4:7], v[20:23], v[160:163], v[4:7]
    v_mfma_f32_16x16x32_bf16 v[8:11], v[20:23], v[164:167], v[8:11]
    v_mfma_f32_16x16x32_bf16 v[12:15], v[20:23], v[168:171], v[12:15]
    v_mfma_f32_16x16x32_bf16 v[16:19], v[20:23], v[172:175], v[16:19]
    ds_read_b128 v[24:27], v30 offset:18880
    s_waitcnt lgkmcnt(0)
    v_mfma_f32_16x16x32_bf16 v[4:7], v[24:27], v[176:179], v[4:7]
    v_mfma_f32_16x16x32_bf16 v[8:11], v[24:27], v[180:183], v[8:11]
    v_mfma_f32_16x16x32_bf16 v[12:15], v[24:27], v[184:187], v[12:15]
    v_mfma_f32_16x16x32_bf16 v[16:19], v[24:27], v[188:191], v[16:19]
    ds_read_b128 v[20:23], v30 offset:18944
    s_waitcnt lgkmcnt(0)
    v_mfma_f32_16x16x32_bf16 v[4:7], v[20:23], v[192:195], v[4:7]
    v_mfma_f32_16x16x32_bf16 v[8:11], v[20:23], v[196:199], v[8:11]
    v_mfma_f32_16x16x32_bf16 v[12:15], v[20:23], v[200:203], v[12:15]
    v_mfma_f32_16x16x32_bf16 v[16:19], v[20:23], v[204:207], v[16:19]
    ds_read_b128 v[24:27], v30 offset:19008
    s_waitcnt lgkmcnt(0)
    v_mfma_f32_16x16x32_bf16 v[4:7], v[24:27], v[208:211], v[4:7]
    v_mfma_f32_16x16x32_bf16 v[8:11], v[24:27], v[212:215], v[8:11]
    v_mfma_f32_16x16x32_bf16 v[12:15], v[24:27], v[216:219], v[12:15]
    v_mfma_f32_16x16x32_bf16 v[16:19], v[24:27], v[220:223], v[16:19]
    ds_read_b128 v[20:23], v30 offset:19072
    s_waitcnt lgkmcnt(0)
    v_mfma_f32_16x16x32_bf16 v[4:7], v[20:23], v[224:227], v[4:7]
    v_mfma_f32_16x16x32_bf16 v[8:11], v[20:23], v[228:231], v[8:11]
    v_mfma_f32_16x16x32_bf16 v[12:15], v[20:23], v[232:235], v[12:15]
    v_mfma_f32_16x16x32_bf16 v[16:19], v[20:23], v[236:239], v[16:19]
    ds_read_b128 v[24:27], v30 offset:19136
    s_waitcnt lgkmcnt(0)
    v_mfma_f32_16x16x32_bf16 v[4:7], v[24:27], v[240:243], v[4:7]
    v_mfma_f32_16x16x32_bf16 v[8:11], v[24:27], v[244:247], v[8:11]
    v_mfma_f32_16x16x32_bf16 v[12:15], v[24:27], v[248:251], v[12:15]
    v_mfma_f32_16x16x32_bf16 v[16:19], v[24:27], v[252:255], v[16:19]
    s_mov_b32 s44, 0
    s_mov_b32 s45, 131072
    s_mov_b32 s46, 262144
    s_mov_b32 s47, 393216
    s_nop 7
    v_mov_b32_dpp v4, v8 quad_perm:[0,1,2,3] row_mask:0x2 bank_mask:0xf
    v_mov_b32_dpp v4, v12 quad_perm:[0,1,2,3] row_mask:0x4 bank_mask:0xf
    v_mov_b32_dpp v4, v16 quad_perm:[0,1,2,3] row_mask:0x8 bank_mask:0xf
    v_mov_b32_dpp v5, v9 quad_perm:[0,1,2,3] row_mask:0x2 bank_mask:0xf
    v_mov_b32_dpp v5, v13 quad_perm:[0,1,2,3] row_mask:0x4 bank_mask:0xf
    v_mov_b32_dpp v5, v17 quad_perm:[0,1,2,3] row_mask:0x8 bank_mask:0xf
    v_mov_b32_dpp v6, v10 quad_perm:[0,1,2,3] row_mask:0x2 bank_mask:0xf
    v_mov_b32_dpp v6, v14 quad_perm:[0,1,2,3] row_mask:0x4 bank_mask:0xf
    v_mov_b32_dpp v6, v18 quad_perm:[0,1,2,3] row_mask:0x8 bank_mask:0xf
    v_mov_b32_dpp v7, v11 quad_perm:[0,1,2,3] row_mask:0x2 bank_mask:0xf
    v_mov_b32_dpp v7, v15 quad_perm:[0,1,2,3] row_mask:0x4 bank_mask:0xf
    v_mov_b32_dpp v7, v19 quad_perm:[0,1,2,3] row_mask:0x8 bank_mask:0xf
    s_cmp_eq_u32 s50, 1
    s_cbranch_scc1 L_f40
    v_or_b32 v21, 0xa000, v1
    v_cvt_pk_bf16_f32 v4, 0, v4
    v_mul_f32 v20, 0xbfb8aa3b, v4
    v_exp_f32 v20, v20
    s_nop 0
    v_add_f32 v20, 1.0, v20
    v_rcp_f32 v20, v20
    s_nop 0
    v_mul_f32 v4, v4, v20
    v_cvt_pk_bf16_f32 v4, 0, v4
    v_or_b32 v4, v4, v21
    v_cvt_pk_bf16_f32 v5, 0, v5
    v_mul_f32 v20, 0xbfb8aa3b, v5
    v_exp_f32 v20, v20
    s_nop 0
    v_add_f32 v20, 1.0, v20
    v_rcp_f32 v20, v20
    s_nop 0
    v_mul_f32 v5, v5, v20
    v_cvt_pk_bf16_f32 v5, 0, v5
    v_or_b32 v5, v5, v21
    v_cvt_pk_bf16_f32 v6, 0, v6
    v_mul_f32 v20, 0xbfb8aa3b, v6
    v_exp_f32 v20, v20
    s_nop 0
    v_add_f32 v20, 1.0, v20
    v_rcp_f32 v20, v20
    s_nop 0
    v_mul_f32 v6, v6, v20
    v_cvt_pk_bf16_f32 v6, 0, v6
    v_or_b32 v6, v6, v21
    v_cvt_pk_bf16_f32 v7, 0, v7
    v_mul_f32 v20, 0xbfb8aa3b, v7
    v_exp_f32 v20, v20
    s_nop 0
    v_add_f32 v20, 1.0, v20
    v_rcp_f32 v20, v20
    s_nop 0
    v_mul_f32 v7, v7, v20
    v_cvt_pk_bf16_f32 v7, 0, v7
    v_or_b32 v7, v7, v21
    s_branch L_f50
L_f40:
    v_add_u32 v4, 0x800, v4
    v_and_or_b32 v4, v4, s97, v1
    v_add_u32 v5, 0x800, v5
    v_and_or_b32 v5, v5, s97, v1
    v_add_u32 v6, 0x800, v6
    v_and_or_b32 v6, v6, s97, v1
    v_add_u32 v7, 0x800, v7
    v_and_or_b32 v7, v7, s97, v1
L_f50:
    buffer_store_dword v4, v31, s[52:55], s44 offen sc1
    buffer_store_dword v5, v31, s[52:55], s45 offen sc1
    buffer_store_dword v6, v31, s[52:55], s46 offen sc1
    buffer_store_dword v7, v31, s[52:55], s47 offen sc1
    s_nop 1
    ds_read_b128 v[20:23], v30 offset:22464
    s_waitcnt lgkmcnt(0)
    v_mfma_f32_16x16x32_bf16 v[4:7], v[20:23], v[32:35], 0
    v_mfma_f32_16x16x32_bf16 v[8:11], v[20:23], v[36:39], 0
    v_mfma_f32_16x16x32_bf16 v[12:15], v[20:23], v[40:43], 0
    v_mfma_f32_16x16x32_bf16 v[16:19], v[20:23], v[44:47], 0
    ds_read_b128 v[24:27], v30 offset:22528
    s_waitcnt lgkmcnt(0)
    v_mfma_f32_16x16x32_bf16 v[4:7], v[24:27], v[48:51], v[4:7]
    v_mfma_f32_16x16x32_bf16 v[8:11], v[24:27], v[52:55], v[8:11]
    v_mfma_f32_16x16x32_bf16 v[12:15], v[24:27], v[56:59], v[12:15]
    v_mfma_f32_16x16x32_bf16 v[16:19], v[24:27], v[60:63], v[16:19]
    ds_read_b128 v[20:23], v30 offset:22592
    s_waitcnt lgkmcnt(0)
    v_mfma_f32_16x16x32_bf16 v[4:7], v[20:23], v[64:67], v[4:7]
    v_mfma_f32_16x16x32_bf16 v[8:11], v[20:23], v[68:71], v[8:11]
    v_mfma_f32_16x16x32_bf16 v[12:15], v[20:23], v[72:75], v[12:15]
    v_mfma_f32_16x16x32_bf16 v[16:19], v[20:23], v[76:79], v[16:19]
    ds_read_b128 v[24:27], v30 offset:22656
    s_waitcnt lgkmcnt(0)
    v_mfma_f32_16x16x32_bf16 v[4:7], v[24:27], v[80:83], v[4:7]
    v_mfma_f32_16x16x32_bf16 v[8:11], v[24:27], v[84:87], v[8:11]
    v_mfma_f32_16x16x32_bf16 v[12:15], v[24:27], v[88:91], v[12:15]
    v_mfma_f32_16x16x32_bf16 v[16:19], v[24:27], v[92:95], v[16:19]
    ds_read_b128 v[20:23], v30 offset:22720
    s_waitcnt lgkmcnt(0)
    v_mfma_f32_16x16x32_bf16 v[4:7], v[20:23], v[96:99], v[4:7]
    v_mfma_f32_16x16x32_bf16 v[8:11], v[20:23], v[100:103], v[8:11]
    v_mfma_f32_16x16x32_bf16 v[12:15], v[20:23], v[104:107], v[12:15]
    v_mfma_f32_16x16x32_bf16 v[16:19], v[20:23], v[108:111], v[16:19]
    ds_read_b128 v[24:27], v30 offset:22784
    s_waitcnt lgkmcnt(0)
    v_mfma_f32_16x16x32_bf16 v[4:7], v[24:27], v[112:115], v[4:7]
    v_mfma_f32_16x16x32_bf16 v[8:11], v[24:27], v[116:119], v[8:11]
    v_mfma_f32_16x16x32_bf16 v[12:15], v[24:27], v[120:123], v[12:15]
    v_mfma_f32_16x16x32_bf16 v[16:19], v[24:27], v[124:127], v[16:19]
    ds_read_b128 v[20:23], v30 offset:22848
    s_waitcnt lgkmcnt(0)
    v_mfma_f32_16x16x32_bf16 v[4:7], v[20:23], v[128:131], v[4:7]
    v_mfma_f32_16x16x32_bf16 v[8:11], v[20:23], v[132:135], v[8:11]
    v_mfma_f32_16x16x32_bf16 v[12:15], v[20:23], v[136:139], v[12:15]
    v_mfma_f32_16x16x32_bf16 v[16:19], v[20:23], v[140:143], v[16:19]
    ds_read_b128 v[24:27], v30 offset:22912
    s_waitcnt lgkmcnt(0)
    v_mfma_f32_16x16x32_bf16 v[4:7], v[24:27], v[144:147], v[4:7]
    v_mfma_f32_16x16x32_bf16 v[8:11], v[24:27], v[148:151], v[8:11]
    v_mfma_f32_16x16x32_bf16 v[12:15], v[24:27], v[152:155], v[12:15]
    v_mfma_f32_16x16x32_bf16 v[16:19], v[24:27], v[156:159], v[16:19]
    ds_read_b128 v[20:23], v30 offset:22976
    s_waitcnt lgkmcnt(0)
    v_mfma_f32_16x16x32_bf16 v[4:7], v[20:23], v[160:163], v[4:7]
    v_mfma_f32_16x16x32_bf16 v[8:11], v[20:23], v[164:167], v[8:11]
    v_mfma_f32_16x16x32_bf16 v[12:15], v[20:23], v[168:171], v[12:15]
    v_mfma_f32_16x16x32_bf16 v[16:19], v[20:23], v[172:175], v[16:19]
    ds_read_b128 v[24:27], v30 offset:23040
    s_waitcnt lgkmcnt(0)
    v_mfma_f32_16x16x32_bf16 v[4:7], v[24:27], v[176:179], v[4:7]
    v_mfma_f32_16x16x32_bf16 v[8:11], v[24:27], v[180:183], v[8:11]
    v_mfma_f32_16x16x32_bf16 v[12:15], v[24:27], v[184:187], v[12:15]
    v_mfma_f32_16x16x32_bf16 v[16:19], v[24:27], v[188:191], v[16:19]
    ds_read_b128 v[20:23], v30 offset:23104
    s_waitcnt lgkmcnt(0)
    v_mfma_f32_16x16x32_bf16 v[4:7], v[20:23], v[192:195], v[4:7]
    v_mfma_f32_16x16x32_bf16 v[8:11], v[20:23], v[196:199], v[8:11]
    v_mfma_f32_16x16x32_bf16 v[12:15], v[20:23], v[200:203], v[12:15]
    v_mfma_f32_16x16x32_bf16 v[16:19], v[20:23], v[204:207], v[16:19]
    ds_read_b128 v[24:27], v30 offset:23168
    s_waitcnt lgkmcnt(0)
    v_mfma_f32_16x16x32_bf16 v[4:7], v[24:27], v[208:211], v[4:7]
    v_mfma_f32_16x16x32_bf16 v[8:11], v[24:27], v[212:215], v[8:11]
    v_mfma_f32_16x16x32_bf16 v[12:15], v[24:27], v[216:219], v[12:15]
    v_mfma_f32_16x16x32_bf16 v[16:19], v[24:27], v[220:223], v[16:19]
    ds_read_b128 v[20:23], v30 offset:23232
    s_waitcnt lgkmcnt(0)
    v_mfma_f32_16x16x32_bf16 v[4:7], v[20:23], v[224:227], v[4:7]
    v_mfma_f32_16x16x32_bf16 v[8:11], v[20:23], v[228:231], v[8:11]
    v_mfma_f32_16x16x32_bf16 v[12:15], v[20:23], v[232:235], v[12:15]
    v_mfma_f32_16x16x32_bf16 v[16:19], v[20:23], v[236:239], v[16:19]
    ds_read_b128 v[24:27], v30 offset:23296
    s_waitcnt lgkmcnt(0)
    v_mfma_f32_16x16x32_bf16 v[4:7], v[24:27], v[240:243], v[4:7]
    v_mfma_f32_16x16x32_bf16 v[8:11], v[24:27], v[244:247], v[8:11]
    v_mfma_f32_16x16x32_bf16 v[12:15], v[24:27], v[248:251], v[12:15]
    v_mfma_f32_16x16x32_bf16 v[16:19], v[24:27], v[252:255], v[16:19]
    s_mov_b32 s44, 524288
    s_mov_b32 s45, 655360
    s_mov_b32 s46, 786432
    s_mov_b32 s47, 917504
    s_nop 7
    v_mov_b32_dpp v4, v8 quad_perm:[0,1,2,3] row_mask:0x2 bank_mask:0xf
    v_mov_b32_dpp v4, v12 quad_perm:[0,1,2,3] row_mask:0x4 bank_mask:0xf
    v_mov_b32_dpp v4, v16 quad_perm:[0,1,2,3] row_mask:0x8 bank_mask:0xf
    v_mov_b32_dpp v5, v9 quad_perm:[0,1,2,3] row_mask:0x2 bank_mask:0xf
    v_mov_b32_dpp v5, v13 quad_perm:[0,1,2,3] row_mask:0x4 bank_mask:0xf
    v_mov_b32_dpp v5, v17 quad_perm:[0,1,2,3] row_mask:0x8 bank_mask:0xf
    v_mov_b32_dpp v6, v10 quad_perm:[0,1,2,3] row_mask:0x2 bank_mask:0xf
    v_mov_b32_dpp v6, v14 quad_perm:[0,1,2,3] row_mask:0x4 bank_mask:0xf
    v_mov_b32_dpp v6, v18 quad_perm:[0,1,2,3] row_mask:0x8 bank_mask:0xf
    v_mov_b32_dpp v7, v11 quad_perm:[0,1,2,3] row_mask:0x2 bank_mask:0xf
    v_mov_b32_dpp v7, v15 quad_perm:[0,1,2,3] row_mask:0x4 bank_mask:0xf
    v_mov_b32_dpp v7, v19 quad_perm:[0,1,2,3] row_mask:0x8 bank_mask:0xf
    s_cmp_eq_u32 s50, 1
    s_cbranch_scc1 L_f41
    v_or_b32 v21, 0xa000, v1
    v_cvt_pk_bf16_f32 v4, 0, v4
    v_mul_f32 v20, 0xbfb8aa3b, v4
    v_exp_f32 v20, v20
    s_nop 0
    v_add_f32 v20, 1.0, v20
    v_rcp_f32 v20, v20
    s_nop 0
    v_mul_f32 v4, v4, v20
    v_cvt_pk_bf16_f32 v4, 0, v4
    v_or_b32 v4, v4, v21
    v_cvt_pk_bf16_f32 v5, 0, v5
    v_mul_f32 v20, 0xbfb8aa3b, v5
    v_exp_f32 v20, v20
    s_nop 0
    v_add_f32 v20, 1.0, v20
    v_rcp_f32 v20, v20
    s_nop 0
    v_mul_f32 v5, v5, v20
    v_cvt_pk_bf16_f32 v5, 0, v5
    v_or_b32 v5, v5, v21
    v_cvt_pk_bf16_f32 v6, 0, v6
    v_mul_f32 v20, 0xbfb8aa3b, v6
    v_exp_f32 v20, v20
    s_nop 0
    v_add_f32 v20, 1.0, v20
    v_rcp_f32 v20, v20
    s_nop 0
    v_mul_f32 v6, v6, v20
    v_cvt_pk_bf16_f32 v6, 0, v6
    v_or_b32 v6, v6, v21
    v_cvt_pk_bf16_f32 v7, 0, v7
    v_mul_f32 v20, 0xbfb8aa3b, v7
    v_exp_f32 v20, v20
    s_nop 0
    v_add_f32 v20, 1.0, v20
    v_rcp_f32 v20, v20
    s_nop 0
    v_mul_f32 v7, v7, v20
    v_cvt_pk_bf16_f32 v7, 0, v7
    v_or_b32 v7, v7, v21
    s_branch L_f51
L_f41:
    v_add_u32 v4, 0x800, v4
    v_and_or_b32 v4, v4, s97, v1
    v_add_u32 v5, 0x800, v5
    v_and_or_b32 v5, v5, s97, v1
    v_add_u32 v6, 0x800, v6
    v_and_or_b32 v6, v6, s97, v1
    v_add_u32 v7, 0x800, v7
    v_and_or_b32 v7, v7, s97, v1
L_f51:
    buffer_store_dword v4, v31, s[52:55], s44 offen sc1
    buffer_store_dword v5, v31, s[52:55], s45 offen sc1
    buffer_store_dword v6, v31, s[52:55], s46 offen sc1
    buffer_store_dword v7, v31, s[52:55], s47 offen sc1
    s_nop 1
    s_barrier
    s_mul_i32 s47, s31, 229376
    s_sub_u32 s48, s3, 1
    s_lshl_b32 s48, s48, 7
    s_add_u32 s47, s47, s48
    s_sub_u32 s48, 3670016, s47
    s_add_u32 s52, s12, s47
    s_addc_u32 s53, s13, 0
    s_mov_b32 s54, s48
    s_mov_b32 s55, 0x20000
    v_mul_u32_u24 v28, 896, v2
    v_lshl_add_u32 v28, v3, 4, v28
    s_mov_b32 s47, 0
    buffer_load_dwordx4 v[128:131], v28, s[52:55], s47 offen
    s_add_u32 s47, s47, 7168
    buffer_load_dwordx4 v[132:135], v28, s[52:55], s47 offen
    s_add_u32 s47, s47, 7168
    buffer_load_dwordx4 v[136:139], v28, s[52:55], s47 offen
    s_add_u32 s47, s47, 7168
    buffer_load_dwordx4 v[140:143], v28, s[52:55], s47 offen
    s_mov_b32 s47, 28672
    s_waitcnt vmcnt(3)
    buffer_load_dwordx4 v[144:147], v28, s[52:55], s47 offen
    s_add_u32 s47, s47, 7168
    s_waitcnt vmcnt(3)
    buffer_load_dwordx4 v[148:151], v28, s[52:55], s47 offen
    s_add_u32 s47, s47, 7168
    s_waitcnt vmcnt(3)
    buffer_load_dwordx4 v[152:155], v28, s[52:55], s47 offen
    s_add_u32 s47, s47, 7168
    s_waitcnt vmcnt(3)
    buffer_load_dwordx4 v[156:159], v28, s[52:55], s47 offen
    s_mov_b32 s47, 57344
    s_waitcnt vmcnt(3)
    buffer_load_dwordx4 v[160:163], v28, s[52:55], s47 offen
    s_add_u32 s47, s47, 7168
    s_waitcnt vmcnt(3)
    buffer_load_dwordx4 v[164:167], v28, s[52:55], s47 offen
    s_add_u32 s47, s47, 7168
    s_waitcnt vmcnt(3)
    buffer_load_dwordx4 v[168:171], v28, s[52:55], s47 offen
    s_add_u32 s47, s47, 7168
    s_waitcnt vmcnt(3)
    buffer_load_dwordx4 v[172:175], v28, s[52:55], s47 offen
    s_mov_b32 s47, 86016
    s_waitcnt vmcnt(3)
    buffer_load_dwordx4 v[176:179], v28, s[52:55], s47 offen
    s_add_u32 s47, s47, 7168
    s_waitcnt vmcnt(3)
    buffer_load_dwordx4 v[180:183], v28, s[52:55], s47 offen
    s_add_u32 s47, s47, 7168
    s_waitcnt vmcnt(3)
    buffer_load_dwordx4 v[184:187], v28, s[52:55], s47 offen
    s_add_u32 s47, s47, 7168
    s_waitcnt vmcnt(3)
    buffer_load_dwordx4 v[188:191], v28, s[52:55], s47 offen
    s_mov_b32 s47, 114688
    s_waitcnt vmcnt(3)
    buffer_load_dwordx4 v[192:195], v28, s[52:55], s47 offen
    s_add_u32 s47, s47, 7168
    s_waitcnt vmcnt(3)
    buffer_load_dwordx4 v[196:199], v28, s[52:55], s47 offen
    s_add_u32 s47, s47, 7168
    s_waitcnt vmcnt(3)
    buffer_load_dwordx4 v[200:203], v28, s[52:55], s47 offen
    s_add_u32 s47, s47, 7168
    s_waitcnt vmcnt(3)
    buffer_load_dwordx4 v[204:207], v28, s[52:55], s47 offen
    s_mov_b32 s47, 143360
    s_waitcnt vmcnt(3)
    buffer_load_dwordx4 v[208:211], v28, s[52:55], s47 offen
    s_add_u32 s47, s47, 7168
    s_waitcnt vmcnt(3)
    buffer_load_dwordx4 v[212:215], v28, s[52:55], s47 offen
    s_add_u32 s47, s47, 7168
    s_waitcnt vmcnt(3)
    buffer_load_dwordx4 v[216:219], v28, s[52:55], s47 offen
    s_add_u32 s47, s47, 7168
    s_waitcnt vmcnt(3)
    buffer_load_dwordx4 v[220:223], v28, s[52:55], s47 offen
    s_mov_b32 s47, 172032
    s_waitcnt vmcnt(3)
    buffer_load_dwordx4 v[224:227], v28, s[52:55], s47 offen
    s_add_u32 s47, s47, 7168
    s_waitcnt vmcnt(3)
    buffer_load_dwordx4 v[228:231], v28, s[52:55], s47 offen
    s_add_u32 s47, s47, 7168
    s_waitcnt vmcnt(3)
    buffer_load_dwordx4 v[232:235], v28, s[52:55], s47 offen
    s_add_u32 s47, s47, 7168
    s_waitcnt vmcnt(3)
    buffer_load_dwordx4 v[236:239], v28, s[52:55], s47 offen
    s_mov_b32 s47, 200704
    s_waitcnt vmcnt(3)
    buffer_load_dwordx4 v[240:243], v28, s[52:55], s47 offen
    s_add_u32 s47, s47, 7168
    s_waitcnt vmcnt(3)
    buffer_load_dwordx4 v[244:247], v28, s[52:55], s47 offen
    s_add_u32 s47, s47, 7168
    s_waitcnt vmcnt(3)
    buffer_load_dwordx4 v[248:251], v28, s[52:55], s47 offen
    s_add_u32 s47, s47, 7168
    s_waitcnt vmcnt(3)
    buffer_load_dwordx4 v[252:255], v28, s[52:55], s47 offen
    s_sub_u32 s47, s3, 1
    s_mul_i32 s47, s47, 8448
    s_add_u32 s47, s47, 27776
    v_lshl_add_u32 v28, v0, 4, s47
    v_bfe_u32 v29, v0, 2, 2
    v_lshrrev_b32 v31, 1, v29
    v_and_b32 v29, 1, v29
    v_lshlrev_b32 v29, 1, v29
    v_lshlrev_b32 v31, 7, v31
    v_lshrrev_b32 v30, 5, v0
    v_add_u32 v29, v29, v30
    v_mul_u32_u24 v29, 1056, v29
    v_bfe_u32 v30, v0, 4, 1
    v_lshl_add_u32 v31, v30, 9, v31
    v_add3_u32 v29, v29, v31, s47
    v_and_b32 v31, 3, v0
    v_lshl_add_u32 v29, v31, 3, v29
    s_waitcnt vmcnt(0)
    ds_write_b128 v28, v[128:131] offset:0
    ds_write_b128 v28, v[132:135] offset:1056
    ds_write_b128 v28, v[136:139] offset:2112
    ds_write_b128 v28, v[140:143] offset:3168
    ds_write_b128 v28, v[144:147] offset:4224
    ds_write_b128 v28, v[148:151] offset:5280
    ds_write_b128 v28, v[152:155] offset:6336
    ds_write_b128 v28, v[156:159] offset:7392
    s_waitcnt lgkmcnt(0)
    ds_read_b64_tr_b16 v[128:129], v29 offset:0
    ds_read_b64_tr_b16 v[130:131], v29 offset:256
    ds_read_b64_tr_b16 v[132:133], v29 offset:32
    ds_read_b64_tr_b16 v[134:135], v29 offset:288
    ds_read_b64_tr_b16 v[136:137], v29 offset:64
    ds_read_b64_tr_b16 v[138:139], v29 offset:320
    ds_read_b64_tr_b16 v[140:141], v29 offset:96
    ds_read_b64_tr_b16 v[142:143], v29 offset:352
    ds_read_b64_tr_b16 v[144:145], v29 offset:4224
    ds_read_b64_tr_b16 v[146:147], v29 offset:4480
    ds_read_b64_tr_b16 v[148:149], v29 offset:4256
    ds_read_b64_tr_b16 v[150:151], v29 offset:4512
    ds_read_b64_tr_b16 v[152:153], v29 offset:4288
    ds_read_b64_tr_b16 v[154:155], v29 offset:4544
    ds_read_b64_tr_b16 v[156:157], v29 offset:4320
    ds_read_b64_tr_b16 v[158:159], v29 offset:4576
    s_waitcnt lgkmcnt(0)
    ds_write_b128 v28, v[160:163] offset:0
    ds_write_b128 v28, v[164:167] offset:1056
    ds_write_b128 v28, v[168:171] offset:2112
    ds_write_b128 v28, v[172:175] offset:3168
    ds_write_b128 v28, v[176:179] offset:4224
    ds_write_b128 v28, v[180:183] offset:5280
    ds_write_b128 v28, v[184:187] offset:6336
    ds_write_b128 v28, v[188:191] offset:7392
    s_waitcnt lgkmcnt(0)
    ds_read_b64_tr_b16 v[160:161], v29 offset:0
    ds_read_b64_tr_b16 v[162:163], v29 offset:256
    ds_read_b64_tr_b16 v[164:165], v29 offset:32
    ds_read_b64_tr_b16 v[166:167], v29 offset:288
    ds_read_b64_tr_b16 v[168:169], v29 offset:64
    ds_read_b64_tr_b16 v[170:171], v29 offset:320
    ds_read_b64_tr_b16 v[172:173], v29 offset:96
    ds_read_b64_tr_b16 v[174:175], v29 offset:352
    ds_read_b64_tr_b16 v[176:177], v29 offset:4224
    ds_read_b64_tr_b16 v[178:179], v29 offset:4480
    ds_read_b64_tr_b16 v[180:181], v29 offset:4256
    ds_read_b64_tr_b16 v[182:183], v29 offset:4512
    ds_read_b64_tr_b16 v[184:185], v29 offset:4288
    ds_read_b64_tr_b16 v[186:187], v29 offset:4544
    ds_read_b64_tr_b16 v[188:189], v29 offset:4320
    ds_read_b64_tr_b16 v[190:191], v29 offset:4576
    s_waitcnt lgkmcnt(0)
    ds_write_b128 v28, v[192:195] offset:0
    ds_write_b128 v28, v[196:199] offset:1056
    ds_write_b128 v28, v[200:203] offset:2112
    ds_write_b128 v28, v[204:207] offset:3168
    ds_write_b128 v28, v[208:211] offset:4224
    ds_write_b128 v28, v[212:215] offset:5280
    ds_write_b128 v28, v[216:219] offset:6336
    ds_write_b128 v28, v[220:223] offset:7392
    s_waitcnt lgkmcnt(0)
    ds_read_b64_tr_b16 v[192:193], v29 offset:0
    ds_read_b64_tr_b16 v[194:195], v29 offset:256
    ds_read_b64_tr_b16 v[196:197], v29 offset:32
    ds_read_b64_tr_b16 v[198:199], v29 offset:288
    ds_read_b64_tr_b16 v[200:201], v29 offset:64
    ds_read_b64_tr_b16 v[202:203], v29 offset:320
    ds_read_b64_tr_b16 v[204:205], v29 offset:96
    ds_read_b64_tr_b16 v[206:207], v29 offset:352
    ds_read_b64_tr_b16 v[208:209], v29 offset:4224
    ds_read_b64_tr_b16 v[210:211], v29 offset:4480
    ds_read_b64_tr_b16 v[212:213], v29 offset:4256
    ds_read_b64_tr_b16 v[214:215], v29 offset:4512
    ds_read_b64_tr_b16 v[216:217], v29 offset:4288
    ds_read_b64_tr_b16 v[218:219], v29 offset:4544
    ds_read_b64_tr_b16 v[220:221], v29 offset:4320
    ds_read_b64_tr_b16 v[222:223], v29 offset:4576
    s_waitcnt lgkmcnt(0)
    ds_write_b128 v28, v[224:227] offset:0
    ds_write_b128 v28, v[228:231] offset:1056
    ds_write_b128 v28, v[232:235] offset:2112
    ds_write_b128 v28, v[236:239] offset:3168
    ds_write_b128 v28, v[240:243] offset:4224
    ds_write_b128 v28, v[244:247] offset:5280
    ds_write_b128 v28, v[248:251] offset:6336
    ds_write_b128 v28, v[252:255] offset:7392
    s_waitcnt lgkmcnt(0)
    ds_read_b64_tr_b16 v[224:225], v29 offset:0
    ds_read_b64_tr_b16 v[226:227], v29 offset:256
    ds_read_b64_tr_b16 v[228:229], v29 offset:32
    ds_read_b64_tr_b16 v[230:231], v29 offset:288
    ds_read_b64_tr_b16 v[232:233], v29 offset:64
    ds_read_b64_tr_b16 v[234:235], v29 offset:320
    ds_read_b64_tr_b16 v[236:237], v29 offset:96
    ds_read_b64_tr_b16 v[238:239], v29 offset:352
    ds_read_b64_tr_b16 v[240:241], v29 offset:4224
    ds_read_b64_tr_b16 v[242:243], v29 offset:4480
    ds_read_b64_tr_b16 v[244:245], v29 offset:4256
    ds_read_b64_tr_b16 v[246:247], v29 offset:4512
    ds_read_b64_tr_b16 v[248:249], v29 offset:4288
    ds_read_b64_tr_b16 v[250:251], v29 offset:4544
    ds_read_b64_tr_b16 v[252:253], v29 offset:4320
    ds_read_b64_tr_b16 v[254:255], v29 offset:4576
    s_waitcnt lgkmcnt(0)
    s_branch L_tail
L_end:
    s_endpgm
.section .rodata,"a"
.p2align 6
.amdhsa_kernel parallel_sum__mha_block_cached__dense_activation_silu__decode_kernel
  .amdhsa_next_free_vgpr 256
  .amdhsa_next_free_sgpr 102
  .amdhsa_accum_offset 256
  .amdhsa_group_segment_fixed_size 0
  .amdhsa_kernarg_size 88
  .amdhsa_user_sgpr_count 2
  .amdhsa_user_sgpr_kernarg_segment_ptr 1
  .amdhsa_system_sgpr_workgroup_id_x 1
.end_amdhsa_kernel
```
